```python
import torch

def _softmax(x, axis=-1):
    return torch.softmax(x, dim=axis)
def _gelu(x):
    return torch.nn.functional.gelu(x, approximate="tanh")
def _silu(x):
    return torch.nn.functional.silu(x)
def _sigmoid(x):
    return torch.sigmoid(x)
def _layernorm(x, axis=-1, eps=1e-5):
    m = x.mean(dim=axis, keepdim=True)
    v = x.var(dim=axis, keepdim=True, unbiased=False)
    return (x - m) / torch.sqrt(v + eps)
def _scatter_add(tgt, idx, src, axis=0):
    return tgt.clone().index_add_(axis, idx, src)
def _segment_sum(src, seg, n):
    out = torch.zeros((n,) + src.shape[1:], dtype=src.dtype)
    return out.index_add_(0, seg, src)
def _pad(x, pw):
    flat = tuple(v for pair in reversed(pw) for v in pair)
    return torch.nn.functional.pad(x, flat)

kernel_name = 'sequential_preLN__mha_block__dense_activation_gelu__prompt'

def setup_inputs():

    _w = (lambda a: (lambda t: t.to(torch.bfloat16) if t.is_floating_point() else t)(torch.as_tensor(a)))
    def _A_setup():
        B, S, D, H = 1, 2048, 576, 32
        return {
            "x": _w((lambda *s: torch.randn(*s, dtype=torch.bfloat16) * 0.05)(B, S, D)),
            "wqkv": _w((lambda *s: torch.randn(*s, dtype=torch.bfloat16) * 0.05)(D, 3 * D)),
            "wo": _w((lambda *s: torch.randn(*s, dtype=torch.bfloat16) * 0.05)(D, D)),
        }
    _A_in = _A_setup()

    def _B_setup():
        B, S, D, F = 1, 2048, 576, 4608
        return {
            "x": _w((lambda *s: torch.randn(*s, dtype=torch.bfloat16) * 0.05)(B, S, D)),
            "w1": _w((lambda *s: torch.randn(*s, dtype=torch.bfloat16) * 1.6)(D, F) * (D ** -0.5)),
            "b1": _w((lambda *s: torch.randn(*s, dtype=torch.bfloat16) * 1.6)(F) * 0.01),
            "w2": _w((lambda *s: torch.randn(*s, dtype=torch.bfloat16) * 0.2)(F, D) * (F ** -0.5)),
            "b2": _w((lambda *s: torch.randn(*s, dtype=torch.bfloat16) * 0.2)(D) * 0.01),
        }
    _B_in = _B_setup()

    return {
        "A_x": _A_in["x"],
        "A_wqkv": _A_in["wqkv"],
        "A_wo": _A_in["wo"],
        "B_x": _B_in["x"],
        "B_w1": _B_in["w1"],
        "B_b1": _B_in["b1"],
        "B_w2": _B_in["w2"],
        "B_b2": _B_in["b2"],
    }

def reference(A_x, A_wqkv, A_wo, B_x, B_w1, B_b1, B_w2, B_b2):
    def _A_ref(x, wqkv, wo):
        B, S, D = x.shape
        H = 32
        Dh = D // H
        qkv = (lambda x, *d: x.permute(*d))((x @ wqkv).reshape(B, S, 3, H, Dh), 2, 0, 3, 1, 4)
        q, k, v = qkv[0], qkv[1], qkv[2]
        scores = torch.einsum("bhqd,bhkd->bhqk", q, k) * (Dh ** -0.5)
        p = _softmax(scores, axis=-1)
        o = torch.einsum("bhqk,bhkd->bhqd", p, v)
        return (lambda x, *d: x.permute(*d))(o, 0, 2, 1, 3).reshape(B, S, D) @ wo

    def _B_ref(x, w1, b1, w2, b2):
        h = torch.einsum("bsd,df->bsf", x, w1) + b1
        h = _gelu(h)
        return torch.einsum("bsf,fd->bsd", h, w2) + b2

    x = A_x
    h = x + _A_ref(_layernorm(x, axis=-1), A_wqkv, A_wo)
    h2 = h + _B_ref(_layernorm(h, axis=-1), B_w1, B_b1, B_w2, B_b2)
    return h2
```

```asm
; @launch kernel=qkv_kernel grid=(256,1,1) block=(256,1,1) lds=100352
; @launch kernel=attn_kernel grid=(256,1,1) block=(512,1,1) lds=160512
; @launch kernel=ffn_kernel grid=(256,1,1) block=(256,1,1) lds=147456
.amdgcn_target "amdgcn-amd-amdhsa--gfx950"
.text
.globl qkv_kernel
.p2align 8
.type qkv_kernel,@function
qkv_kernel:
    s_cmp_ge_u32 s2, 256
    s_cbranch_scc1 qkv_kernel_end
    s_load_dwordx2 s[4:5], s[0:1], 0
    s_load_dwordx2 s[8:9], s[0:1], 8
    s_load_dwordx2 s[12:13], s[0:1], 80
    s_mov_b32 s6, 2359296
    s_mov_b32 s7, 0x20000
    s_mov_b32 s10, 1990656
    s_mov_b32 s11, 0x20000
    s_mov_b32 s14, 44826624
    s_mov_b32 s15, 0x20000
    v_lshrrev_b32 v212, 6, v0
    v_and_b32 v208, 63, v0
    v_readfirstlane_b32 s16, v212
    s_and_b32 s17, s2, 3
    s_bfe_u32 s24, s2, 0x20003
    s_lshl2_add_u32 s17, s17, s24
    s_bfe_u32 s18, s2, 0x10002
    s_lshr_b32 s25, s2, 5
    s_lshl3_add_u32 s18, s18, s25
    s_lshl2_add_u32 s23, s17, s16
    s_mul_i32 s19, s23, 36864
    v_lshrrev_b32 v212, 3, v208
    v_and_b32 v213, 7, v208
    v_lshrrev_b32 v210, 4, v208
    v_mul_u32_u24 v228, 1152, v212
    v_xor_b32 v213, v213, v210
    v_lshl_add_u32 v228, v213, 4, v228
    v_add_u32 v228, s19, v228
    v_xor_b32 v229, 64, v228
    v_add_u32 v230, 16384, v228
    v_add_u32 v231, 24576, v229
    v_add_u32 v229, 8192, v229
    s_lshl_b32 s30, s16, 12
    s_add_u32 s30, s30, 51200
    s_add_u32 s26, s24, s25
    s_and_b32 s26, s26, 3
    s_mul_i32 s26, s26, 2
    s_lshl_b32 s27, s26, 7
    v_and_b32 v209, 15, v208
    v_and_b32 v179, 1, v210
    v_lshrrev_b32 v178, 1, v210
    v_lshl_add_u32 v214, v178, 2, v179
    v_mul_u32_u24 v232, 13824, v214
    v_min_u32 v214, 13, v209
    v_lshl_add_u32 v232, v214, 4, v232
    v_add_u32 v233, 2400, v232
    v_add_u32 v234, 4800, v232
    v_add_u32 v235, 7200, v232
    s_and_b32 s19, s16, 2
    s_add_u32 s19, s19, s16
    s_mul_i32 s22, s19, 27648
    s_mul_i32 s19, s18, 216
    s_and_b32 s28, s19, 8
    s_sub_u32 s19, s19, s28
    s_add_u32 s22, s22, s19
    s_mul_i32 s20, s16, 4224
    s_waitcnt lgkmcnt(0)
    s_add_u32 m0, s30, 0
    s_nop 0
    buffer_load_dwordx4 v228, s[4:7], s27 offen offset:0 lds
    buffer_load_dwordx4 v229, s[4:7], s27 offen offset:1024 lds
    s_mul_i32 s21, s27, 1728
    buffer_load_dwordx4 v230, s[4:7], s27 offen offset:2048 lds
    s_add_u32 s21, s21, s22
    buffer_load_dwordx4 v231, s[4:7], s27 offen offset:3072 lds
    s_add_u32 m0, s20, 0
    s_nop 0
    buffer_load_dwordx4 v232, s[8:11], s21 offen offset:0 lds
    s_add_u32 s27, s27, 128
    buffer_load_dwordx4 v233, s[8:11], s21 offen offset:1056 lds
    s_cmp_eq_u32 s27, 1152
    buffer_load_dwordx4 v234, s[8:11], s21 offen offset:2112 lds
    s_cselect_b32 s27, 0, s27
    buffer_load_dwordx4 v235, s[8:11], s21 offen offset:3168 lds
    v_lshrrev_b32 v212, 1, v209
    v_xor_b32 v212, v212, v210
    v_lshl_add_u32 v212, v209, 3, v212
    v_lshl_add_u32 v224, v212, 4, s30
    v_xor_b32 v225, 64, v224
    v_bfe_u32 v212, v208, 2, 3
    v_mul_u32_u24 v212, 1056, v212
    v_lshl_add_u32 v212, v178, 9, v212
    v_add_u32 v212, s28, v212
    v_and_b32 v213, 3, v208
    v_lshlrev_b32 v213, 3, v213
    s_mov_b32 s24, 942149632
    s_mov_b32 s25, 2964351008
    v_bfe_u32 v214, s24, v213, 8
    v_bfe_u32 v211, s25, v213, 8
    v_add_u32 v214, v212, v214
    v_add_u32 v211, v212, v211
    v_mov_b32 v220, 0x3f803f80
    v_mov_b32 v221, 0x3f803f80
    v_mov_b32 v222, 0x3f803f80
    v_mov_b32 v223, 0x3f803f80
    s_add_u32 m0, s30, 16384
    s_nop 0
    buffer_load_dwordx4 v228, s[4:7], s27 offen offset:0 lds
    buffer_load_dwordx4 v229, s[4:7], s27 offen offset:1024 lds
    s_mul_i32 s21, s27, 1728
    buffer_load_dwordx4 v230, s[4:7], s27 offen offset:2048 lds
    s_add_u32 s21, s21, s22
    buffer_load_dwordx4 v231, s[4:7], s27 offen offset:3072 lds
    s_add_u32 m0, s20, 16896
    s_nop 0
    buffer_load_dwordx4 v232, s[8:11], s21 offen offset:0 lds
    s_add_u32 s27, s27, 128
    buffer_load_dwordx4 v233, s[8:11], s21 offen offset:1056 lds
    s_cmp_eq_u32 s27, 1152
    buffer_load_dwordx4 v234, s[8:11], s21 offen offset:2112 lds
    s_cselect_b32 s27, 0, s27
    buffer_load_dwordx4 v235, s[8:11], s21 offen offset:3168 lds
    s_mul_i32 s32, s18, 3
    v_min_u32 v182, 2, v210
    v_add_u32 v182, s32, v182
    v_lshlrev_b32 v212, 4, v209
    v_lshl_add_u32 v172, v179, 9, v212
    v_lshrrev_b32 v212, 2, v209
    v_mul_u32_u24 v212, 160, v212
    v_add_u32 v212, 1152, v212
    v_and_b32 v175, 3, v209
    v_lshl_add_u32 v173, v175, 4, v212
    v_lshl_add_u32 v173, v179, 6, v173
    s_lshl_b32 s33, s23, 10
    s_mul_i32 s34, s23, 2432
    s_add_u32 s34, s34, 2359296
    s_mov_b32 s29, 155648
    s_add_u32 s24, s16, 0
    s_cmp_ge_u32 s24, 3
    s_cselect_b32 s25, 3, 0
    s_sub_u32 s24, s24, s25
    s_lshl_b32 s45, s24, 7
    s_mul_i32 s25, s24, 72
    v_add_u32 v216, s25, v214
    s_add_u32 s24, s24, s32
    s_and_b32 s25, s24, 15
    s_cmp_lt_u32 s24, 16
    s_cselect_b32 s35, 0x10000, s29
    s_cselect_b32 s36, s33, s34
    s_cselect_b32 s42, 0x3eae1a93, 1.0
    s_mul_i32 s25, s25, s35
    s_lshl1_add_u32 s36, s25, s36
    s_cmp_lt_u32 s24, 32
    s_cselect_b64 vcc, -1, 0
    s_cselect_b32 s25, 0, 384
    s_add_u32 s37, s36, s25
    v_cndmask_b32 v188, v173, v172, vcc
    v_mad_u32_u24 v188, v178, s35, v188
    s_add_u32 s24, s16, 1
    s_cmp_ge_u32 s24, 3
    s_cselect_b32 s25, 3, 0
    s_sub_u32 s24, s24, s25
    s_lshl_b32 s46, s24, 7
    s_mul_i32 s25, s24, 72
    v_add_u32 v217, s25, v214
    s_add_u32 s24, s24, s32
    s_and_b32 s25, s24, 15
    s_cmp_lt_u32 s24, 16
    s_cselect_b32 s35, 0x10000, s29
    s_cselect_b32 s38, s33, s34
    s_cselect_b32 s43, 0x3eae1a93, 1.0
    s_mul_i32 s25, s25, s35
    s_lshl1_add_u32 s38, s25, s38
    s_cmp_lt_u32 s24, 32
    s_cselect_b64 vcc, -1, 0
    s_cselect_b32 s25, 0, 384
    s_add_u32 s39, s38, s25
    v_cndmask_b32 v189, v173, v172, vcc
    v_mad_u32_u24 v189, v178, s35, v189
    s_add_u32 s24, s16, 2
    s_cmp_ge_u32 s24, 3
    s_cselect_b32 s25, 3, 0
    s_sub_u32 s24, s24, s25
    s_lshl_b32 s47, s24, 7
    s_mul_i32 s25, s24, 72
    v_add_u32 v218, s25, v214
    s_add_u32 s24, s24, s32
    s_and_b32 s25, s24, 15
    s_cmp_lt_u32 s24, 16
    s_cselect_b32 s35, 0x10000, s29
    s_cselect_b32 s40, s33, s34
    s_cselect_b32 s44, 0x3eae1a93, 1.0
    s_mul_i32 s25, s25, s35
    s_lshl1_add_u32 s40, s25, s40
    s_cmp_lt_u32 s24, 32
    s_cselect_b64 vcc, -1, 0
    s_cselect_b32 s25, 0, 384
    s_add_u32 s41, s40, s25
    v_cndmask_b32 v190, v173, v172, vcc
    v_mad_u32_u24 v190, v178, s35, v190
    v_lshl_add_u32 v174, v175, 3, v212
    v_add_u32 v174, 128, v174
    v_lshlrev_b32 v212, 2, v209
    v_add_u32 v214, 1024, v212
    v_cmp_gt_u32 vcc, 32, v182
    s_nop 1
    v_cndmask_b32 v174, v174, v214, vcc
    v_mov_b32 v180, 640
    v_cndmask_b32 v180, v180, 64, vcc
    v_cndmask_b32 v176, 4, 2.0, vcc
    v_add_u32 v174, s34, v174
    s_lshl_b32 s25, s23, 7
    s_add_u32 s24, s25, 2097152
    v_add_u32 v212, s24, v212
    v_cmp_gt_u32 vcc, 16, v182
    s_nop 1
    v_cndmask_b32 v174, v174, v212, vcc
    v_mov_b32 v181, s29
    v_mov_b32 v212, 8192
    v_cndmask_b32 v181, v181, v212, vcc
    v_mov_b32 v212, 0x3eae1a93
    v_cndmask_b32 v172, 1.0, v212, vcc
    v_and_b32 v182, 15, v182
    v_lshlrev_b32 v182, 1, v182
    v_mad_u32_u24 v174, v182, v181, v174
    v_add_u32 v175, v174, v181
    v_add_u32 v177, v175, v176
    v_add_u32 v176, v174, v176
    v_add_u32 v182, v174, v180
    v_add_u32 v181, v175, v180
    v_lshlrev_b32 v185, 4, v210
    v_add_u32 v185, 50688, v185
    v_add_u32 v184, s45, v185
    v_add_u32 v173, s46, v185
    v_add_u32 v185, s47, v185
    v_lshlrev_b32 v183, 2, v210
    v_sub_u32 v183, v209, v183
    v_cmp_eq_u32 s[48:49], 0, v183
    v_cmp_eq_u32 s[50:51], 1, v183
    v_cmp_eq_u32 s[52:53], 2, v183
    v_cmp_eq_u32 s[54:55], 3, v183
    s_waitcnt vmcnt(8)
    s_barrier
    ds_read_b128 v[64:67], v224 offset:0
    ds_read_b128 v[68:71], v224 offset:2048
    ds_read_b64_tr_b16 a[0:1], v216 offset:0
    ds_read_b64_tr_b16 a[2:3], v216 offset:256
    ds_read_b64_tr_b16 a[4:5], v216 offset:8
    ds_read_b64_tr_b16 a[6:7], v216 offset:264
    ds_read_b64_tr_b16 a[8:9], v217 offset:0
    ds_read_b64_tr_b16 a[10:11], v217 offset:256
    ds_read_b64_tr_b16 a[12:13], v217 offset:8
    ds_read_b64_tr_b16 a[14:15], v217 offset:264
    ds_read_b64_tr_b16 a[16:17], v218 offset:0
    ds_read_b64_tr_b16 a[18:19], v218 offset:256
    ds_read_b64_tr_b16 a[20:21], v218 offset:8
    ds_read_b64_tr_b16 a[22:23], v218 offset:264
    ds_read_b64_tr_b16 a[24:25], v211 offset:0
    ds_read_b64_tr_b16 a[26:27], v211 offset:256
    s_waitcnt lgkmcnt(12)
    v_mfma_f32_16x16x32_bf16 v[8:11], a[0:3], v[64:67], 0
    ds_read_b128 v[72:75], v225 offset:0
    v_mfma_f32_16x16x32_bf16 v[12:15], a[0:3], v[68:71], 0
    ds_read_b128 v[76:79], v225 offset:2048
    v_mfma_f32_16x16x32_bf16 v[160:163], a[0:3], v[220:223], 0
    s_add_u32 m0, s30, 32768
    s_nop 0
    buffer_load_dwordx4 v228, s[4:7], s27 offen offset:0 lds
    s_waitcnt lgkmcnt(12)
    v_mfma_f32_16x16x32_bf16 v[16:19], a[4:7], v[64:67], 0
    ds_read_b64_tr_b16 a[0:1], v216 offset:8448
    v_mfma_f32_16x16x32_bf16 v[20:23], a[4:7], v[68:71], 0
    ds_read_b64_tr_b16 a[2:3], v216 offset:8704
    v_mfma_f32_16x16x32_bf16 v[164:167], a[4:7], v[220:223], 0
    s_waitcnt lgkmcnt(12)
    v_mfma_f32_16x16x32_bf16 v[24:27], a[8:11], v[64:67], 0
    ds_read_b64_tr_b16 a[4:5], v216 offset:8456
    v_mfma_f32_16x16x32_bf16 v[28:31], a[8:11], v[68:71], 0
    buffer_load_dwordx4 v229, s[4:7], s27 offen offset:1024 lds
    s_mul_i32 s21, s27, 1728
    s_waitcnt lgkmcnt(11)
    v_mfma_f32_16x16x32_bf16 v[32:35], a[12:15], v[64:67], 0
    ds_read_b64_tr_b16 a[6:7], v216 offset:8712
    v_mfma_f32_16x16x32_bf16 v[36:39], a[12:15], v[68:71], 0
    ds_read_b64_tr_b16 a[8:9], v217 offset:8448
    v_mfma_f32_16x16x32_bf16 v[144:147], v[220:223], v[64:67], 0
    ds_read_b64_tr_b16 a[10:11], v217 offset:8704
    v_mfma_f32_16x16x32_bf16 v[152:155], v[64:67], v[64:67], 0
    ds_read_b64_tr_b16 a[12:13], v217 offset:8456
    s_waitcnt lgkmcnt(13)
    v_mfma_f32_16x16x32_bf16 v[40:43], a[16:19], v[64:67], 0
    buffer_load_dwordx4 v230, s[4:7], s27 offen offset:2048 lds
    s_add_u32 s21, s21, s22
    v_mfma_f32_16x16x32_bf16 v[44:47], a[16:19], v[68:71], 0
    ds_read_b64_tr_b16 a[14:15], v217 offset:8712
    s_waitcnt lgkmcnt(12)
    v_mfma_f32_16x16x32_bf16 v[48:51], a[20:23], v[64:67], 0
    ds_read_b64_tr_b16 a[16:17], v218 offset:8448
    v_mfma_f32_16x16x32_bf16 v[52:55], a[20:23], v[68:71], 0
    ds_read_b64_tr_b16 a[18:19], v218 offset:8704
    s_waitcnt lgkmcnt(12)
    v_mfma_f32_16x16x32_bf16 v[56:59], a[24:27], v[64:67], 0
    ds_read_b64_tr_b16 a[20:21], v218 offset:8456
    v_mfma_f32_16x16x32_bf16 v[60:63], a[24:27], v[68:71], 0
    buffer_load_dwordx4 v231, s[4:7], s27 offen offset:3072 lds
    s_add_u32 m0, s20, 33792
    v_mfma_f32_16x16x32_bf16 v[168:171], a[24:27], v[220:223], 0
    ds_read_b64_tr_b16 a[22:23], v218 offset:8712
    v_mfma_f32_16x16x32_bf16 v[148:151], v[220:223], v[68:71], 0
    ds_read_b64_tr_b16 a[24:25], v211 offset:8448
    v_mfma_f32_16x16x32_bf16 v[156:159], v[68:71], v[68:71], 0
    ds_read_b64_tr_b16 a[26:27], v211 offset:8704
    s_waitcnt lgkmcnt(12)
    v_mfma_f32_16x16x32_bf16 v[8:11], a[0:3], v[72:75], v[8:11]
    s_waitcnt vmcnt(4)
    s_barrier
    ds_read_b128 v[64:67], v224 offset:16384
    v_mfma_f32_16x16x32_bf16 v[12:15], a[0:3], v[76:79], v[12:15]
    ds_read_b128 v[68:71], v224 offset:18432
    v_mfma_f32_16x16x32_bf16 v[160:163], a[0:3], v[220:223], v[160:163]
    buffer_load_dwordx4 v232, s[8:11], s21 offen offset:0 lds
    s_add_u32 s27, s27, 128
    s_waitcnt lgkmcnt(12)
    v_mfma_f32_16x16x32_bf16 v[16:19], a[4:7], v[72:75], v[16:19]
    ds_read_b64_tr_b16 a[0:1], v216 offset:16896
    v_mfma_f32_16x16x32_bf16 v[20:23], a[4:7], v[76:79], v[20:23]
    ds_read_b64_tr_b16 a[2:3], v216 offset:17152
    v_mfma_f32_16x16x32_bf16 v[164:167], a[4:7], v[220:223], v[164:167]
    s_waitcnt lgkmcnt(12)
    v_mfma_f32_16x16x32_bf16 v[24:27], a[8:11], v[72:75], v[24:27]
    ds_read_b64_tr_b16 a[4:5], v216 offset:16904
    v_mfma_f32_16x16x32_bf16 v[28:31], a[8:11], v[76:79], v[28:31]
    buffer_load_dwordx4 v233, s[8:11], s21 offen offset:1056 lds
    s_cmp_eq_u32 s27, 1152
    s_waitcnt lgkmcnt(11)
    v_mfma_f32_16x16x32_bf16 v[32:35], a[12:15], v[72:75], v[32:35]
    ds_read_b64_tr_b16 a[6:7], v216 offset:17160
    v_mfma_f32_16x16x32_bf16 v[36:39], a[12:15], v[76:79], v[36:39]
    ds_read_b64_tr_b16 a[8:9], v217 offset:16896
    v_mfma_f32_16x16x32_bf16 v[144:147], v[220:223], v[72:75], v[144:147]
    ds_read_b64_tr_b16 a[10:11], v217 offset:17152
    v_mfma_f32_16x16x32_bf16 v[152:155], v[72:75], v[72:75], v[152:155]
    ds_read_b64_tr_b16 a[12:13], v217 offset:16904
    s_waitcnt lgkmcnt(13)
    v_mfma_f32_16x16x32_bf16 v[40:43], a[16:19], v[72:75], v[40:43]
    buffer_load_dwordx4 v234, s[8:11], s21 offen offset:2112 lds
    s_cselect_b32 s27, 0, s27
    v_mfma_f32_16x16x32_bf16 v[44:47], a[16:19], v[76:79], v[44:47]
    ds_read_b64_tr_b16 a[14:15], v217 offset:17160
    s_waitcnt lgkmcnt(12)
    v_mfma_f32_16x16x32_bf16 v[48:51], a[20:23], v[72:75], v[48:51]
    ds_read_b64_tr_b16 a[16:17], v218 offset:16896
    v_mfma_f32_16x16x32_bf16 v[52:55], a[20:23], v[76:79], v[52:55]
    ds_read_b64_tr_b16 a[18:19], v218 offset:17152
    s_waitcnt lgkmcnt(12)
    v_mfma_f32_16x16x32_bf16 v[56:59], a[24:27], v[72:75], v[56:59]
    ds_read_b64_tr_b16 a[20:21], v218 offset:16904
    v_mfma_f32_16x16x32_bf16 v[60:63], a[24:27], v[76:79], v[60:63]
    buffer_load_dwordx4 v235, s[8:11], s21 offen offset:3168 lds
    v_mfma_f32_16x16x32_bf16 v[168:171], a[24:27], v[220:223], v[168:171]
    ds_read_b64_tr_b16 a[22:23], v218 offset:17160
    v_mfma_f32_16x16x32_bf16 v[148:151], v[220:223], v[76:79], v[148:151]
    ds_read_b64_tr_b16 a[24:25], v211 offset:16896
    v_mfma_f32_16x16x32_bf16 v[156:159], v[76:79], v[76:79], v[156:159]
    ds_read_b64_tr_b16 a[26:27], v211 offset:17152
    s_waitcnt lgkmcnt(12)
    v_mfma_f32_16x16x32_bf16 v[8:11], a[0:3], v[64:67], v[8:11]
    ds_read_b128 v[72:75], v225 offset:16384
    v_mfma_f32_16x16x32_bf16 v[12:15], a[0:3], v[68:71], v[12:15]
    ds_read_b128 v[76:79], v225 offset:18432
    v_mfma_f32_16x16x32_bf16 v[160:163], a[0:3], v[220:223], v[160:163]
    s_add_u32 m0, s30, 0
    s_nop 0
    buffer_load_dwordx4 v228, s[4:7], s27 offen offset:0 lds
    s_waitcnt lgkmcnt(12)
    v_mfma_f32_16x16x32_bf16 v[16:19], a[4:7], v[64:67], v[16:19]
    ds_read_b64_tr_b16 a[0:1], v216 offset:25344
    v_mfma_f32_16x16x32_bf16 v[20:23], a[4:7], v[68:71], v[20:23]
    ds_read_b64_tr_b16 a[2:3], v216 offset:25600
    v_mfma_f32_16x16x32_bf16 v[164:167], a[4:7], v[220:223], v[164:167]
    s_waitcnt lgkmcnt(12)
    v_mfma_f32_16x16x32_bf16 v[24:27], a[8:11], v[64:67], v[24:27]
    ds_read_b64_tr_b16 a[4:5], v216 offset:25352
    v_mfma_f32_16x16x32_bf16 v[28:31], a[8:11], v[68:71], v[28:31]
    buffer_load_dwordx4 v229, s[4:7], s27 offen offset:1024 lds
    s_mul_i32 s21, s27, 1728
    s_waitcnt lgkmcnt(11)
    v_mfma_f32_16x16x32_bf16 v[32:35], a[12:15], v[64:67], v[32:35]
    ds_read_b64_tr_b16 a[6:7], v216 offset:25608
    v_mfma_f32_16x16x32_bf16 v[36:39], a[12:15], v[68:71], v[36:39]
    ds_read_b64_tr_b16 a[8:9], v217 offset:25344
    v_mfma_f32_16x16x32_bf16 v[144:147], v[220:223], v[64:67], v[144:147]
    ds_read_b64_tr_b16 a[10:11], v217 offset:25600
    v_mfma_f32_16x16x32_bf16 v[152:155], v[64:67], v[64:67], v[152:155]
    ds_read_b64_tr_b16 a[12:13], v217 offset:25352
    s_waitcnt lgkmcnt(13)
    v_mfma_f32_16x16x32_bf16 v[40:43], a[16:19], v[64:67], v[40:43]
    buffer_load_dwordx4 v230, s[4:7], s27 offen offset:2048 lds
    s_add_u32 s21, s21, s22
    v_mfma_f32_16x16x32_bf16 v[44:47], a[16:19], v[68:71], v[44:47]
    ds_read_b64_tr_b16 a[14:15], v217 offset:25608
    s_waitcnt lgkmcnt(12)
    v_mfma_f32_16x16x32_bf16 v[48:51], a[20:23], v[64:67], v[48:51]
    ds_read_b64_tr_b16 a[16:17], v218 offset:25344
    v_mfma_f32_16x16x32_bf16 v[52:55], a[20:23], v[68:71], v[52:55]
    ds_read_b64_tr_b16 a[18:19], v218 offset:25600
    s_waitcnt lgkmcnt(12)
    v_mfma_f32_16x16x32_bf16 v[56:59], a[24:27], v[64:67], v[56:59]
    ds_read_b64_tr_b16 a[20:21], v218 offset:25352
    v_mfma_f32_16x16x32_bf16 v[60:63], a[24:27], v[68:71], v[60:63]
    buffer_load_dwordx4 v231, s[4:7], s27 offen offset:3072 lds
    s_add_u32 m0, s20, 0
    v_mfma_f32_16x16x32_bf16 v[168:171], a[24:27], v[220:223], v[168:171]
    ds_read_b64_tr_b16 a[22:23], v218 offset:25608
    v_mfma_f32_16x16x32_bf16 v[148:151], v[220:223], v[68:71], v[148:151]
    ds_read_b64_tr_b16 a[24:25], v211 offset:25344
    v_mfma_f32_16x16x32_bf16 v[156:159], v[68:71], v[68:71], v[156:159]
    ds_read_b64_tr_b16 a[26:27], v211 offset:25600
    s_waitcnt lgkmcnt(12)
    v_mfma_f32_16x16x32_bf16 v[8:11], a[0:3], v[72:75], v[8:11]
    s_waitcnt vmcnt(4)
    s_barrier
    ds_read_b128 v[64:67], v224 offset:32768
    v_mfma_f32_16x16x32_bf16 v[12:15], a[0:3], v[76:79], v[12:15]
    ds_read_b128 v[68:71], v224 offset:34816
    v_mfma_f32_16x16x32_bf16 v[160:163], a[0:3], v[220:223], v[160:163]
    buffer_load_dwordx4 v232, s[8:11], s21 offen offset:0 lds
    s_add_u32 s27, s27, 128
    s_waitcnt lgkmcnt(12)
    v_mfma_f32_16x16x32_bf16 v[16:19], a[4:7], v[72:75], v[16:19]
    ds_read_b64_tr_b16 a[0:1], v216 offset:33792
    v_mfma_f32_16x16x32_bf16 v[20:23], a[4:7], v[76:79], v[20:23]
    ds_read_b64_tr_b16 a[2:3], v216 offset:34048
    v_mfma_f32_16x16x32_bf16 v[164:167], a[4:7], v[220:223], v[164:167]
    s_waitcnt lgkmcnt(12)
    v_mfma_f32_16x16x32_bf16 v[24:27], a[8:11], v[72:75], v[24:27]
    ds_read_b64_tr_b16 a[4:5], v216 offset:33800
    v_mfma_f32_16x16x32_bf16 v[28:31], a[8:11], v[76:79], v[28:31]
    buffer_load_dwordx4 v233, s[8:11], s21 offen offset:1056 lds
    s_cmp_eq_u32 s27, 1152
    s_waitcnt lgkmcnt(11)
    v_mfma_f32_16x16x32_bf16 v[32:35], a[12:15], v[72:75], v[32:35]
    ds_read_b64_tr_b16 a[6:7], v216 offset:34056
    v_mfma_f32_16x16x32_bf16 v[36:39], a[12:15], v[76:79], v[36:39]
    ds_read_b64_tr_b16 a[8:9], v217 offset:33792
    v_mfma_f32_16x16x32_bf16 v[144:147], v[220:223], v[72:75], v[144:147]
    ds_read_b64_tr_b16 a[10:11], v217 offset:34048
    v_mfma_f32_16x16x32_bf16 v[152:155], v[72:75], v[72:75], v[152:155]
    ds_read_b64_tr_b16 a[12:13], v217 offset:33800
    s_waitcnt lgkmcnt(13)
    v_mfma_f32_16x16x32_bf16 v[40:43], a[16:19], v[72:75], v[40:43]
    buffer_load_dwordx4 v234, s[8:11], s21 offen offset:2112 lds
    s_cselect_b32 s27, 0, s27
    v_mfma_f32_16x16x32_bf16 v[44:47], a[16:19], v[76:79], v[44:47]
    ds_read_b64_tr_b16 a[14:15], v217 offset:34056
    s_waitcnt lgkmcnt(12)
    v_mfma_f32_16x16x32_bf16 v[48:51], a[20:23], v[72:75], v[48:51]
    ds_read_b64_tr_b16 a[16:17], v218 offset:33792
    v_mfma_f32_16x16x32_bf16 v[52:55], a[20:23], v[76:79], v[52:55]
    ds_read_b64_tr_b16 a[18:19], v218 offset:34048
    s_waitcnt lgkmcnt(12)
    v_mfma_f32_16x16x32_bf16 v[56:59], a[24:27], v[72:75], v[56:59]
    ds_read_b64_tr_b16 a[20:21], v218 offset:33800
    v_mfma_f32_16x16x32_bf16 v[60:63], a[24:27], v[76:79], v[60:63]
    buffer_load_dwordx4 v235, s[8:11], s21 offen offset:3168 lds
    v_mfma_f32_16x16x32_bf16 v[168:171], a[24:27], v[220:223], v[168:171]
    ds_read_b64_tr_b16 a[22:23], v218 offset:34056
    v_mfma_f32_16x16x32_bf16 v[148:151], v[220:223], v[76:79], v[148:151]
    ds_read_b64_tr_b16 a[24:25], v211 offset:33792
    v_mfma_f32_16x16x32_bf16 v[156:159], v[76:79], v[76:79], v[156:159]
    ds_read_b64_tr_b16 a[26:27], v211 offset:34048
    s_waitcnt lgkmcnt(12)
    v_mfma_f32_16x16x32_bf16 v[8:11], a[0:3], v[64:67], v[8:11]
    ds_read_b128 v[72:75], v225 offset:32768
    v_mfma_f32_16x16x32_bf16 v[12:15], a[0:3], v[68:71], v[12:15]
    ds_read_b128 v[76:79], v225 offset:34816
    v_mfma_f32_16x16x32_bf16 v[160:163], a[0:3], v[220:223], v[160:163]
    s_add_u32 m0, s30, 16384
    s_nop 0
    buffer_load_dwordx4 v228, s[4:7], s27 offen offset:0 lds
    s_waitcnt lgkmcnt(12)
    v_mfma_f32_16x16x32_bf16 v[16:19], a[4:7], v[64:67], v[16:19]
    ds_read_b64_tr_b16 a[0:1], v216 offset:42240
    v_mfma_f32_16x16x32_bf16 v[20:23], a[4:7], v[68:71], v[20:23]
    ds_read_b64_tr_b16 a[2:3], v216 offset:42496
    v_mfma_f32_16x16x32_bf16 v[164:167], a[4:7], v[220:223], v[164:167]
    s_waitcnt lgkmcnt(12)
    v_mfma_f32_16x16x32_bf16 v[24:27], a[8:11], v[64:67], v[24:27]
    ds_read_b64_tr_b16 a[4:5], v216 offset:42248
    v_mfma_f32_16x16x32_bf16 v[28:31], a[8:11], v[68:71], v[28:31]
    buffer_load_dwordx4 v229, s[4:7], s27 offen offset:1024 lds
    s_mul_i32 s21, s27, 1728
    s_waitcnt lgkmcnt(11)
    v_mfma_f32_16x16x32_bf16 v[32:35], a[12:15], v[64:67], v[32:35]
    ds_read_b64_tr_b16 a[6:7], v216 offset:42504
    v_mfma_f32_16x16x32_bf16 v[36:39], a[12:15], v[68:71], v[36:39]
    ds_read_b64_tr_b16 a[8:9], v217 offset:42240
    v_mfma_f32_16x16x32_bf16 v[144:147], v[220:223], v[64:67], v[144:147]
    ds_read_b64_tr_b16 a[10:11], v217 offset:42496
    v_mfma_f32_16x16x32_bf16 v[152:155], v[64:67], v[64:67], v[152:155]
    ds_read_b64_tr_b16 a[12:13], v217 offset:42248
    s_waitcnt lgkmcnt(13)
    v_mfma_f32_16x16x32_bf16 v[40:43], a[16:19], v[64:67], v[40:43]
    buffer_load_dwordx4 v230, s[4:7], s27 offen offset:2048 lds
    s_add_u32 s21, s21, s22
    v_mfma_f32_16x16x32_bf16 v[44:47], a[16:19], v[68:71], v[44:47]
    ds_read_b64_tr_b16 a[14:15], v217 offset:42504
    s_waitcnt lgkmcnt(12)
    v_mfma_f32_16x16x32_bf16 v[48:51], a[20:23], v[64:67], v[48:51]
    ds_read_b64_tr_b16 a[16:17], v218 offset:42240
    v_mfma_f32_16x16x32_bf16 v[52:55], a[20:23], v[68:71], v[52:55]
    ds_read_b64_tr_b16 a[18:19], v218 offset:42496
    s_waitcnt lgkmcnt(12)
    v_mfma_f32_16x16x32_bf16 v[56:59], a[24:27], v[64:67], v[56:59]
    ds_read_b64_tr_b16 a[20:21], v218 offset:42248
    v_mfma_f32_16x16x32_bf16 v[60:63], a[24:27], v[68:71], v[60:63]
    buffer_load_dwordx4 v231, s[4:7], s27 offen offset:3072 lds
    s_add_u32 m0, s20, 16896
    v_mfma_f32_16x16x32_bf16 v[168:171], a[24:27], v[220:223], v[168:171]
    ds_read_b64_tr_b16 a[22:23], v218 offset:42504
    v_mfma_f32_16x16x32_bf16 v[148:151], v[220:223], v[68:71], v[148:151]
    ds_read_b64_tr_b16 a[24:25], v211 offset:42240
    v_mfma_f32_16x16x32_bf16 v[156:159], v[68:71], v[68:71], v[156:159]
    ds_read_b64_tr_b16 a[26:27], v211 offset:42496
    s_waitcnt lgkmcnt(12)
    v_mfma_f32_16x16x32_bf16 v[8:11], a[0:3], v[72:75], v[8:11]
    s_waitcnt vmcnt(4)
    s_barrier
    ds_read_b128 v[64:67], v224 offset:0
    v_mfma_f32_16x16x32_bf16 v[12:15], a[0:3], v[76:79], v[12:15]
    ds_read_b128 v[68:71], v224 offset:2048
    v_mfma_f32_16x16x32_bf16 v[160:163], a[0:3], v[220:223], v[160:163]
    buffer_load_dwordx4 v232, s[8:11], s21 offen offset:0 lds
    s_add_u32 s27, s27, 128
    s_waitcnt lgkmcnt(12)
    v_mfma_f32_16x16x32_bf16 v[16:19], a[4:7], v[72:75], v[16:19]
    ds_read_b64_tr_b16 a[0:1], v216 offset:0
    v_mfma_f32_16x16x32_bf16 v[20:23], a[4:7], v[76:79], v[20:23]
    ds_read_b64_tr_b16 a[2:3], v216 offset:256
    v_mfma_f32_16x16x32_bf16 v[164:167], a[4:7], v[220:223], v[164:167]
    s_waitcnt lgkmcnt(12)
    v_mfma_f32_16x16x32_bf16 v[24:27], a[8:11], v[72:75], v[24:27]
    ds_read_b64_tr_b16 a[4:5], v216 offset:8
    v_mfma_f32_16x16x32_bf16 v[28:31], a[8:11], v[76:79], v[28:31]
    buffer_load_dwordx4 v233, s[8:11], s21 offen offset:1056 lds
    s_cmp_eq_u32 s27, 1152
    s_waitcnt lgkmcnt(11)
    v_mfma_f32_16x16x32_bf16 v[32:35], a[12:15], v[72:75], v[32:35]
    ds_read_b64_tr_b16 a[6:7], v216 offset:264
    v_mfma_f32_16x16x32_bf16 v[36:39], a[12:15], v[76:79], v[36:39]
    ds_read_b64_tr_b16 a[8:9], v217 offset:0
    v_mfma_f32_16x16x32_bf16 v[144:147], v[220:223], v[72:75], v[144:147]
    ds_read_b64_tr_b16 a[10:11], v217 offset:256
    v_mfma_f32_16x16x32_bf16 v[152:155], v[72:75], v[72:75], v[152:155]
    ds_read_b64_tr_b16 a[12:13], v217 offset:8
    s_waitcnt lgkmcnt(13)
    v_mfma_f32_16x16x32_bf16 v[40:43], a[16:19], v[72:75], v[40:43]
    buffer_load_dwordx4 v234, s[8:11], s21 offen offset:2112 lds
    s_cselect_b32 s27, 0, s27
    v_mfma_f32_16x16x32_bf16 v[44:47], a[16:19], v[76:79], v[44:47]
    ds_read_b64_tr_b16 a[14:15], v217 offset:264
    s_waitcnt lgkmcnt(12)
    v_mfma_f32_16x16x32_bf16 v[48:51], a[20:23], v[72:75], v[48:51]
    ds_read_b64_tr_b16 a[16:17], v218 offset:0
    v_mfma_f32_16x16x32_bf16 v[52:55], a[20:23], v[76:79], v[52:55]
    ds_read_b64_tr_b16 a[18:19], v218 offset:256
    s_waitcnt lgkmcnt(12)
    v_mfma_f32_16x16x32_bf16 v[56:59], a[24:27], v[72:75], v[56:59]
    ds_read_b64_tr_b16 a[20:21], v218 offset:8
    v_mfma_f32_16x16x32_bf16 v[60:63], a[24:27], v[76:79], v[60:63]
    buffer_load_dwordx4 v235, s[8:11], s21 offen offset:3168 lds
    v_mfma_f32_16x16x32_bf16 v[168:171], a[24:27], v[220:223], v[168:171]
    ds_read_b64_tr_b16 a[22:23], v218 offset:264
    v_mfma_f32_16x16x32_bf16 v[148:151], v[220:223], v[76:79], v[148:151]
    ds_read_b64_tr_b16 a[24:25], v211 offset:0
    v_mfma_f32_16x16x32_bf16 v[156:159], v[76:79], v[76:79], v[156:159]
    ds_read_b64_tr_b16 a[26:27], v211 offset:256
    s_waitcnt lgkmcnt(12)
    v_mfma_f32_16x16x32_bf16 v[8:11], a[0:3], v[64:67], v[8:11]
    ds_read_b128 v[72:75], v225 offset:0
    v_mfma_f32_16x16x32_bf16 v[12:15], a[0:3], v[68:71], v[12:15]
    ds_read_b128 v[76:79], v225 offset:2048
    v_mfma_f32_16x16x32_bf16 v[160:163], a[0:3], v[220:223], v[160:163]
    s_add_u32 m0, s30, 32768
    s_nop 0
    buffer_load_dwordx4 v228, s[4:7], s27 offen offset:0 lds
    s_waitcnt lgkmcnt(12)
    v_mfma_f32_16x16x32_bf16 v[16:19], a[4:7], v[64:67], v[16:19]
    ds_read_b64_tr_b16 a[0:1], v216 offset:8448
    v_mfma_f32_16x16x32_bf16 v[20:23], a[4:7], v[68:71], v[20:23]
    ds_read_b64_tr_b16 a[2:3], v216 offset:8704
    v_mfma_f32_16x16x32_bf16 v[164:167], a[4:7], v[220:223], v[164:167]
    s_waitcnt lgkmcnt(12)
    v_mfma_f32_16x16x32_bf16 v[24:27], a[8:11], v[64:67], v[24:27]
    ds_read_b64_tr_b16 a[4:5], v216 offset:8456
    v_mfma_f32_16x16x32_bf16 v[28:31], a[8:11], v[68:71], v[28:31]
    buffer_load_dwordx4 v229, s[4:7], s27 offen offset:1024 lds
    s_mul_i32 s21, s27, 1728
    s_waitcnt lgkmcnt(11)
    v_mfma_f32_16x16x32_bf16 v[32:35], a[12:15], v[64:67], v[32:35]
    ds_read_b64_tr_b16 a[6:7], v216 offset:8712
    v_mfma_f32_16x16x32_bf16 v[36:39], a[12:15], v[68:71], v[36:39]
    ds_read_b64_tr_b16 a[8:9], v217 offset:8448
    v_mfma_f32_16x16x32_bf16 v[144:147], v[220:223], v[64:67], v[144:147]
    ds_read_b64_tr_b16 a[10:11], v217 offset:8704
    v_mfma_f32_16x16x32_bf16 v[152:155], v[64:67], v[64:67], v[152:155]
    ds_read_b64_tr_b16 a[12:13], v217 offset:8456
    s_waitcnt lgkmcnt(13)
    v_mfma_f32_16x16x32_bf16 v[40:43], a[16:19], v[64:67], v[40:43]
    buffer_load_dwordx4 v230, s[4:7], s27 offen offset:2048 lds
    s_add_u32 s21, s21, s22
    v_mfma_f32_16x16x32_bf16 v[44:47], a[16:19], v[68:71], v[44:47]
    ds_read_b64_tr_b16 a[14:15], v217 offset:8712
    s_waitcnt lgkmcnt(12)
    v_mfma_f32_16x16x32_bf16 v[48:51], a[20:23], v[64:67], v[48:51]
    ds_read_b64_tr_b16 a[16:17], v218 offset:8448
    v_mfma_f32_16x16x32_bf16 v[52:55], a[20:23], v[68:71], v[52:55]
    ds_read_b64_tr_b16 a[18:19], v218 offset:8704
    s_waitcnt lgkmcnt(12)
    v_mfma_f32_16x16x32_bf16 v[56:59], a[24:27], v[64:67], v[56:59]
    ds_read_b64_tr_b16 a[20:21], v218 offset:8456
    v_mfma_f32_16x16x32_bf16 v[60:63], a[24:27], v[68:71], v[60:63]
    buffer_load_dwordx4 v231, s[4:7], s27 offen offset:3072 lds
    s_add_u32 m0, s20, 33792
    v_mfma_f32_16x16x32_bf16 v[168:171], a[24:27], v[220:223], v[168:171]
    ds_read_b64_tr_b16 a[22:23], v218 offset:8712
    v_mfma_f32_16x16x32_bf16 v[148:151], v[220:223], v[68:71], v[148:151]
    ds_read_b64_tr_b16 a[24:25], v211 offset:8448
    v_mfma_f32_16x16x32_bf16 v[156:159], v[68:71], v[68:71], v[156:159]
    ds_read_b64_tr_b16 a[26:27], v211 offset:8704
    s_waitcnt lgkmcnt(12)
    v_mfma_f32_16x16x32_bf16 v[8:11], a[0:3], v[72:75], v[8:11]
    s_waitcnt vmcnt(4)
    s_barrier
    ds_read_b128 v[64:67], v224 offset:16384
    v_mfma_f32_16x16x32_bf16 v[12:15], a[0:3], v[76:79], v[12:15]
    ds_read_b128 v[68:71], v224 offset:18432
    v_mfma_f32_16x16x32_bf16 v[160:163], a[0:3], v[220:223], v[160:163]
    buffer_load_dwordx4 v232, s[8:11], s21 offen offset:0 lds
    s_add_u32 s27, s27, 128
    s_waitcnt lgkmcnt(12)
    v_mfma_f32_16x16x32_bf16 v[16:19], a[4:7], v[72:75], v[16:19]
    ds_read_b64_tr_b16 a[0:1], v216 offset:16896
    v_mfma_f32_16x16x32_bf16 v[20:23], a[4:7], v[76:79], v[20:23]
    ds_read_b64_tr_b16 a[2:3], v216 offset:17152
    v_mfma_f32_16x16x32_bf16 v[164:167], a[4:7], v[220:223], v[164:167]
    s_waitcnt lgkmcnt(12)
    v_mfma_f32_16x16x32_bf16 v[24:27], a[8:11], v[72:75], v[24:27]
    ds_read_b64_tr_b16 a[4:5], v216 offset:16904
    v_mfma_f32_16x16x32_bf16 v[28:31], a[8:11], v[76:79], v[28:31]
    buffer_load_dwordx4 v233, s[8:11], s21 offen offset:1056 lds
    s_cmp_eq_u32 s27, 1152
    s_waitcnt lgkmcnt(11)
    v_mfma_f32_16x16x32_bf16 v[32:35], a[12:15], v[72:75], v[32:35]
    ds_read_b64_tr_b16 a[6:7], v216 offset:17160
    v_mfma_f32_16x16x32_bf16 v[36:39], a[12:15], v[76:79], v[36:39]
    ds_read_b64_tr_b16 a[8:9], v217 offset:16896
    v_mfma_f32_16x16x32_bf16 v[144:147], v[220:223], v[72:75], v[144:147]
    ds_read_b64_tr_b16 a[10:11], v217 offset:17152
    v_mfma_f32_16x16x32_bf16 v[152:155], v[72:75], v[72:75], v[152:155]
    ds_read_b64_tr_b16 a[12:13], v217 offset:16904
    s_waitcnt lgkmcnt(13)
    v_mfma_f32_16x16x32_bf16 v[40:43], a[16:19], v[72:75], v[40:43]
    buffer_load_dwordx4 v234, s[8:11], s21 offen offset:2112 lds
    s_cselect_b32 s27, 0, s27
    v_mfma_f32_16x16x32_bf16 v[44:47], a[16:19], v[76:79], v[44:47]
    ds_read_b64_tr_b16 a[14:15], v217 offset:17160
    s_waitcnt lgkmcnt(12)
    v_mfma_f32_16x16x32_bf16 v[48:51], a[20:23], v[72:75], v[48:51]
    ds_read_b64_tr_b16 a[16:17], v218 offset:16896
    v_mfma_f32_16x16x32_bf16 v[52:55], a[20:23], v[76:79], v[52:55]
    ds_read_b64_tr_b16 a[18:19], v218 offset:17152
    s_waitcnt lgkmcnt(12)
    v_mfma_f32_16x16x32_bf16 v[56:59], a[24:27], v[72:75], v[56:59]
    ds_read_b64_tr_b16 a[20:21], v218 offset:16904
    v_mfma_f32_16x16x32_bf16 v[60:63], a[24:27], v[76:79], v[60:63]
    buffer_load_dwordx4 v235, s[8:11], s21 offen offset:3168 lds
    v_mfma_f32_16x16x32_bf16 v[168:171], a[24:27], v[220:223], v[168:171]
    ds_read_b64_tr_b16 a[22:23], v218 offset:17160
    v_mfma_f32_16x16x32_bf16 v[148:151], v[220:223], v[76:79], v[148:151]
    ds_read_b64_tr_b16 a[24:25], v211 offset:16896
    v_mfma_f32_16x16x32_bf16 v[156:159], v[76:79], v[76:79], v[156:159]
    ds_read_b64_tr_b16 a[26:27], v211 offset:17152
    s_waitcnt lgkmcnt(12)
    v_mfma_f32_16x16x32_bf16 v[8:11], a[0:3], v[64:67], v[8:11]
    ds_read_b128 v[72:75], v225 offset:16384
    v_mfma_f32_16x16x32_bf16 v[12:15], a[0:3], v[68:71], v[12:15]
    ds_read_b128 v[76:79], v225 offset:18432
    v_mfma_f32_16x16x32_bf16 v[160:163], a[0:3], v[220:223], v[160:163]
    s_add_u32 m0, s30, 0
    s_nop 0
    buffer_load_dwordx4 v228, s[4:7], s27 offen offset:0 lds
    s_waitcnt lgkmcnt(12)
    v_mfma_f32_16x16x32_bf16 v[16:19], a[4:7], v[64:67], v[16:19]
    ds_read_b64_tr_b16 a[0:1], v216 offset:25344
    v_mfma_f32_16x16x32_bf16 v[20:23], a[4:7], v[68:71], v[20:23]
    ds_read_b64_tr_b16 a[2:3], v216 offset:25600
    v_mfma_f32_16x16x32_bf16 v[164:167], a[4:7], v[220:223], v[164:167]
    s_waitcnt lgkmcnt(12)
    v_mfma_f32_16x16x32_bf16 v[24:27], a[8:11], v[64:67], v[24:27]
    ds_read_b64_tr_b16 a[4:5], v216 offset:25352
    v_mfma_f32_16x16x32_bf16 v[28:31], a[8:11], v[68:71], v[28:31]
    buffer_load_dwordx4 v229, s[4:7], s27 offen offset:1024 lds
    s_mul_i32 s21, s27, 1728
    s_waitcnt lgkmcnt(11)
    v_mfma_f32_16x16x32_bf16 v[32:35], a[12:15], v[64:67], v[32:35]
    ds_read_b64_tr_b16 a[6:7], v216 offset:25608
    v_mfma_f32_16x16x32_bf16 v[36:39], a[12:15], v[68:71], v[36:39]
    ds_read_b64_tr_b16 a[8:9], v217 offset:25344
    v_mfma_f32_16x16x32_bf16 v[144:147], v[220:223], v[64:67], v[144:147]
    ds_read_b64_tr_b16 a[10:11], v217 offset:25600
    v_mfma_f32_16x16x32_bf16 v[152:155], v[64:67], v[64:67], v[152:155]
    ds_read_b64_tr_b16 a[12:13], v217 offset:25352
    s_waitcnt lgkmcnt(13)
    v_mfma_f32_16x16x32_bf16 v[40:43], a[16:19], v[64:67], v[40:43]
    buffer_load_dwordx4 v230, s[4:7], s27 offen offset:2048 lds
    s_add_u32 s21, s21, s22
    v_mfma_f32_16x16x32_bf16 v[44:47], a[16:19], v[68:71], v[44:47]
    ds_read_b64_tr_b16 a[14:15], v217 offset:25608
    s_waitcnt lgkmcnt(12)
    v_mfma_f32_16x16x32_bf16 v[48:51], a[20:23], v[64:67], v[48:51]
    ds_read_b64_tr_b16 a[16:17], v218 offset:25344
    v_mfma_f32_16x16x32_bf16 v[52:55], a[20:23], v[68:71], v[52:55]
    ds_read_b64_tr_b16 a[18:19], v218 offset:25600
    s_waitcnt lgkmcnt(12)
    v_mfma_f32_16x16x32_bf16 v[56:59], a[24:27], v[64:67], v[56:59]
    ds_read_b64_tr_b16 a[20:21], v218 offset:25352
    v_mfma_f32_16x16x32_bf16 v[60:63], a[24:27], v[68:71], v[60:63]
    buffer_load_dwordx4 v231, s[4:7], s27 offen offset:3072 lds
    s_add_u32 m0, s20, 0
    v_mfma_f32_16x16x32_bf16 v[168:171], a[24:27], v[220:223], v[168:171]
    ds_read_b64_tr_b16 a[22:23], v218 offset:25608
    v_mfma_f32_16x16x32_bf16 v[148:151], v[220:223], v[68:71], v[148:151]
    ds_read_b64_tr_b16 a[24:25], v211 offset:25344
    v_mfma_f32_16x16x32_bf16 v[156:159], v[68:71], v[68:71], v[156:159]
    ds_read_b64_tr_b16 a[26:27], v211 offset:25600
    s_waitcnt lgkmcnt(12)
    v_mfma_f32_16x16x32_bf16 v[8:11], a[0:3], v[72:75], v[8:11]
    s_waitcnt vmcnt(4)
    s_barrier
    ds_read_b128 v[64:67], v224 offset:32768
    v_mfma_f32_16x16x32_bf16 v[12:15], a[0:3], v[76:79], v[12:15]
    ds_read_b128 v[68:71], v224 offset:34816
    v_mfma_f32_16x16x32_bf16 v[160:163], a[0:3], v[220:223], v[160:163]
    buffer_load_dwordx4 v232, s[8:11], s21 offen offset:0 lds
    s_add_u32 s27, s27, 128
    s_waitcnt lgkmcnt(12)
    v_mfma_f32_16x16x32_bf16 v[16:19], a[4:7], v[72:75], v[16:19]
    ds_read_b64_tr_b16 a[0:1], v216 offset:33792
    v_mfma_f32_16x16x32_bf16 v[20:23], a[4:7], v[76:79], v[20:23]
    ds_read_b64_tr_b16 a[2:3], v216 offset:34048
    v_mfma_f32_16x16x32_bf16 v[164:167], a[4:7], v[220:223], v[164:167]
    s_waitcnt lgkmcnt(12)
    v_mfma_f32_16x16x32_bf16 v[24:27], a[8:11], v[72:75], v[24:27]
    ds_read_b64_tr_b16 a[4:5], v216 offset:33800
    v_mfma_f32_16x16x32_bf16 v[28:31], a[8:11], v[76:79], v[28:31]
    buffer_load_dwordx4 v233, s[8:11], s21 offen offset:1056 lds
    s_cmp_eq_u32 s27, 1152
    s_waitcnt lgkmcnt(11)
    v_mfma_f32_16x16x32_bf16 v[32:35], a[12:15], v[72:75], v[32:35]
    ds_read_b64_tr_b16 a[6:7], v216 offset:34056
    v_mfma_f32_16x16x32_bf16 v[36:39], a[12:15], v[76:79], v[36:39]
    ds_read_b64_tr_b16 a[8:9], v217 offset:33792
    v_mfma_f32_16x16x32_bf16 v[144:147], v[220:223], v[72:75], v[144:147]
    ds_read_b64_tr_b16 a[10:11], v217 offset:34048
    v_mfma_f32_16x16x32_bf16 v[152:155], v[72:75], v[72:75], v[152:155]
    ds_read_b64_tr_b16 a[12:13], v217 offset:33800
    s_waitcnt lgkmcnt(13)
    v_mfma_f32_16x16x32_bf16 v[40:43], a[16:19], v[72:75], v[40:43]
    buffer_load_dwordx4 v234, s[8:11], s21 offen offset:2112 lds
    s_cselect_b32 s27, 0, s27
    v_mfma_f32_16x16x32_bf16 v[44:47], a[16:19], v[76:79], v[44:47]
    ds_read_b64_tr_b16 a[14:15], v217 offset:34056
    s_waitcnt lgkmcnt(12)
    v_mfma_f32_16x16x32_bf16 v[48:51], a[20:23], v[72:75], v[48:51]
    ds_read_b64_tr_b16 a[16:17], v218 offset:33792
    v_mfma_f32_16x16x32_bf16 v[52:55], a[20:23], v[76:79], v[52:55]
    ds_read_b64_tr_b16 a[18:19], v218 offset:34048
    s_waitcnt lgkmcnt(12)
    v_mfma_f32_16x16x32_bf16 v[56:59], a[24:27], v[72:75], v[56:59]
    ds_read_b64_tr_b16 a[20:21], v218 offset:33800
    v_mfma_f32_16x16x32_bf16 v[60:63], a[24:27], v[76:79], v[60:63]
    buffer_load_dwordx4 v235, s[8:11], s21 offen offset:3168 lds
    v_mfma_f32_16x16x32_bf16 v[168:171], a[24:27], v[220:223], v[168:171]
    ds_read_b64_tr_b16 a[22:23], v218 offset:34056
    v_mfma_f32_16x16x32_bf16 v[148:151], v[220:223], v[76:79], v[148:151]
    ds_read_b64_tr_b16 a[24:25], v211 offset:33792
    v_mfma_f32_16x16x32_bf16 v[156:159], v[76:79], v[76:79], v[156:159]
    ds_read_b64_tr_b16 a[26:27], v211 offset:34048
    s_waitcnt lgkmcnt(12)
    v_mfma_f32_16x16x32_bf16 v[8:11], a[0:3], v[64:67], v[8:11]
    ds_read_b128 v[72:75], v225 offset:32768
    v_mfma_f32_16x16x32_bf16 v[12:15], a[0:3], v[68:71], v[12:15]
    ds_read_b128 v[76:79], v225 offset:34816
    v_mfma_f32_16x16x32_bf16 v[160:163], a[0:3], v[220:223], v[160:163]
    s_add_u32 m0, s30, 16384
    s_nop 0
    buffer_load_dwordx4 v228, s[4:7], s27 offen offset:0 lds
    s_waitcnt lgkmcnt(12)
    v_mfma_f32_16x16x32_bf16 v[16:19], a[4:7], v[64:67], v[16:19]
    ds_read_b64_tr_b16 a[0:1], v216 offset:42240
    v_mfma_f32_16x16x32_bf16 v[20:23], a[4:7], v[68:71], v[20:23]
    ds_read_b64_tr_b16 a[2:3], v216 offset:42496
    v_mfma_f32_16x16x32_bf16 v[164:167], a[4:7], v[220:223], v[164:167]
    s_waitcnt lgkmcnt(12)
    v_mfma_f32_16x16x32_bf16 v[24:27], a[8:11], v[64:67], v[24:27]
    ds_read_b64_tr_b16 a[4:5], v216 offset:42248
    v_mfma_f32_16x16x32_bf16 v[28:31], a[8:11], v[68:71], v[28:31]
    buffer_load_dwordx4 v229, s[4:7], s27 offen offset:1024 lds
    s_mul_i32 s21, s27, 1728
    s_waitcnt lgkmcnt(11)
    v_mfma_f32_16x16x32_bf16 v[32:35], a[12:15], v[64:67], v[32:35]
    ds_read_b64_tr_b16 a[6:7], v216 offset:42504
    v_mfma_f32_16x16x32_bf16 v[36:39], a[12:15], v[68:71], v[36:39]
    ds_read_b64_tr_b16 a[8:9], v217 offset:42240
    v_mfma_f32_16x16x32_bf16 v[144:147], v[220:223], v[64:67], v[144:147]
    ds_read_b64_tr_b16 a[10:11], v217 offset:42496
    v_mfma_f32_16x16x32_bf16 v[152:155], v[64:67], v[64:67], v[152:155]
    ds_read_b64_tr_b16 a[12:13], v217 offset:42248
    s_waitcnt lgkmcnt(13)
    v_mfma_f32_16x16x32_bf16 v[40:43], a[16:19], v[64:67], v[40:43]
    buffer_load_dwordx4 v230, s[4:7], s27 offen offset:2048 lds
    s_add_u32 s21, s21, s22
    v_mfma_f32_16x16x32_bf16 v[44:47], a[16:19], v[68:71], v[44:47]
    ds_read_b64_tr_b16 a[14:15], v217 offset:42504
    s_waitcnt lgkmcnt(12)
    v_mfma_f32_16x16x32_bf16 v[48:51], a[20:23], v[64:67], v[48:51]
    ds_read_b64_tr_b16 a[16:17], v218 offset:42240
    v_mfma_f32_16x16x32_bf16 v[52:55], a[20:23], v[68:71], v[52:55]
    ds_read_b64_tr_b16 a[18:19], v218 offset:42496
    s_waitcnt lgkmcnt(12)
    v_mfma_f32_16x16x32_bf16 v[56:59], a[24:27], v[64:67], v[56:59]
    ds_read_b64_tr_b16 a[20:21], v218 offset:42248
    v_mfma_f32_16x16x32_bf16 v[60:63], a[24:27], v[68:71], v[60:63]
    buffer_load_dwordx4 v231, s[4:7], s27 offen offset:3072 lds
    s_add_u32 m0, s20, 16896
    v_mfma_f32_16x16x32_bf16 v[168:171], a[24:27], v[220:223], v[168:171]
    ds_read_b64_tr_b16 a[22:23], v218 offset:42504
    v_mfma_f32_16x16x32_bf16 v[148:151], v[220:223], v[68:71], v[148:151]
    ds_read_b64_tr_b16 a[24:25], v211 offset:42240
    v_mfma_f32_16x16x32_bf16 v[156:159], v[68:71], v[68:71], v[156:159]
    ds_read_b64_tr_b16 a[26:27], v211 offset:42496
    s_waitcnt lgkmcnt(12)
    v_mfma_f32_16x16x32_bf16 v[8:11], a[0:3], v[72:75], v[8:11]
    s_waitcnt vmcnt(4)
    s_barrier
    ds_read_b128 v[64:67], v224 offset:0
    v_mfma_f32_16x16x32_bf16 v[12:15], a[0:3], v[76:79], v[12:15]
    ds_read_b128 v[68:71], v224 offset:2048
    v_mfma_f32_16x16x32_bf16 v[160:163], a[0:3], v[220:223], v[160:163]
    buffer_load_dwordx4 v232, s[8:11], s21 offen offset:0 lds
    s_add_u32 s27, s27, 128
    s_waitcnt lgkmcnt(12)
    v_mfma_f32_16x16x32_bf16 v[16:19], a[4:7], v[72:75], v[16:19]
    ds_read_b64_tr_b16 a[0:1], v216 offset:0
    v_mfma_f32_16x16x32_bf16 v[20:23], a[4:7], v[76:79], v[20:23]
    ds_read_b64_tr_b16 a[2:3], v216 offset:256
    v_mfma_f32_16x16x32_bf16 v[164:167], a[4:7], v[220:223], v[164:167]
    s_waitcnt lgkmcnt(12)
    v_mfma_f32_16x16x32_bf16 v[24:27], a[8:11], v[72:75], v[24:27]
    ds_read_b64_tr_b16 a[4:5], v216 offset:8
    v_mfma_f32_16x16x32_bf16 v[28:31], a[8:11], v[76:79], v[28:31]
    buffer_load_dwordx4 v233, s[8:11], s21 offen offset:1056 lds
    s_cmp_eq_u32 s27, 1152
    s_waitcnt lgkmcnt(11)
    v_mfma_f32_16x16x32_bf16 v[32:35], a[12:15], v[72:75], v[32:35]
    ds_read_b64_tr_b16 a[6:7], v216 offset:264
    v_mfma_f32_16x16x32_bf16 v[36:39], a[12:15], v[76:79], v[36:39]
    ds_read_b64_tr_b16 a[8:9], v217 offset:0
    v_mfma_f32_16x16x32_bf16 v[144:147], v[220:223], v[72:75], v[144:147]
    ds_read_b64_tr_b16 a[10:11], v217 offset:256
    v_mfma_f32_16x16x32_bf16 v[152:155], v[72:75], v[72:75], v[152:155]
    ds_read_b64_tr_b16 a[12:13], v217 offset:8
    s_waitcnt lgkmcnt(13)
    v_mfma_f32_16x16x32_bf16 v[40:43], a[16:19], v[72:75], v[40:43]
    buffer_load_dwordx4 v234, s[8:11], s21 offen offset:2112 lds
    s_cselect_b32 s27, 0, s27
    v_mfma_f32_16x16x32_bf16 v[44:47], a[16:19], v[76:79], v[44:47]
    ds_read_b64_tr_b16 a[14:15], v217 offset:264
    s_waitcnt lgkmcnt(12)
    v_mfma_f32_16x16x32_bf16 v[48:51], a[20:23], v[72:75], v[48:51]
    ds_read_b64_tr_b16 a[16:17], v218 offset:0
    v_mfma_f32_16x16x32_bf16 v[52:55], a[20:23], v[76:79], v[52:55]
    ds_read_b64_tr_b16 a[18:19], v218 offset:256
    s_waitcnt lgkmcnt(12)
    v_mfma_f32_16x16x32_bf16 v[56:59], a[24:27], v[72:75], v[56:59]
    ds_read_b64_tr_b16 a[20:21], v218 offset:8
    v_mfma_f32_16x16x32_bf16 v[60:63], a[24:27], v[76:79], v[60:63]
    buffer_load_dwordx4 v235, s[8:11], s21 offen offset:3168 lds
    v_mfma_f32_16x16x32_bf16 v[168:171], a[24:27], v[220:223], v[168:171]
    ds_read_b64_tr_b16 a[22:23], v218 offset:264
    v_mfma_f32_16x16x32_bf16 v[148:151], v[220:223], v[76:79], v[148:151]
    ds_read_b64_tr_b16 a[24:25], v211 offset:0
    v_mfma_f32_16x16x32_bf16 v[156:159], v[76:79], v[76:79], v[156:159]
    ds_read_b64_tr_b16 a[26:27], v211 offset:256
    s_waitcnt lgkmcnt(12)
    v_mfma_f32_16x16x32_bf16 v[8:11], a[0:3], v[64:67], v[8:11]
    ds_read_b128 v[72:75], v225 offset:0
    v_mfma_f32_16x16x32_bf16 v[12:15], a[0:3], v[68:71], v[12:15]
    ds_read_b128 v[76:79], v225 offset:2048
    v_mfma_f32_16x16x32_bf16 v[160:163], a[0:3], v[220:223], v[160:163]
    s_add_u32 m0, s30, 32768
    s_nop 0
    buffer_load_dwordx4 v228, s[4:7], s27 offen offset:0 lds
    s_waitcnt lgkmcnt(12)
    v_mfma_f32_16x16x32_bf16 v[16:19], a[4:7], v[64:67], v[16:19]
    ds_read_b64_tr_b16 a[0:1], v216 offset:8448
    v_mfma_f32_16x16x32_bf16 v[20:23], a[4:7], v[68:71], v[20:23]
    ds_read_b64_tr_b16 a[2:3], v216 offset:8704
    v_mfma_f32_16x16x32_bf16 v[164:167], a[4:7], v[220:223], v[164:167]
    s_waitcnt lgkmcnt(12)
    v_mfma_f32_16x16x32_bf16 v[24:27], a[8:11], v[64:67], v[24:27]
    ds_read_b64_tr_b16 a[4:5], v216 offset:8456
    v_mfma_f32_16x16x32_bf16 v[28:31], a[8:11], v[68:71], v[28:31]
    buffer_load_dwordx4 v229, s[4:7], s27 offen offset:1024 lds
    s_mul_i32 s21, s27, 1728
    s_waitcnt lgkmcnt(11)
    v_mfma_f32_16x16x32_bf16 v[32:35], a[12:15], v[64:67], v[32:35]
    ds_read_b64_tr_b16 a[6:7], v216 offset:8712
    v_mfma_f32_16x16x32_bf16 v[36:39], a[12:15], v[68:71], v[36:39]
    ds_read_b64_tr_b16 a[8:9], v217 offset:8448
    v_mfma_f32_16x16x32_bf16 v[144:147], v[220:223], v[64:67], v[144:147]
    ds_read_b64_tr_b16 a[10:11], v217 offset:8704
    v_mfma_f32_16x16x32_bf16 v[152:155], v[64:67], v[64:67], v[152:155]
    ds_read_b64_tr_b16 a[12:13], v217 offset:8456
    s_waitcnt lgkmcnt(13)
    v_mfma_f32_16x16x32_bf16 v[40:43], a[16:19], v[64:67], v[40:43]
    buffer_load_dwordx4 v230, s[4:7], s27 offen offset:2048 lds
    s_add_u32 s21, s21, s22
    v_mfma_f32_16x16x32_bf16 v[44:47], a[16:19], v[68:71], v[44:47]
    ds_read_b64_tr_b16 a[14:15], v217 offset:8712
    s_waitcnt lgkmcnt(12)
    v_mfma_f32_16x16x32_bf16 v[48:51], a[20:23], v[64:67], v[48:51]
    ds_read_b64_tr_b16 a[16:17], v218 offset:8448
    v_mfma_f32_16x16x32_bf16 v[52:55], a[20:23], v[68:71], v[52:55]
    ds_read_b64_tr_b16 a[18:19], v218 offset:8704
    s_waitcnt lgkmcnt(12)
    v_mfma_f32_16x16x32_bf16 v[56:59], a[24:27], v[64:67], v[56:59]
    ds_read_b64_tr_b16 a[20:21], v218 offset:8456
    v_mfma_f32_16x16x32_bf16 v[60:63], a[24:27], v[68:71], v[60:63]
    buffer_load_dwordx4 v231, s[4:7], s27 offen offset:3072 lds
    s_add_u32 m0, s20, 33792
    v_mfma_f32_16x16x32_bf16 v[168:171], a[24:27], v[220:223], v[168:171]
    ds_read_b64_tr_b16 a[22:23], v218 offset:8712
    v_mfma_f32_16x16x32_bf16 v[148:151], v[220:223], v[68:71], v[148:151]
    ds_read_b64_tr_b16 a[24:25], v211 offset:8448
    v_mfma_f32_16x16x32_bf16 v[156:159], v[68:71], v[68:71], v[156:159]
    ds_read_b64_tr_b16 a[26:27], v211 offset:8704
    s_waitcnt lgkmcnt(12)
    v_mfma_f32_16x16x32_bf16 v[8:11], a[0:3], v[72:75], v[8:11]
    s_waitcnt vmcnt(4)
    s_barrier
    ds_read_b128 v[64:67], v224 offset:16384
    v_mfma_f32_16x16x32_bf16 v[12:15], a[0:3], v[76:79], v[12:15]
    ds_read_b128 v[68:71], v224 offset:18432
    v_mfma_f32_16x16x32_bf16 v[160:163], a[0:3], v[220:223], v[160:163]
    buffer_load_dwordx4 v232, s[8:11], s21 offen offset:0 lds
    s_add_u32 s27, s27, 128
    s_waitcnt lgkmcnt(12)
    v_mfma_f32_16x16x32_bf16 v[16:19], a[4:7], v[72:75], v[16:19]
    ds_read_b64_tr_b16 a[0:1], v216 offset:16896
    v_mfma_f32_16x16x32_bf16 v[20:23], a[4:7], v[76:79], v[20:23]
    ds_read_b64_tr_b16 a[2:3], v216 offset:17152
    v_mfma_f32_16x16x32_bf16 v[164:167], a[4:7], v[220:223], v[164:167]
    s_waitcnt lgkmcnt(12)
    v_mfma_f32_16x16x32_bf16 v[24:27], a[8:11], v[72:75], v[24:27]
    ds_read_b64_tr_b16 a[4:5], v216 offset:16904
    v_mfma_f32_16x16x32_bf16 v[28:31], a[8:11], v[76:79], v[28:31]
    buffer_load_dwordx4 v233, s[8:11], s21 offen offset:1056 lds
    s_cmp_eq_u32 s27, 1152
    s_waitcnt lgkmcnt(11)
    v_mfma_f32_16x16x32_bf16 v[32:35], a[12:15], v[72:75], v[32:35]
    ds_read_b64_tr_b16 a[6:7], v216 offset:17160
    v_mfma_f32_16x16x32_bf16 v[36:39], a[12:15], v[76:79], v[36:39]
    ds_read_b64_tr_b16 a[8:9], v217 offset:16896
    v_mfma_f32_16x16x32_bf16 v[144:147], v[220:223], v[72:75], v[144:147]
    ds_read_b64_tr_b16 a[10:11], v217 offset:17152
    v_mfma_f32_16x16x32_bf16 v[152:155], v[72:75], v[72:75], v[152:155]
    ds_read_b64_tr_b16 a[12:13], v217 offset:16904
    s_waitcnt lgkmcnt(13)
    v_mfma_f32_16x16x32_bf16 v[40:43], a[16:19], v[72:75], v[40:43]
    buffer_load_dwordx4 v234, s[8:11], s21 offen offset:2112 lds
    s_cselect_b32 s27, 0, s27
    v_mfma_f32_16x16x32_bf16 v[44:47], a[16:19], v[76:79], v[44:47]
    ds_read_b64_tr_b16 a[14:15], v217 offset:17160
    s_waitcnt lgkmcnt(12)
    v_mfma_f32_16x16x32_bf16 v[48:51], a[20:23], v[72:75], v[48:51]
    ds_read_b64_tr_b16 a[16:17], v218 offset:16896
    v_mfma_f32_16x16x32_bf16 v[52:55], a[20:23], v[76:79], v[52:55]
    ds_read_b64_tr_b16 a[18:19], v218 offset:17152
    s_waitcnt lgkmcnt(12)
    v_mfma_f32_16x16x32_bf16 v[56:59], a[24:27], v[72:75], v[56:59]
    ds_read_b64_tr_b16 a[20:21], v218 offset:16904
    v_mfma_f32_16x16x32_bf16 v[60:63], a[24:27], v[76:79], v[60:63]
    buffer_load_dwordx4 v235, s[8:11], s21 offen offset:3168 lds
    v_mfma_f32_16x16x32_bf16 v[168:171], a[24:27], v[220:223], v[168:171]
    ds_read_b64_tr_b16 a[22:23], v218 offset:17160
    v_mfma_f32_16x16x32_bf16 v[148:151], v[220:223], v[76:79], v[148:151]
    ds_read_b64_tr_b16 a[24:25], v211 offset:16896
    v_mfma_f32_16x16x32_bf16 v[156:159], v[76:79], v[76:79], v[156:159]
    ds_read_b64_tr_b16 a[26:27], v211 offset:17152
    s_waitcnt lgkmcnt(12)
    v_mfma_f32_16x16x32_bf16 v[8:11], a[0:3], v[64:67], v[8:11]
    ds_read_b128 v[72:75], v225 offset:16384
    v_mfma_f32_16x16x32_bf16 v[12:15], a[0:3], v[68:71], v[12:15]
    ds_read_b128 v[76:79], v225 offset:18432
    v_mfma_f32_16x16x32_bf16 v[160:163], a[0:3], v[220:223], v[160:163]
    s_waitcnt lgkmcnt(12)
    v_mfma_f32_16x16x32_bf16 v[16:19], a[4:7], v[64:67], v[16:19]
    ds_read_b64_tr_b16 a[0:1], v216 offset:25344
    v_mfma_f32_16x16x32_bf16 v[20:23], a[4:7], v[68:71], v[20:23]
    ds_read_b64_tr_b16 a[2:3], v216 offset:25600
    v_mfma_f32_16x16x32_bf16 v[164:167], a[4:7], v[220:223], v[164:167]
    s_waitcnt lgkmcnt(12)
    v_mfma_f32_16x16x32_bf16 v[24:27], a[8:11], v[64:67], v[24:27]
    ds_read_b64_tr_b16 a[4:5], v216 offset:25352
    v_mfma_f32_16x16x32_bf16 v[28:31], a[8:11], v[68:71], v[28:31]
    ds_read_b64_tr_b16 a[6:7], v216 offset:25608
    s_waitcnt lgkmcnt(12)
    v_mfma_f32_16x16x32_bf16 v[32:35], a[12:15], v[64:67], v[32:35]
    ds_read_b64_tr_b16 a[8:9], v217 offset:25344
    v_mfma_f32_16x16x32_bf16 v[36:39], a[12:15], v[68:71], v[36:39]
    ds_read_b64_tr_b16 a[10:11], v217 offset:25600
    v_mfma_f32_16x16x32_bf16 v[144:147], v[220:223], v[64:67], v[144:147]
    ds_read_b64_tr_b16 a[12:13], v217 offset:25352
    v_mfma_f32_16x16x32_bf16 v[152:155], v[64:67], v[64:67], v[152:155]
    ds_read_b64_tr_b16 a[14:15], v217 offset:25608
    s_waitcnt lgkmcnt(14)
    v_mfma_f32_16x16x32_bf16 v[40:43], a[16:19], v[64:67], v[40:43]
    v_mfma_f32_16x16x32_bf16 v[44:47], a[16:19], v[68:71], v[44:47]
    s_waitcnt lgkmcnt(12)
    v_mfma_f32_16x16x32_bf16 v[48:51], a[20:23], v[64:67], v[48:51]
    ds_read_b64_tr_b16 a[16:17], v218 offset:25344
    v_mfma_f32_16x16x32_bf16 v[52:55], a[20:23], v[68:71], v[52:55]
    ds_read_b64_tr_b16 a[18:19], v218 offset:25600
    s_waitcnt lgkmcnt(12)
    v_mfma_f32_16x16x32_bf16 v[56:59], a[24:27], v[64:67], v[56:59]
    ds_read_b64_tr_b16 a[20:21], v218 offset:25352
    v_mfma_f32_16x16x32_bf16 v[60:63], a[24:27], v[68:71], v[60:63]
    ds_read_b64_tr_b16 a[22:23], v218 offset:25608
    v_mfma_f32_16x16x32_bf16 v[168:171], a[24:27], v[220:223], v[168:171]
    v_mfma_f32_16x16x32_bf16 v[148:151], v[220:223], v[68:71], v[148:151]
    ds_read_b64_tr_b16 a[24:25], v211 offset:25344
    v_mfma_f32_16x16x32_bf16 v[156:159], v[68:71], v[68:71], v[156:159]
    ds_read_b64_tr_b16 a[26:27], v211 offset:25600
    s_waitcnt lgkmcnt(12)
    v_mfma_f32_16x16x32_bf16 v[8:11], a[0:3], v[72:75], v[8:11]
    s_waitcnt vmcnt(0)
    s_barrier
    ds_read_b128 v[64:67], v224 offset:32768
    v_mfma_f32_16x16x32_bf16 v[12:15], a[0:3], v[76:79], v[12:15]
    ds_read_b128 v[68:71], v224 offset:34816
    v_mfma_f32_16x16x32_bf16 v[160:163], a[0:3], v[220:223], v[160:163]
    s_waitcnt lgkmcnt(12)
    v_mfma_f32_16x16x32_bf16 v[16:19], a[4:7], v[72:75], v[16:19]
    ds_read_b64_tr_b16 a[0:1], v216 offset:33792
    v_mfma_f32_16x16x32_bf16 v[20:23], a[4:7], v[76:79], v[20:23]
    ds_read_b64_tr_b16 a[2:3], v216 offset:34048
    v_mfma_f32_16x16x32_bf16 v[164:167], a[4:7], v[220:223], v[164:167]
    s_waitcnt lgkmcnt(12)
    v_mfma_f32_16x16x32_bf16 v[24:27], a[8:11], v[72:75], v[24:27]
    ds_read_b64_tr_b16 a[4:5], v216 offset:33800
    v_mfma_f32_16x16x32_bf16 v[28:31], a[8:11], v[76:79], v[28:31]
    ds_read_b64_tr_b16 a[6:7], v216 offset:34056
    s_waitcnt lgkmcnt(12)
    v_mfma_f32_16x16x32_bf16 v[32:35], a[12:15], v[72:75], v[32:35]
    ds_read_b64_tr_b16 a[8:9], v217 offset:33792
    v_mfma_f32_16x16x32_bf16 v[36:39], a[12:15], v[76:79], v[36:39]
    ds_read_b64_tr_b16 a[10:11], v217 offset:34048
    v_mfma_f32_16x16x32_bf16 v[144:147], v[220:223], v[72:75], v[144:147]
    ds_read_b64_tr_b16 a[12:13], v217 offset:33800
    v_mfma_f32_16x16x32_bf16 v[152:155], v[72:75], v[72:75], v[152:155]
    ds_read_b64_tr_b16 a[14:15], v217 offset:34056
    s_waitcnt lgkmcnt(14)
    v_mfma_f32_16x16x32_bf16 v[40:43], a[16:19], v[72:75], v[40:43]
    v_mfma_f32_16x16x32_bf16 v[44:47], a[16:19], v[76:79], v[44:47]
    s_waitcnt lgkmcnt(12)
    v_mfma_f32_16x16x32_bf16 v[48:51], a[20:23], v[72:75], v[48:51]
    ds_read_b64_tr_b16 a[16:17], v218 offset:33792
    v_mfma_f32_16x16x32_bf16 v[52:55], a[20:23], v[76:79], v[52:55]
    ds_read_b64_tr_b16 a[18:19], v218 offset:34048
    s_waitcnt lgkmcnt(12)
    v_mfma_f32_16x16x32_bf16 v[56:59], a[24:27], v[72:75], v[56:59]
    ds_read_b64_tr_b16 a[20:21], v218 offset:33800
    v_mfma_f32_16x16x32_bf16 v[60:63], a[24:27], v[76:79], v[60:63]
    ds_read_b64_tr_b16 a[22:23], v218 offset:34056
    v_mfma_f32_16x16x32_bf16 v[168:171], a[24:27], v[220:223], v[168:171]
    v_mfma_f32_16x16x32_bf16 v[148:151], v[220:223], v[76:79], v[148:151]
    ds_read_b64_tr_b16 a[24:25], v211 offset:33792
    v_mfma_f32_16x16x32_bf16 v[156:159], v[76:79], v[76:79], v[156:159]
    ds_read_b64_tr_b16 a[26:27], v211 offset:34048
    v_mov_b32 v212, 0x3f80
    s_waitcnt lgkmcnt(12)
    v_mfma_f32_16x16x32_bf16 v[8:11], a[0:3], v[64:67], v[8:11]
    ds_read_b128 v[72:75], v225 offset:32768
    v_mfma_f32_16x16x32_bf16 v[12:15], a[0:3], v[68:71], v[12:15]
    ds_read_b128 v[76:79], v225 offset:34816
    v_mfma_f32_16x16x32_bf16 v[160:163], a[0:3], v[220:223], v[160:163]
    buffer_store_dword v212, v176, s[12:15], 0 offen offset:0
    s_waitcnt lgkmcnt(12)
    v_mfma_f32_16x16x32_bf16 v[16:19], a[4:7], v[64:67], v[16:19]
    ds_read_b64_tr_b16 a[0:1], v216 offset:42240
    v_mfma_f32_16x16x32_bf16 v[20:23], a[4:7], v[68:71], v[20:23]
    ds_read_b64_tr_b16 a[2:3], v216 offset:42496
    v_mfma_f32_16x16x32_bf16 v[164:167], a[4:7], v[220:223], v[164:167]
    s_waitcnt lgkmcnt(12)
    v_mfma_f32_16x16x32_bf16 v[24:27], a[8:11], v[64:67], v[24:27]
    ds_read_b64_tr_b16 a[4:5], v216 offset:42248
    v_mfma_f32_16x16x32_bf16 v[28:31], a[8:11], v[68:71], v[28:31]
    buffer_store_dword v212, v177, s[12:15], 0 offen offset:0
    s_waitcnt lgkmcnt(11)
    v_mfma_f32_16x16x32_bf16 v[32:35], a[12:15], v[64:67], v[32:35]
    ds_read_b64_tr_b16 a[6:7], v216 offset:42504
    v_mfma_f32_16x16x32_bf16 v[36:39], a[12:15], v[68:71], v[36:39]
    ds_read_b64_tr_b16 a[8:9], v217 offset:42240
    v_mfma_f32_16x16x32_bf16 v[144:147], v[220:223], v[64:67], v[144:147]
    ds_read_b64_tr_b16 a[10:11], v217 offset:42496
    v_mfma_f32_16x16x32_bf16 v[152:155], v[64:67], v[64:67], v[152:155]
    ds_read_b64_tr_b16 a[12:13], v217 offset:42248
    s_waitcnt lgkmcnt(13)
    v_mfma_f32_16x16x32_bf16 v[40:43], a[16:19], v[64:67], v[40:43]
    buffer_store_dword v212, v176, s[12:15], 0 offen offset:640
    v_mfma_f32_16x16x32_bf16 v[44:47], a[16:19], v[68:71], v[44:47]
    ds_read_b64_tr_b16 a[14:15], v217 offset:42504
    s_waitcnt lgkmcnt(12)
    v_mfma_f32_16x16x32_bf16 v[48:51], a[20:23], v[64:67], v[48:51]
    ds_read_b64_tr_b16 a[16:17], v218 offset:42240
    v_mfma_f32_16x16x32_bf16 v[52:55], a[20:23], v[68:71], v[52:55]
    ds_read_b64_tr_b16 a[18:19], v218 offset:42496
    s_waitcnt lgkmcnt(12)
    v_mfma_f32_16x16x32_bf16 v[56:59], a[24:27], v[64:67], v[56:59]
    ds_read_b64_tr_b16 a[20:21], v218 offset:42248
    v_mfma_f32_16x16x32_bf16 v[60:63], a[24:27], v[68:71], v[60:63]
    buffer_store_dword v212, v177, s[12:15], 0 offen offset:640
    v_mfma_f32_16x16x32_bf16 v[168:171], a[24:27], v[220:223], v[168:171]
    ds_read_b64_tr_b16 a[22:23], v218 offset:42504
    v_mfma_f32_16x16x32_bf16 v[148:151], v[220:223], v[68:71], v[148:151]
    ds_read_b64_tr_b16 a[24:25], v211 offset:42240
    v_mfma_f32_16x16x32_bf16 v[156:159], v[68:71], v[68:71], v[156:159]
    ds_read_b64_tr_b16 a[26:27], v211 offset:42496
    s_waitcnt lgkmcnt(12)
    v_mfma_f32_16x16x32_bf16 v[8:11], a[0:3], v[72:75], v[8:11]
    v_mfma_f32_16x16x32_bf16 v[12:15], a[0:3], v[76:79], v[12:15]
    v_mfma_f32_16x16x32_bf16 v[160:163], a[0:3], v[220:223], v[160:163]
    s_waitcnt lgkmcnt(10)
    v_mfma_f32_16x16x32_bf16 v[16:19], a[4:7], v[72:75], v[16:19]
    v_mfma_f32_16x16x32_bf16 v[20:23], a[4:7], v[76:79], v[20:23]
    v_mfma_f32_16x16x32_bf16 v[164:167], a[4:7], v[220:223], v[164:167]
    s_waitcnt lgkmcnt(8)
    v_mfma_f32_16x16x32_bf16 v[24:27], a[8:11], v[72:75], v[24:27]
    v_mfma_f32_16x16x32_bf16 v[28:31], a[8:11], v[76:79], v[28:31]
    s_waitcnt lgkmcnt(6)
    v_mfma_f32_16x16x32_bf16 v[32:35], a[12:15], v[72:75], v[32:35]
    v_mfma_f32_16x16x32_bf16 v[36:39], a[12:15], v[76:79], v[36:39]
    v_mfma_f32_16x16x32_bf16 v[144:147], v[220:223], v[72:75], v[144:147]
    v_mfma_f32_16x16x32_bf16 v[152:155], v[72:75], v[72:75], v[152:155]
    s_waitcnt lgkmcnt(4)
    v_mfma_f32_16x16x32_bf16 v[40:43], a[16:19], v[72:75], v[40:43]
    v_mfma_f32_16x16x32_bf16 v[44:47], a[16:19], v[76:79], v[44:47]
    s_waitcnt lgkmcnt(2)
    v_mfma_f32_16x16x32_bf16 v[48:51], a[20:23], v[72:75], v[48:51]
    v_mfma_f32_16x16x32_bf16 v[52:55], a[20:23], v[76:79], v[52:55]
    s_waitcnt lgkmcnt(0)
    v_mfma_f32_16x16x32_bf16 v[56:59], a[24:27], v[72:75], v[56:59]
    v_mfma_f32_16x16x32_bf16 v[60:63], a[24:27], v[76:79], v[60:63]
    v_mfma_f32_16x16x32_bf16 v[168:171], a[24:27], v[220:223], v[168:171]
    v_mfma_f32_16x16x32_bf16 v[148:151], v[220:223], v[76:79], v[148:151]
    v_mfma_f32_16x16x32_bf16 v[156:159], v[76:79], v[76:79], v[156:159]
    s_mov_b32 exec_lo, 0x00010001
    s_mov_b32 exec_hi, 0x00010001
    ds_write_b128 v184, v[160:163]
    ds_write_b128 v184, v[164:167] offset:64
    s_mov_b64 exec, -1
    v_cndmask_b32 v212, 0, v152, s[48:49]
    s_nop 1
    v_cndmask_b32 v213, 0, v156, s[48:49]
    v_cndmask_b32 v212, v212, v153, s[50:51]
    v_cndmask_b32 v213, v213, v157, s[50:51]
    v_cndmask_b32 v212, v212, v154, s[52:53]
    v_cndmask_b32 v213, v213, v158, s[52:53]
    v_cndmask_b32 v212, v212, v155, s[54:55]
    v_cndmask_b32 v213, v213, v159, s[54:55]
    s_waitcnt lgkmcnt(0)
    s_barrier
    ds_read_b128 v[236:239], v173 offset:0
    ds_read_b128 v[240:243], v173 offset:64
    ds_read_b128 v[244:247], v185 offset:0
    ds_read_b128 v[248:251], v185 offset:64
    v_mov_b32 v152, v212
    v_mov_b32 v153, v213
    v_mul_f32 v192, 0xbae38e39, v144
    v_mul_f32 v193, 0xbae38e39, v148
    v_permlane16_swap_b32 v212, v152
    v_permlane16_swap_b32 v213, v153
    v_add_f32 v212, v212, v152
    v_add_f32 v213, v213, v153
    v_mov_b32 v152, v212
    v_mov_b32 v153, v213
    v_mul_f32 v194, v192, v192
    v_mul_f32 v195, v193, v193
    v_permlane32_swap_b32 v212, v152
    v_permlane32_swap_b32 v213, v153
    v_add_f32 v212, v212, v152
    v_add_f32 v213, v213, v153
    s_mov_b32 s24, 0x3ae38e39
    v_fma_f32 v194, v212, s24, -v194
    v_fma_f32 v195, v213, s24, -v195
    v_max_f32 v194, 0, v194
    v_max_f32 v195, 0, v195
    v_add_f32 v194, 0x3727c5ac, v194
    v_add_f32 v195, 0x3727c5ac, v195
    v_rsq_f32 v194, v194
    v_rsq_f32 v195, v195
    v_pk_fma_f32 v[8:9], v[160:161], v[192:193], v[8:9] op_sel:[0,0,0] op_sel_hi:[1,0,1]
    v_pk_fma_f32 v[10:11], v[162:163], v[192:193], v[10:11] op_sel:[0,0,0] op_sel_hi:[1,0,1]
    v_pk_fma_f32 v[12:13], v[160:161], v[192:193], v[12:13] op_sel:[0,1,0] op_sel_hi:[1,1,1]
    v_pk_fma_f32 v[14:15], v[162:163], v[192:193], v[14:15] op_sel:[0,1,0] op_sel_hi:[1,1,1]
    v_mul_f32 v196, s42, v194
    v_mul_f32 v197, s42, v195
    v_mul_f32 v198, s43, v194
    v_mul_f32 v199, s43, v195
    v_mul_f32 v200, s44, v194
    v_mul_f32 v201, s44, v195
    v_mul_f32 v202, v172, v194
    v_mul_f32 v203, v172, v195
    v_pk_fma_f32 v[16:17], v[164:165], v[192:193], v[16:17] op_sel:[0,0,0] op_sel_hi:[1,0,1]
    v_pk_fma_f32 v[18:19], v[166:167], v[192:193], v[18:19] op_sel:[0,0,0] op_sel_hi:[1,0,1]
    v_pk_fma_f32 v[20:21], v[164:165], v[192:193], v[20:21] op_sel:[0,1,0] op_sel_hi:[1,1,1]
    v_pk_fma_f32 v[22:23], v[166:167], v[192:193], v[22:23] op_sel:[0,1,0] op_sel_hi:[1,1,1]
    v_pk_mul_f32 v[8:9], v[8:9], v[196:197] op_sel:[0,0] op_sel_hi:[1,0]
    v_pk_mul_f32 v[10:11], v[10:11], v[196:197] op_sel:[0,0] op_sel_hi:[1,0]
    v_cvt_pk_bf16_f32 v64, v8, v9
    v_cvt_pk_bf16_f32 v65, v10, v11
    v_pk_mul_f32 v[12:13], v[12:13], v[196:197] op_sel:[0,1] op_sel_hi:[1,1]
    v_pk_mul_f32 v[14:15], v[14:15], v[196:197] op_sel:[0,1] op_sel_hi:[1,1]
    v_cvt_pk_bf16_f32 v68, v12, v13
    v_cvt_pk_bf16_f32 v69, v14, v15
    s_waitcnt lgkmcnt(3)
    v_pk_fma_f32 v[24:25], v[236:237], v[192:193], v[24:25] op_sel:[0,0,0] op_sel_hi:[1,0,1]
    v_pk_fma_f32 v[26:27], v[238:239], v[192:193], v[26:27] op_sel:[0,0,0] op_sel_hi:[1,0,1]
    v_pk_fma_f32 v[28:29], v[236:237], v[192:193], v[28:29] op_sel:[0,1,0] op_sel_hi:[1,1,1]
    v_pk_fma_f32 v[30:31], v[238:239], v[192:193], v[30:31] op_sel:[0,1,0] op_sel_hi:[1,1,1]
    v_pk_mul_f32 v[16:17], v[16:17], v[196:197] op_sel:[0,0] op_sel_hi:[1,0]
    v_pk_mul_f32 v[18:19], v[18:19], v[196:197] op_sel:[0,0] op_sel_hi:[1,0]
    v_cvt_pk_bf16_f32 v66, v16, v17
    v_cvt_pk_bf16_f32 v67, v18, v19
    buffer_store_dwordx4 v[64:67], v188, s[12:15], s36 offen offset:0
    v_pk_mul_f32 v[20:21], v[20:21], v[196:197] op_sel:[0,1] op_sel_hi:[1,1]
    v_pk_mul_f32 v[22:23], v[22:23], v[196:197] op_sel:[0,1] op_sel_hi:[1,1]
    v_cvt_pk_bf16_f32 v70, v20, v21
    v_cvt_pk_bf16_f32 v71, v22, v23
    buffer_store_dwordx4 v[68:71], v188, s[12:15], s37 offen offset:256
    s_waitcnt lgkmcnt(2)
    v_pk_fma_f32 v[32:33], v[240:241], v[192:193], v[32:33] op_sel:[0,0,0] op_sel_hi:[1,0,1]
    v_pk_fma_f32 v[34:35], v[242:243], v[192:193], v[34:35] op_sel:[0,0,0] op_sel_hi:[1,0,1]
    v_pk_fma_f32 v[36:37], v[240:241], v[192:193], v[36:37] op_sel:[0,1,0] op_sel_hi:[1,1,1]
    v_pk_fma_f32 v[38:39], v[242:243], v[192:193], v[38:39] op_sel:[0,1,0] op_sel_hi:[1,1,1]
    v_pk_mul_f32 v[24:25], v[24:25], v[198:199] op_sel:[0,0] op_sel_hi:[1,0]
    v_pk_mul_f32 v[26:27], v[26:27], v[198:199] op_sel:[0,0] op_sel_hi:[1,0]
    v_cvt_pk_bf16_f32 v72, v24, v25
    v_cvt_pk_bf16_f32 v73, v26, v27
    v_pk_mul_f32 v[28:29], v[28:29], v[198:199] op_sel:[0,1] op_sel_hi:[1,1]
    v_pk_mul_f32 v[30:31], v[30:31], v[198:199] op_sel:[0,1] op_sel_hi:[1,1]
    v_cvt_pk_bf16_f32 v76, v28, v29
    v_cvt_pk_bf16_f32 v77, v30, v31
    s_waitcnt lgkmcnt(1)
    v_pk_fma_f32 v[40:41], v[244:245], v[192:193], v[40:41] op_sel:[0,0,0] op_sel_hi:[1,0,1]
    v_pk_fma_f32 v[42:43], v[246:247], v[192:193], v[42:43] op_sel:[0,0,0] op_sel_hi:[1,0,1]
    v_pk_fma_f32 v[44:45], v[244:245], v[192:193], v[44:45] op_sel:[0,1,0] op_sel_hi:[1,1,1]
    v_pk_fma_f32 v[46:47], v[246:247], v[192:193], v[46:47] op_sel:[0,1,0] op_sel_hi:[1,1,1]
    v_pk_mul_f32 v[32:33], v[32:33], v[198:199] op_sel:[0,0] op_sel_hi:[1,0]
    v_pk_mul_f32 v[34:35], v[34:35], v[198:199] op_sel:[0,0] op_sel_hi:[1,0]
    v_cvt_pk_bf16_f32 v74, v32, v33
    v_cvt_pk_bf16_f32 v75, v34, v35
    buffer_store_dwordx4 v[72:75], v189, s[12:15], s38 offen offset:0
    v_pk_mul_f32 v[36:37], v[36:37], v[198:199] op_sel:[0,1] op_sel_hi:[1,1]
    v_pk_mul_f32 v[38:39], v[38:39], v[198:199] op_sel:[0,1] op_sel_hi:[1,1]
    v_cvt_pk_bf16_f32 v78, v36, v37
    v_cvt_pk_bf16_f32 v79, v38, v39
    buffer_store_dwordx4 v[76:79], v189, s[12:15], s39 offen offset:256
    s_waitcnt lgkmcnt(0)
    v_pk_fma_f32 v[48:49], v[248:249], v[192:193], v[48:49] op_sel:[0,0,0] op_sel_hi:[1,0,1]
    v_pk_fma_f32 v[50:51], v[250:251], v[192:193], v[50:51] op_sel:[0,0,0] op_sel_hi:[1,0,1]
    v_pk_fma_f32 v[52:53], v[248:249], v[192:193], v[52:53] op_sel:[0,1,0] op_sel_hi:[1,1,1]
    v_pk_fma_f32 v[54:55], v[250:251], v[192:193], v[54:55] op_sel:[0,1,0] op_sel_hi:[1,1,1]
    v_pk_mul_f32 v[40:41], v[40:41], v[200:201] op_sel:[0,0] op_sel_hi:[1,0]
    v_pk_mul_f32 v[42:43], v[42:43], v[200:201] op_sel:[0,0] op_sel_hi:[1,0]
    v_cvt_pk_bf16_f32 v80, v40, v41
    v_cvt_pk_bf16_f32 v81, v42, v43
    v_pk_mul_f32 v[44:45], v[44:45], v[200:201] op_sel:[0,1] op_sel_hi:[1,1]
    v_pk_mul_f32 v[46:47], v[46:47], v[200:201] op_sel:[0,1] op_sel_hi:[1,1]
    v_cvt_pk_bf16_f32 v84, v44, v45
    v_cvt_pk_bf16_f32 v85, v46, v47
    v_pk_fma_f32 v[56:57], v[168:169], v[192:193], v[56:57] op_sel:[0,0,0] op_sel_hi:[1,0,1]
    v_pk_fma_f32 v[58:59], v[170:171], v[192:193], v[58:59] op_sel:[0,0,0] op_sel_hi:[1,0,1]
    v_pk_fma_f32 v[60:61], v[168:169], v[192:193], v[60:61] op_sel:[0,1,0] op_sel_hi:[1,1,1]
    v_pk_fma_f32 v[62:63], v[170:171], v[192:193], v[62:63] op_sel:[0,1,0] op_sel_hi:[1,1,1]
    v_pk_mul_f32 v[48:49], v[48:49], v[200:201] op_sel:[0,0] op_sel_hi:[1,0]
    v_pk_mul_f32 v[50:51], v[50:51], v[200:201] op_sel:[0,0] op_sel_hi:[1,0]
    v_cvt_pk_bf16_f32 v82, v48, v49
    v_cvt_pk_bf16_f32 v83, v50, v51
    buffer_store_dwordx4 v[80:83], v190, s[12:15], s40 offen offset:0
    v_pk_mul_f32 v[52:53], v[52:53], v[200:201] op_sel:[0,1] op_sel_hi:[1,1]
    v_pk_mul_f32 v[54:55], v[54:55], v[200:201] op_sel:[0,1] op_sel_hi:[1,1]
    v_cvt_pk_bf16_f32 v86, v52, v53
    v_cvt_pk_bf16_f32 v87, v54, v55
    buffer_store_dwordx4 v[84:87], v190, s[12:15], s41 offen offset:256
    v_pk_mul_f32 v[56:57], v[56:57], v[202:203] op_sel:[0,0] op_sel_hi:[1,0]
    v_pk_mul_f32 v[58:59], v[58:59], v[202:203] op_sel:[0,0] op_sel_hi:[1,0]
    v_cvt_pk_bf16_f32 v88, v56, v57
    v_cvt_pk_bf16_f32 v89, v58, v59
    buffer_store_dword v88, v174, s[12:15], 0 offen
    buffer_store_dword v89, v175, s[12:15], 0 offen
    v_pk_mul_f32 v[60:61], v[60:61], v[202:203] op_sel:[0,1] op_sel_hi:[1,1]
    v_pk_mul_f32 v[62:63], v[62:63], v[202:203] op_sel:[0,1] op_sel_hi:[1,1]
    v_cvt_pk_bf16_f32 v92, v60, v61
    v_cvt_pk_bf16_f32 v93, v62, v63
    buffer_store_dword v92, v182, s[12:15], 0 offen
    buffer_store_dword v93, v181, s[12:15], 0 offen
qkv_kernel_end:
    s_endpgm
.globl attn_kernel
.p2align 8
.type attn_kernel,@function
attn_kernel:
    s_cmp_ge_u32 s2, 256
    s_cbranch_scc1 attn_kernel_end
    s_load_dwordx2 s[12:13], s[0:1], 80
    s_load_dwordx2 s[56:57], s[0:1], 80
    s_mov_b32 s14, 44826624
    s_mov_b32 s15, 0x20000
    s_mov_b32 s58, 44826624
    s_mov_b32 s59, 0x20000
    s_mov_b32 s58, 44826624
    s_load_dwordx2 s[44:45], s[0:1], 32
    s_load_dwordx2 s[46:47], s[0:1], 48
    s_load_dwordx2 s[48:49], s[0:1], 16
    v_lshrrev_b32 v145, 6, v0
    v_and_b32 v140, 63, v0
    v_readfirstlane_b32 s24, v145
    s_and_b32 s25, s2, 7
    s_lshl_b32 s25, s25, 2
    s_bfe_u32 s27, s2, 0x20003
    s_add_u32 s25, s25, s27
    s_lshr_b32 s26, s2, 5
    s_lshl_b32 s26, s26, 3
    s_add_u32 s26, s26, s24
    v_lshlrev_b32 v142, 4, v140
    v_and_b32 v146, 31, v140
    v_lshlrev_b32 v143, 2, v146
    s_lshl_b32 s28, s24, 10
    s_mul_i32 s29, s25, 155648
    s_add_u32 s29, s29, s28
    s_add_u32 s29, s29, 2359296
    s_lshl_b32 s27, s25, 6
    s_add_u32 s27, s27, s26
    s_lshl_b32 s34, s27, 10
    s_lshl_b32 s35, s27, 7
    s_add_u32 s35, s35, 2097152
    s_waitcnt lgkmcnt(0)
    buffer_load_dwordx4 v[72:75], v142, s[12:15], s34 offen
    buffer_load_dword v76, v143, s[12:15], s35 offen
    v_mov_b32 v159, v142
    s_mov_b32 m0, s28
    s_add_u32 s28, s28, 8192
    buffer_load_dwordx4 v159, s[12:15], s29 offen lds
    s_add_u32 s29, s29, 8192
    s_mov_b32 m0, s28
    s_add_u32 s28, s28, 8192
    buffer_load_dwordx4 v159, s[12:15], s29 offen lds
    s_add_u32 s29, s29, 8192
    s_mov_b32 m0, s28
    s_add_u32 s28, s28, 8192
    buffer_load_dwordx4 v159, s[12:15], s29 offen lds
    s_add_u32 s29, s29, 8192
    v_lshrrev_b32 v141, 5, v140
    v_bfe_u32 v145, v140, 2, 2
    v_add_u32 v147, 16, v145
    v_bfe_u32 v146, v140, 1, 1
    v_lshl_add_u32 v145, v145, 1, v146
    v_and_b32 v146, 1, v140
    v_lshl_add_u32 v145, v146, 3, v145
    v_and_b32 v146, 16, v140
    v_cmp_eq_u32 vcc, 0, v146
    s_nop 1
    v_cndmask_b32 v145, v147, v145, vcc
    v_mul_u32_u24 v144, 160, v141
    v_lshl_add_u32 v144, v145, 3, v144
    v_mov_b32 v16, 0
    v_mov_b32 v17, 0
    v_mov_b32 v18, 0
    v_mov_b32 v19, 0
    v_mov_b32 v20, 0
    v_mov_b32 v21, 0
    v_mov_b32 v22, 0
    v_mov_b32 v23, 0
    v_mov_b32 v24, 0
    v_mov_b32 v25, 0
    v_mov_b32 v26, 0
    v_mov_b32 v27, 0
    v_mov_b32 v28, 0
    v_mov_b32 v29, 0
    v_mov_b32 v30, 0
    v_mov_b32 v31, 0
    v_mov_b32 v77, 0
    s_lshl_b32 s32, s24, 8
    s_add_u32 s32, s32, s2
    s_lshl_b32 s41, s32, 10
    s_add_u32 s41, s41, 42336256
    v_lshl_add_u32 v171, v140, 4, s41
    v_mov_b32 v172, -1
    v_mov_b32 v173, -1
    v_mov_b32 v174, -1
    v_mov_b32 v175, -1
    s_min_u32 s41, s32, 1376
    s_cmp_lt_u32 s41, 648
    s_cbranch_scc0 attn_kernel_sh2
    s_mov_b64 s[16:17], s[44:45]
    s_mov_b32 s18, 5308416
    s_mov_b32 s20, 9216
    v_mov_b32 v152, s41
    v_mul_u32_u24 v153, 911, v152
    v_lshrrev_b32 v153, 13, v153
    v_mul_u32_u24 v155, 9, v153
    v_sub_u32 v155, v152, v155
    v_lshl_add_u32 v154, v155, 6, v140
    v_mul_u32_u24 v148, 73728, v153
    v_lshl_add_u32 v148, v154, 4, v148
    v_add_u32 v149, 36864, v148
    v_lshrrev_b32 v155, 2, v154
    v_mul_u32_u24 v156, 171, v155
    v_lshrrev_b32 v156, 10, v156
    v_mul_u32_u24 v157, 6, v156
    v_sub_u32 v155, v155, v157
    v_mul_u32_u24 v157, 11, v156
    v_lshrrev_b32 v157, 5, v157
    v_mul_u32_u24 v150, 1161216, v157
    v_mul_u32_u24 v156, 55296, v156
    v_add_u32 v150, v150, v156
    v_bfe_u32 v156, v154, 1, 1
    v_lshl_add_u32 v157, v155, 1, v156
    v_add_u32 v157, -8, v157
    v_cmp_gt_u32 vcc, 4, v155
    s_nop 1
    v_cndmask_b32 v157, v157, v155, vcc
    v_cndmask_b32 v156, 2, v156, vcc
    v_mul_u32_u24 v157, 331776, v157
    v_add_u32 v150, v150, v157
    v_lshl_add_u32 v150, v156, 10, v150
    v_lshrrev_b32 v155, 2, v153
    v_mul_u32_u24 v155, 3072, v155
    v_add_u32 v150, v150, v155
    v_and_b32 v155, 1, v154
    v_lshl_add_u32 v150, v155, 7, v150
    v_add_u32 v150, 12845056, v150
    v_mov_b32 v151, 64
    s_branch attn_kernel_sh9
attn_kernel_sh2:
    s_mov_b32 s20, 1152
    s_cmp_lt_u32 s41, 1296
    s_cbranch_scc0 attn_kernel_sh3
    s_mov_b64 s[16:17], s[46:47]
    s_mov_b32 s18, 5308416
    s_sub_u32 s41, s41, 648
    v_lshl_add_u32 v152, s41, 6, v140
    v_lshrrev_b32 v155, 3, v152
    v_mul_u32_u24 v153, 3641, v155
    v_lshrrev_b32 v153, 15, v153
    v_mul_u32_u24 v155, 72, v153
    v_sub_u32 v154, v152, v155
    v_lshrrev_b32 v155, 2, v153
    v_and_b32 v156, 3, v153
    v_lshl_add_u32 v156, v155, 3, v156
    v_mul_u32_u24 v148, 4608, v156
    v_lshl_add_u32 v148, v154, 4, v148
    v_add_u32 v149, 18432, v148
    v_mul_u32_u24 v156, 57, v155
    v_lshrrev_b32 v156, 10, v156
    v_mul_u32_u24 v150, 1271808, v156
    v_mul_u32_u24 v155, 3072, v155
    v_add_u32 v150, v150, v155
    v_mul_u32_u24 v155, 43, v154
    v_lshrrev_b32 v155, 8, v155
    v_mul_u32_u24 v156, 6, v155
    v_sub_u32 v156, v154, v156
    v_mul_u32_u24 v157, 11, v155
    v_lshrrev_b32 v157, 5, v157
    v_mul_u32_u24 v157, 165888, v157
    v_mul_u32_u24 v155, 55296, v155
    v_add3_u32 v150, v150, v155, v157
    v_lshlrev_b32 v155, 6, v156
    v_lshlrev_b32 v157, 7, v156
    v_add_u32 v157, 1536, v157
    v_cmp_gt_u32 vcc, 4, v156
    s_nop 1
    v_cndmask_b32 v155, v157, v155, vcc
    v_add_u32 v150, v150, v155
    v_add_u32 v150, 13010944, v150
    v_mov_b32 v155, 1024
    v_cndmask_b32 v151, 64, v155, vcc
    s_branch attn_kernel_sh9
attn_kernel_sh3:
    s_mov_b64 s[16:17], s[48:49]
    s_mov_b32 s18, 663552
    s_sub_u32 s41, s41, 1296
    v_lshl_add_u32 v152, s41, 6, v140
    v_lshrrev_b32 v155, 3, v152
    v_mul_u32_u24 v153, 3641, v155
    v_lshrrev_b32 v153, 15, v153
    v_mul_u32_u24 v155, 72, v153
    v_sub_u32 v154, v152, v155
    v_lshrrev_b32 v155, 2, v153
    v_mul_u32_u24 v156, 36, v155
    v_bfe_u32 v157, v153, 1, 1
    v_mad_u32_u24 v156, v157, 20, v156
    v_and_b32 v157, 1, v153
    v_lshl_add_u32 v156, v157, 3, v156
    v_mul_u32_u24 v157, 72, v153
    v_add_u32 v157, -4592, v157
    v_cmp_gt_u32 vcc, 64, v153
    s_nop 1
    v_cndmask_b32 v156, v157, v156, vcc
    v_cndmask_b32 v157, 36, 4, vcc
    v_mul_u32_u24 v148, 1152, v156
    v_lshl_add_u32 v148, v154, 4, v148
    v_mul_u32_u24 v157, 1152, v157
    v_add_u32 v149, v148, v157
    v_mul_u32_u24 v150, 5120, v155
    v_mul_u32_u24 v155, 57, v154
    v_lshrrev_b32 v155, 9, v155
    v_mul_u32_u24 v156, 9, v155
    v_sub_u32 v156, v154, v156
    v_mul_u32_u24 v155, 92160, v155
    v_lshrrev_b32 v157, 2, v156
    v_lshl_add_u32 v155, v157, 11, v155
    v_and_b32 v157, 3, v156
    v_lshl_add_u32 v155, v157, 6, v155
    v_add_u32 v150, v150, v155
    v_add_u32 v150, 9699328, v150
    v_cmp_gt_u32 vcc, 8, v156
    v_mov_b32 v155, 1024
    s_nop 0
    v_cndmask_b32 v151, 64, v155, vcc
attn_kernel_sh9:
    v_and_b32 v155, 3, v153
    v_lshl_add_u32 v150, v155, 8, v150
    v_add_u32 v151, v150, v151
    s_mov_b32 s19, 0x20000
    s_lshl_b32 s21, s20, 1
    s_add_u32 s22, s21, s20
    v_permlane32_swap_b32 v150, v151
    v_lshrrev_b32 v145, 3, v140
    v_lshlrev_b32 v145, 2, v145
    v_and_b32 v146, 4, v140
    v_lshl_add_u32 v145, v146, 5, v145
    ds_bpermute_b32 v160, v145, v150 offset:0
    ds_bpermute_b32 v161, v145, v150 offset:32
    ds_bpermute_b32 v162, v145, v150 offset:64
    ds_bpermute_b32 v163, v145, v150 offset:96
    ds_bpermute_b32 v164, v145, v151 offset:0
    ds_bpermute_b32 v165, v145, v151 offset:32
    ds_bpermute_b32 v166, v145, v151 offset:64
    ds_bpermute_b32 v167, v145, v151 offset:96
    v_and_b32 v146, 3, v140
    v_bfe_u32 v145, v140, 2, 2
    v_mul_u32_u24 v145, 1088, v145
    v_lshl_add_u32 v145, v146, 3, v145
    v_and_b32 v147, 48, v140
    v_lshl_add_u32 v145, v147, 1, v145
    s_mul_i32 s41, s24, 8704
    v_add_u32 v168, s41, v145
    s_waitcnt lgkmcnt(0)
    v_lshl_add_u32 v160, v146, 4, v160
    v_lshl_add_u32 v161, v146, 4, v161
    v_lshl_add_u32 v162, v146, 4, v162
    v_lshl_add_u32 v163, v146, 4, v163
    v_lshl_add_u32 v164, v146, 4, v164
    v_lshl_add_u32 v165, v146, 4, v165
    v_lshl_add_u32 v166, v146, 4, v166
    v_lshl_add_u32 v167, v146, 4, v167
    v_mov_b32 v89, 0
    v_mov_b32 v91, 0
    v_cmp_eq_u32 vcc, 0, v141
    s_waitcnt vmcnt(3)
    s_nop 0
    v_cndmask_b32 v76, 0, v76, vcc
    s_mov_b32 s31, 0
    s_waitcnt vmcnt(0)
    s_barrier
attn_kernel_main:
    v_mov_b32 v0, 0
    v_mov_b32 v1, 0
    v_mov_b32 v2, 0
    v_mov_b32 v3, 0
    v_mov_b32 v4, 0
    v_mov_b32 v5, 0
    v_mov_b32 v6, 0
    v_mov_b32 v7, 0
    v_mov_b32 v8, 0
    v_mov_b32 v9, 0
    v_mov_b32 v10, 0
    v_mov_b32 v11, 0
    v_mov_b32 v12, 0
    v_mov_b32 v13, 0
    v_mov_b32 v14, 0
    v_mov_b32 v15, 0
    ds_read_b128 v[80:83], v142 offset:0
    ds_read_b32 v88, v143 offset:1024
    ds_read_b128 v[84:87], v142 offset:2432
    ds_read_b32 v90, v143 offset:3456
    ds_read_b64_tr_b16 v[92:93], v144 offset:1152
    ds_read_b64_tr_b16 v[94:95], v144 offset:1472
    s_waitcnt lgkmcnt(4)
    v_mfma_f32_32x32x16_bf16 v[32:47], v[80:83], v[72:75], v[16:31]
    v_mfma_f32_32x32x8_bf16 v[32:47], v[88:89], v[76:77], v[32:47]
    s_mov_b32 s30, 0
    v_mov_b32 v68, 0
    v_mov_b32 v104, 0
    v_mov_b32 v69, 0
    v_mov_b32 v105, 0
    v_mov_b32 v70, 0
    v_mov_b32 v106, 0
    v_mov_b32 v71, 0
    v_mov_b32 v107, 0
    s_waitcnt lgkmcnt(0)
    s_nop 7
    s_nop 1
    s_cmp_lg_u32 s31, 0
    s_cbranch_scc1 attn_kernel_loop
attn_kernel_loopa:
    v_mfma_f32_32x32x16_bf16 v[48:63], v[84:87], v[72:75], v[16:31]
    s_setprio 3
    s_waitcnt lgkmcnt(3)
    ds_read_b128 v[80:83], v142 offset:4864
    ds_read_b64_tr_b16 v[96:97], v144 offset:1792
    v_exp_f32 v32, v32
    v_exp_f32 v33, v33
    v_exp_f32 v34, v34
    v_exp_f32 v35, v35
    v_cvt_pk_bf16_f32 v64, v32, v33
    v_cvt_pk_bf16_f32 v65, v34, v35
    v_mfma_f32_32x32x16_bf16 v[0:15], v[104:107], v[68:71], v[0:15]
    s_setprio 2
    s_waitcnt lgkmcnt(4)
    ds_read_b64_tr_b16 v[98:99], v144 offset:2112
    s_mov_b32 m0, s28
    s_add_u32 s28, s28, 8192
    buffer_load_dwordx4 v159, s[12:15], s29 offen lds
    s_add_u32 s29, s29, 8192
    v_exp_f32 v36, v36
    v_exp_f32 v37, v37
    v_exp_f32 v38, v38
    v_exp_f32 v39, v39
    v_cvt_pk_bf16_f32 v66, v36, v37
    v_cvt_pk_bf16_f32 v67, v38, v39
    v_mfma_f32_32x32x8_bf16 v[48:63], v[90:91], v[76:77], v[48:63]
    s_setprio 1
    s_waitcnt lgkmcnt(3)
    ds_read_b32 v88, v143 offset:5888
    ds_read_b64_tr_b16 v[100:101], v144 offset:3584
    v_exp_f32 v40, v40
    v_exp_f32 v41, v41
    v_exp_f32 v42, v42
    v_exp_f32 v43, v43
    v_cvt_pk_bf16_f32 v68, v40, v41
    v_cvt_pk_bf16_f32 v69, v42, v43
    v_mfma_f32_32x32x16_bf16 v[0:15], v[92:95], v[64:67], v[0:15]
    s_setprio 0
    s_waitcnt lgkmcnt(4)
    ds_read_b64_tr_b16 v[102:103], v144 offset:3904
    s_mov_b32 m0, s28
    s_add_u32 s28, s28, 8192
    buffer_load_dwordx4 v159, s[12:15], s29 offen lds
    s_add_u32 s29, s29, 8192
    v_exp_f32 v44, v44
    v_exp_f32 v45, v45
    v_exp_f32 v46, v46
    v_exp_f32 v47, v47
    v_cvt_pk_bf16_f32 v70, v44, v45
    v_cvt_pk_bf16_f32 v71, v46, v47
    v_mfma_f32_32x32x16_bf16 v[32:47], v[80:83], v[72:75], v[16:31]
    s_setprio 3
    s_waitcnt lgkmcnt(3)
    ds_read_b128 v[84:87], v142 offset:7296
    ds_read_b64_tr_b16 v[104:105], v144 offset:4224
    v_exp_f32 v48, v48
    v_exp_f32 v49, v49
    v_exp_f32 v50, v50
    v_exp_f32 v51, v51
    v_cvt_pk_bf16_f32 v64, v48, v49
    v_cvt_pk_bf16_f32 v65, v50, v51
    v_mfma_f32_32x32x16_bf16 v[0:15], v[96:99], v[68:71], v[0:15]
    s_setprio 2
    s_waitcnt lgkmcnt(4)
    ds_read_b64_tr_b16 v[106:107], v144 offset:4544
    s_mov_b32 m0, s28
    s_add_u32 s28, s28, 8192
    buffer_load_dwordx4 v159, s[12:15], s29 offen lds
    s_add_u32 s29, s29, 8192
    v_exp_f32 v52, v52
    v_exp_f32 v53, v53
    v_exp_f32 v54, v54
    v_exp_f32 v55, v55
    v_cvt_pk_bf16_f32 v66, v52, v53
    v_cvt_pk_bf16_f32 v67, v54, v55
    v_mfma_f32_32x32x8_bf16 v[32:47], v[88:89], v[76:77], v[32:47]
    s_setprio 1
    s_waitcnt lgkmcnt(3)
    ds_read_b32 v90, v143 offset:8320
    ds_read_b64_tr_b16 v[92:93], v144 offset:6016
    v_exp_f32 v56, v56
    v_exp_f32 v57, v57
    v_exp_f32 v58, v58
    v_exp_f32 v59, v59
    v_cvt_pk_bf16_f32 v68, v56, v57
    v_cvt_pk_bf16_f32 v69, v58, v59
    v_mfma_f32_32x32x16_bf16 v[0:15], v[100:103], v[64:67], v[0:15]
    s_setprio 0
    s_waitcnt lgkmcnt(4)
    ds_read_b64_tr_b16 v[94:95], v144 offset:6336
    s_mov_b32 m0, s28
    s_add_u32 s28, s28, 8192
    buffer_load_dwordx4 v159, s[12:15], s29 offen lds
    s_add_u32 s29, s29, 8192
    v_exp_f32 v60, v60
    v_exp_f32 v61, v61
    v_exp_f32 v62, v62
    v_exp_f32 v63, v63
    v_cvt_pk_bf16_f32 v70, v60, v61
    v_cvt_pk_bf16_f32 v71, v62, v63
    v_mfma_f32_32x32x16_bf16 v[48:63], v[84:87], v[72:75], v[16:31]
    s_setprio 3
    s_waitcnt lgkmcnt(3)
    ds_read_b128 v[80:83], v142 offset:9728
    ds_read_b64_tr_b16 v[96:97], v144 offset:6656
    v_exp_f32 v32, v32
    v_exp_f32 v33, v33
    v_exp_f32 v34, v34
    v_exp_f32 v35, v35
    v_cvt_pk_bf16_f32 v64, v32, v33
    v_cvt_pk_bf16_f32 v65, v34, v35
    v_mfma_f32_32x32x16_bf16 v[0:15], v[104:107], v[68:71], v[0:15]
    s_setprio 2
    s_waitcnt lgkmcnt(4)
    ds_read_b64_tr_b16 v[98:99], v144 offset:6976
    s_mov_b32 m0, s28
    s_add_u32 s28, s28, 8192
    buffer_load_dwordx4 v159, s[12:15], s29 offen lds
    s_add_u32 s29, s29, 8192
    v_exp_f32 v36, v36
    v_exp_f32 v37, v37
    v_exp_f32 v38, v38
    v_exp_f32 v39, v39
    v_cvt_pk_bf16_f32 v66, v36, v37
    v_cvt_pk_bf16_f32 v67, v38, v39
    v_mfma_f32_32x32x8_bf16 v[48:63], v[90:91], v[76:77], v[48:63]
    s_setprio 1
    s_waitcnt lgkmcnt(3)
    ds_read_b32 v88, v143 offset:10752
    ds_read_b64_tr_b16 v[100:101], v144 offset:8448
    v_exp_f32 v40, v40
    v_exp_f32 v41, v41
    v_exp_f32 v42, v42
    v_exp_f32 v43, v43
    v_cvt_pk_bf16_f32 v68, v40, v41
    v_cvt_pk_bf16_f32 v69, v42, v43
    v_mfma_f32_32x32x16_bf16 v[0:15], v[92:95], v[64:67], v[0:15]
    s_setprio 0
    s_waitcnt lgkmcnt(4)
    ds_read_b64_tr_b16 v[102:103], v144 offset:8768
    s_mov_b32 m0, s28
    s_add_u32 s28, s28, 8192
    buffer_load_dwordx4 v159, s[12:15], s29 offen lds
    s_add_u32 s29, s29, 8192
    v_exp_f32 v44, v44
    v_exp_f32 v45, v45
    v_exp_f32 v46, v46
    v_exp_f32 v47, v47
    v_cvt_pk_bf16_f32 v70, v44, v45
    v_cvt_pk_bf16_f32 v71, v46, v47
    v_mfma_f32_32x32x16_bf16 v[32:47], v[80:83], v[72:75], v[16:31]
    s_setprio 3
    s_waitcnt lgkmcnt(3)
    ds_read_b128 v[84:87], v142 offset:12160
    ds_read_b64_tr_b16 v[104:105], v144 offset:9088
    v_exp_f32 v48, v48
    v_exp_f32 v49, v49
    v_exp_f32 v50, v50
    v_exp_f32 v51, v51
    v_cvt_pk_bf16_f32 v64, v48, v49
    v_cvt_pk_bf16_f32 v65, v50, v51
    v_mfma_f32_32x32x16_bf16 v[0:15], v[96:99], v[68:71], v[0:15]
    s_setprio 2
    s_waitcnt lgkmcnt(4)
    ds_read_b64_tr_b16 v[106:107], v144 offset:9408
    s_mov_b32 m0, s28
    s_add_u32 s28, s28, 8192
    buffer_load_dwordx4 v159, s[12:15], s29 offen lds
    s_add_u32 s29, s29, 8192
    v_exp_f32 v52, v52
    v_exp_f32 v53, v53
    v_exp_f32 v54, v54
    v_exp_f32 v55, v55
    v_cvt_pk_bf16_f32 v66, v52, v53
    v_cvt_pk_bf16_f32 v67, v54, v55
    v_mfma_f32_32x32x8_bf16 v[32:47], v[88:89], v[76:77], v[32:47]
    s_setprio 1
    s_waitcnt lgkmcnt(3)
    ds_read_b32 v90, v143 offset:13184
    ds_read_b64_tr_b16 v[92:93], v144 offset:10880
    v_exp_f32 v56, v56
    v_exp_f32 v57, v57
    v_exp_f32 v58, v58
    v_exp_f32 v59, v59
    v_cvt_pk_bf16_f32 v68, v56, v57
    v_cvt_pk_bf16_f32 v69, v58, v59
    v_mfma_f32_32x32x16_bf16 v[0:15], v[100:103], v[64:67], v[0:15]
    s_setprio 0
    s_waitcnt lgkmcnt(4)
    ds_read_b64_tr_b16 v[94:95], v144 offset:11200
    s_mov_b32 m0, s28
    s_add_u32 s28, s28, 8192
    buffer_load_dwordx4 v159, s[12:15], s29 offen lds
    s_add_u32 s29, s29, 8192
    s_add_u32 s30, s30, 4
    v_exp_f32 v60, v60
    v_exp_f32 v61, v61
    v_exp_f32 v62, v62
    v_exp_f32 v63, v63
    v_cvt_pk_bf16_f32 v70, v60, v61
    v_cvt_pk_bf16_f32 v71, v62, v63
    v_add_u32 v142, 9728, v142
    v_add_u32 v143, 9728, v143
    v_add_u32 v144, 9728, v144
    s_cmp_lt_u32 s30, 8
    s_cbranch_scc1 attn_kernel_loopa
    s_waitcnt vmcnt(8)
    s_barrier
    s_mov_b32 s40, 24
.p2align 6
attn_kernel_loop:
    v_mfma_f32_32x32x16_bf16 v[48:63], v[84:87], v[72:75], v[16:31]
    s_setprio 3
    s_waitcnt lgkmcnt(3)
    ds_read_b128 v[80:83], v142 offset:4864
    ds_read_b64_tr_b16 v[96:97], v144 offset:1792
    v_exp_f32 v32, v32
    v_exp_f32 v33, v33
    v_exp_f32 v34, v34
    v_exp_f32 v35, v35
    v_cvt_pk_bf16_f32 v64, v32, v33
    v_cvt_pk_bf16_f32 v65, v34, v35
    v_mfma_f32_32x32x16_bf16 v[0:15], v[104:107], v[68:71], v[0:15]
    s_setprio 2
    s_waitcnt lgkmcnt(4)
    ds_read_b64_tr_b16 v[98:99], v144 offset:2112
    v_exp_f32 v36, v36
    v_exp_f32 v37, v37
    v_exp_f32 v38, v38
    v_exp_f32 v39, v39
    v_cvt_pk_bf16_f32 v66, v36, v37
    v_cvt_pk_bf16_f32 v67, v38, v39
    v_mfma_f32_32x32x8_bf16 v[48:63], v[90:91], v[76:77], v[48:63]
    s_setprio 1
    s_waitcnt lgkmcnt(3)
    ds_read_b32 v88, v143 offset:5888
    ds_read_b64_tr_b16 v[100:101], v144 offset:3584
    v_exp_f32 v40, v40
    v_exp_f32 v41, v41
    v_exp_f32 v42, v42
    v_exp_f32 v43, v43
    v_cvt_pk_bf16_f32 v68, v40, v41
    v_cvt_pk_bf16_f32 v69, v42, v43
    v_mfma_f32_32x32x16_bf16 v[0:15], v[92:95], v[64:67], v[0:15]
    s_setprio 0
    s_waitcnt lgkmcnt(4)
    ds_read_b64_tr_b16 v[102:103], v144 offset:3904
    v_exp_f32 v44, v44
    v_exp_f32 v45, v45
    v_exp_f32 v46, v46
    v_exp_f32 v47, v47
    v_cvt_pk_bf16_f32 v70, v44, v45
    v_cvt_pk_bf16_f32 v71, v46, v47
    v_mfma_f32_32x32x16_bf16 v[32:47], v[80:83], v[72:75], v[16:31]
    s_setprio 3
    s_waitcnt lgkmcnt(3)
    ds_read_b128 v[84:87], v142 offset:7296
    ds_read_b64_tr_b16 v[104:105], v144 offset:4224
    v_exp_f32 v48, v48
    v_exp_f32 v49, v49
    v_exp_f32 v50, v50
    v_exp_f32 v51, v51
    v_cvt_pk_bf16_f32 v64, v48, v49
    v_cvt_pk_bf16_f32 v65, v50, v51
    v_mfma_f32_32x32x16_bf16 v[0:15], v[96:99], v[68:71], v[0:15]
    s_setprio 2
    s_waitcnt lgkmcnt(4)
    ds_read_b64_tr_b16 v[106:107], v144 offset:4544
    v_exp_f32 v52, v52
    v_exp_f32 v53, v53
    v_exp_f32 v54, v54
    v_exp_f32 v55, v55
    v_cvt_pk_bf16_f32 v66, v52, v53
    v_cvt_pk_bf16_f32 v67, v54, v55
    v_mfma_f32_32x32x8_bf16 v[32:47], v[88:89], v[76:77], v[32:47]
    s_setprio 1
    s_waitcnt lgkmcnt(3)
    ds_read_b32 v90, v143 offset:8320
    ds_read_b64_tr_b16 v[92:93], v144 offset:6016
    v_exp_f32 v56, v56
    v_exp_f32 v57, v57
    v_exp_f32 v58, v58
    v_exp_f32 v59, v59
    v_cvt_pk_bf16_f32 v68, v56, v57
    v_cvt_pk_bf16_f32 v69, v58, v59
    v_mfma_f32_32x32x16_bf16 v[0:15], v[100:103], v[64:67], v[0:15]
    s_setprio 0
    s_waitcnt lgkmcnt(4)
    ds_read_b64_tr_b16 v[94:95], v144 offset:6336
    v_exp_f32 v60, v60
    v_exp_f32 v61, v61
    v_exp_f32 v62, v62
    v_exp_f32 v63, v63
    v_cvt_pk_bf16_f32 v70, v60, v61
    v_cvt_pk_bf16_f32 v71, v62, v63
    v_mfma_f32_32x32x16_bf16 v[48:63], v[84:87], v[72:75], v[16:31]
    s_setprio 3
    s_waitcnt lgkmcnt(3)
    ds_read_b128 v[80:83], v142 offset:9728
    ds_read_b64_tr_b16 v[96:97], v144 offset:6656
    v_exp_f32 v32, v32
    v_exp_f32 v33, v33
    v_exp_f32 v34, v34
    v_exp_f32 v35, v35
    v_cvt_pk_bf16_f32 v64, v32, v33
    v_cvt_pk_bf16_f32 v65, v34, v35
    v_mfma_f32_32x32x16_bf16 v[0:15], v[104:107], v[68:71], v[0:15]
    s_setprio 2
    s_waitcnt lgkmcnt(4)
    ds_read_b64_tr_b16 v[98:99], v144 offset:6976
    v_exp_f32 v36, v36
    v_exp_f32 v37, v37
    v_exp_f32 v38, v38
    v_exp_f32 v39, v39
    v_cvt_pk_bf16_f32 v66, v36, v37
    v_cvt_pk_bf16_f32 v67, v38, v39
    v_mfma_f32_32x32x8_bf16 v[48:63], v[90:91], v[76:77], v[48:63]
    s_setprio 1
    s_waitcnt lgkmcnt(3)
    ds_read_b32 v88, v143 offset:10752
    ds_read_b64_tr_b16 v[100:101], v144 offset:8448
    v_exp_f32 v40, v40
    v_exp_f32 v41, v41
    v_exp_f32 v42, v42
    v_exp_f32 v43, v43
    v_cvt_pk_bf16_f32 v68, v40, v41
    v_cvt_pk_bf16_f32 v69, v42, v43
    v_mfma_f32_32x32x16_bf16 v[0:15], v[92:95], v[64:67], v[0:15]
    s_setprio 0
    s_waitcnt lgkmcnt(4)
    ds_read_b64_tr_b16 v[102:103], v144 offset:8768
    v_exp_f32 v44, v44
    v_exp_f32 v45, v45
    v_exp_f32 v46, v46
    v_exp_f32 v47, v47
    v_cvt_pk_bf16_f32 v70, v44, v45
    v_cvt_pk_bf16_f32 v71, v46, v47
    v_mfma_f32_32x32x16_bf16 v[32:47], v[80:83], v[72:75], v[16:31]
    s_setprio 3
    s_waitcnt lgkmcnt(3)
    ds_read_b128 v[84:87], v142 offset:12160
    ds_read_b64_tr_b16 v[104:105], v144 offset:9088
    v_exp_f32 v48, v48
    v_exp_f32 v49, v49
    v_exp_f32 v50, v50
    v_exp_f32 v51, v51
    v_cvt_pk_bf16_f32 v64, v48, v49
    v_cvt_pk_bf16_f32 v65, v50, v51
    v_mfma_f32_32x32x16_bf16 v[0:15], v[96:99], v[68:71], v[0:15]
    s_setprio 2
    s_waitcnt lgkmcnt(4)
    ds_read_b64_tr_b16 v[106:107], v144 offset:9408
    v_exp_f32 v52, v52
    v_exp_f32 v53, v53
    v_exp_f32 v54, v54
    v_exp_f32 v55, v55
    v_cvt_pk_bf16_f32 v66, v52, v53
    v_cvt_pk_bf16_f32 v67, v54, v55
    v_mfma_f32_32x32x8_bf16 v[32:47], v[88:89], v[76:77], v[32:47]
    s_setprio 1
    s_waitcnt lgkmcnt(3)
    ds_read_b32 v90, v143 offset:13184
    ds_read_b64_tr_b16 v[92:93], v144 offset:10880
    v_exp_f32 v56, v56
    v_exp_f32 v57, v57
    v_exp_f32 v58, v58
    v_exp_f32 v59, v59
    v_cvt_pk_bf16_f32 v68, v56, v57
    v_cvt_pk_bf16_f32 v69, v58, v59
    v_mfma_f32_32x32x16_bf16 v[0:15], v[100:103], v[64:67], v[0:15]
    s_setprio 0
    s_waitcnt lgkmcnt(4)
    ds_read_b64_tr_b16 v[94:95], v144 offset:11200
    s_add_u32 s30, s30, 4
    v_exp_f32 v60, v60
    v_exp_f32 v61, v61
    v_exp_f32 v62, v62
    v_exp_f32 v63, v63
    v_cvt_pk_bf16_f32 v70, v60, v61
    v_cvt_pk_bf16_f32 v71, v62, v63
    v_add_u32 v142, 9728, v142
    v_add_u32 v143, 9728, v143
    v_add_u32 v144, 9728, v144
attn_kernel_chk:
    s_cmp_lg_u32 s30, s40
    s_cbranch_scc1 attn_kernel_loop
    s_cmp_lg_u32 s30, 64
    s_cbranch_scc1 attn_kernel_x2
    s_waitcnt lgkmcnt(0)
    v_mfma_f32_32x32x16_bf16 v[0:15], v[104:107], v[68:71], v[0:15]
    s_nop 7
    s_nop 7
    s_nop 3
    v_add_f32 v145, |v0|, |v1|
    v_add_f32 v145, v145, |v2|
    v_add_f32 v145, v145, |v3|
    v_add_f32 v145, v145, |v4|
    v_add_f32 v145, v145, |v5|
    v_add_f32 v145, v145, |v6|
    v_add_f32 v145, v145, |v7|
    v_add_f32 v145, v145, |v8|
    v_add_f32 v145, v145, |v9|
    v_cmp_gt_f32 vcc, 0x7e800000, v145
    s_mov_b64 s[34:35], vcc
    v_cmp_le_f32 vcc, 0x21800000, v10
    s_and_b64 s[34:35], s[34:35], vcc
    v_cmp_ge_f32 vcc, 0x5d800000, v10
    s_and_b64 s[34:35], s[34:35], vcc
    s_cmp_eq_u64 s[34:35], -1
    s_cbranch_scc1 attn_kernel_fin
    s_cmp_eq_u32 s31, 0x100
    s_cbranch_scc1 attn_kernel_fin
    s_mov_b32 s31, 0x100
    s_barrier
    s_mul_i32 s29, s25, 155648
    s_add_u32 s29, s29, 2359296
    s_mov_b32 s28, 0
attn_kernel_rl:
    s_mov_b32 m0, s28
    s_add_u32 s28, s28, 1024
    buffer_load_dwordx4 v159, s[12:15], s29 offen lds
    s_add_u32 s29, s29, 1024
    s_cmp_lt_u32 s28, 52224
    s_cbranch_scc1 attn_kernel_rl
    s_waitcnt vmcnt(0)
    v_mov_b32 v145, 0xff800000
    s_mov_b32 s30, 0
attn_kernel_mx:
    v_add_u32 v142, -2432, v142
    v_add_u32 v143, -2432, v143
    ds_read_b128 v[80:83], v142 offset:0
    ds_read_b32 v88, v143 offset:1024
    s_waitcnt lgkmcnt(0)
    v_mfma_f32_32x32x16_bf16 v[32:47], v[80:83], v[72:75], v[16:31]
    v_mfma_f32_32x32x8_bf16 v[32:47], v[88:89], v[76:77], v[32:47]
    s_nop 7
    s_nop 3
    v_max3_f32 v145, v145, v32, v33
    v_max3_f32 v145, v145, v34, v35
    v_max3_f32 v145, v145, v36, v37
    v_max3_f32 v145, v145, v38, v39
    v_max3_f32 v145, v145, v40, v41
    v_max3_f32 v145, v145, v42, v43
    v_max3_f32 v145, v145, v44, v45
    v_max3_f32 v145, v145, v46, v47
    s_add_u32 s30, s30, 1
    s_cmp_lt_u32 s30, 64
    s_cbranch_scc1 attn_kernel_mx
    v_add_u32 v144, -155648, v144
    v_mov_b32 v146, v145
    s_nop 1
    v_permlane32_swap_b32 v145, v146
    v_max_f32 v145, v145, v146
    v_sub_f32 v16, 0, v145
    v_sub_f32 v17, 0, v145
    v_sub_f32 v18, 0, v145
    v_sub_f32 v19, 0, v145
    v_sub_f32 v20, 0, v145
    v_sub_f32 v21, 0, v145
    v_sub_f32 v22, 0, v145
    v_sub_f32 v23, 0, v145
    v_sub_f32 v24, 0, v145
    v_sub_f32 v25, 0, v145
    v_sub_f32 v26, 0, v145
    v_sub_f32 v27, 0, v145
    v_sub_f32 v28, 0, v145
    v_sub_f32 v29, 0, v145
    v_sub_f32 v30, 0, v145
    v_sub_f32 v31, 0, v145
    s_branch attn_kernel_main
attn_kernel_fin:
    v_rcp_f32 v145, v10
    v_and_b32 v146, 31, v140
    v_lshlrev_b32 v147, 4, v146
    v_and_b32 v146, 16, v140
    v_lshl_add_u32 v146, v146, 4, v147
    v_lshl_add_u32 v146, v141, 8, v146
    s_lshl_b32 s27, s25, 6
    s_add_u32 s27, s27, s26
    s_lshl_b32 s34, s27, 10
    s_add_u32 s34, s34, 7340032
    s_lshr_b32 s35, s25, 2
    s_lshl_b32 s35, s35, 6
    s_add_u32 s35, s35, s26
    s_lshl_b32 s35, s35, 7
    s_and_b32 s27, s25, 3
    s_add_u32 s35, s35, s27
    s_lshl_b32 s35, s35, 2
    s_add_u32 s35, s35, 9437184
    v_mul_f32 v0, v145, v0
    v_mul_f32 v1, v145, v1
    v_mul_f32 v2, v145, v2
    v_mul_f32 v3, v145, v3
    v_mul_f32 v4, v145, v4
    v_mul_f32 v5, v145, v5
    v_mul_f32 v6, v145, v6
    v_mul_f32 v7, v145, v7
    v_mul_f32 v8, v145, v8
    v_mul_f32 v9, v145, v9
    v_cvt_pk_bf16_f32 v64, v0, v1
    v_cvt_pk_bf16_f32 v65, v2, v3
    v_cvt_pk_bf16_f32 v66, v4, v5
    v_cvt_pk_bf16_f32 v67, v6, v7
    v_cvt_pk_bf16_f32 v68, v8, v9
    buffer_store_dwordx4 v[64:67], v146, s[12:15], s34 offen
    s_mov_b32 exec_hi, 0
    buffer_store_dword v68, v147, s[12:15], s35 offen
    s_mov_b32 exec_hi, -1
attn_kernel_end:
    s_endpgm
attn_kernel_x2:
    s_mov_b32 s40, 64
    s_cmp_eq_u32 s30, 24
    s_cbranch_scc0 attn_kernel_x5
    s_waitcnt vmcnt(0) lgkmcnt(0)
    s_barrier
    buffer_store_dwordx4 v[172:175], v171, s[56:59], 0 offen sc1
    v_add_u32 v171, 0x200000, v171
    buffer_store_dwordx4 v[172:175], v171, s[56:59], 0 offen sc1
    s_cmp_lt_u32 s32, 1377
    s_cbranch_scc0 attn_kernel_loop
    s_lshl_b32 s27, s24, 2
    s_lshr_b32 s42, 12447179, s27
    s_and_b32 s42, s42, 15
    s_lshl_b32 s42, s42, 2
    s_lshr_b32 s40, 6784886, s27
    s_and_b32 s40, s40, 15
    s_lshl_b32 s40, s40, 2
    s_cmp_lg_u32 s30, s40
    s_cbranch_scc1 attn_kernel_loop
attn_kernel_x4:
    s_mov_b32 s40, s42
    v_mfma_f32_32x32x16_bf16 v[48:63], v[84:87], v[72:75], v[16:31]
    s_setprio 3
    s_waitcnt lgkmcnt(3)
    ds_read_b128 v[80:83], v142 offset:4864
    ds_read_b64_tr_b16 v[96:97], v144 offset:1792
    v_exp_f32 v32, v32
    v_exp_f32 v33, v33
    v_exp_f32 v34, v34
    v_exp_f32 v35, v35
    v_cvt_pk_bf16_f32 v64, v32, v33
    v_cvt_pk_bf16_f32 v65, v34, v35
    v_mfma_f32_32x32x16_bf16 v[0:15], v[104:107], v[68:71], v[0:15]
    s_setprio 2
    s_waitcnt lgkmcnt(4)
    ds_read_b64_tr_b16 v[98:99], v144 offset:2112
    s_mov_b32 m0, s41
    s_add_u32 s41, s41, 1088
    buffer_load_dwordx4 v148, s[16:19], 0 offen lds
    v_exp_f32 v36, v36
    v_exp_f32 v37, v37
    v_exp_f32 v38, v38
    v_exp_f32 v39, v39
    v_cvt_pk_bf16_f32 v66, v36, v37
    v_cvt_pk_bf16_f32 v67, v38, v39
    v_mfma_f32_32x32x8_bf16 v[48:63], v[90:91], v[76:77], v[48:63]
    s_setprio 1
    s_waitcnt lgkmcnt(3)
    ds_read_b32 v88, v143 offset:5888
    ds_read_b64_tr_b16 v[100:101], v144 offset:3584
    v_exp_f32 v40, v40
    v_exp_f32 v41, v41
    v_exp_f32 v42, v42
    v_exp_f32 v43, v43
    v_cvt_pk_bf16_f32 v68, v40, v41
    v_cvt_pk_bf16_f32 v69, v42, v43
    v_mfma_f32_32x32x16_bf16 v[0:15], v[92:95], v[64:67], v[0:15]
    s_setprio 0
    s_waitcnt lgkmcnt(4)
    ds_read_b64_tr_b16 v[102:103], v144 offset:3904
    s_mov_b32 m0, s41
    s_add_u32 s41, s41, 1088
    buffer_load_dwordx4 v148, s[16:19], s20 offen lds
    v_exp_f32 v44, v44
    v_exp_f32 v45, v45
    v_exp_f32 v46, v46
    v_exp_f32 v47, v47
    v_cvt_pk_bf16_f32 v70, v44, v45
    v_cvt_pk_bf16_f32 v71, v46, v47
    v_mfma_f32_32x32x16_bf16 v[32:47], v[80:83], v[72:75], v[16:31]
    s_setprio 3
    s_waitcnt lgkmcnt(3)
    ds_read_b128 v[84:87], v142 offset:7296
    ds_read_b64_tr_b16 v[104:105], v144 offset:4224
    v_exp_f32 v48, v48
    v_exp_f32 v49, v49
    v_exp_f32 v50, v50
    v_exp_f32 v51, v51
    v_cvt_pk_bf16_f32 v64, v48, v49
    v_cvt_pk_bf16_f32 v65, v50, v51
    v_mfma_f32_32x32x16_bf16 v[0:15], v[96:99], v[68:71], v[0:15]
    s_setprio 2
    s_waitcnt lgkmcnt(4)
    ds_read_b64_tr_b16 v[106:107], v144 offset:4544
    s_mov_b32 m0, s41
    s_add_u32 s41, s41, 1088
    buffer_load_dwordx4 v148, s[16:19], s21 offen lds
    v_exp_f32 v52, v52
    v_exp_f32 v53, v53
    v_exp_f32 v54, v54
    v_exp_f32 v55, v55
    v_cvt_pk_bf16_f32 v66, v52, v53
    v_cvt_pk_bf16_f32 v67, v54, v55
    v_mfma_f32_32x32x8_bf16 v[32:47], v[88:89], v[76:77], v[32:47]
    s_setprio 1
    s_waitcnt lgkmcnt(3)
    ds_read_b32 v90, v143 offset:8320
    ds_read_b64_tr_b16 v[92:93], v144 offset:6016
    v_exp_f32 v56, v56
    v_exp_f32 v57, v57
    v_exp_f32 v58, v58
    v_exp_f32 v59, v59
    v_cvt_pk_bf16_f32 v68, v56, v57
    v_cvt_pk_bf16_f32 v69, v58, v59
    v_mfma_f32_32x32x16_bf16 v[0:15], v[100:103], v[64:67], v[0:15]
    s_setprio 0
    s_waitcnt lgkmcnt(4)
    ds_read_b64_tr_b16 v[94:95], v144 offset:6336
    s_mov_b32 m0, s41
    s_add_u32 s41, s41, 1088
    buffer_load_dwordx4 v148, s[16:19], s22 offen lds
    v_exp_f32 v60, v60
    v_exp_f32 v61, v61
    v_exp_f32 v62, v62
    v_exp_f32 v63, v63
    v_cvt_pk_bf16_f32 v70, v60, v61
    v_cvt_pk_bf16_f32 v71, v62, v63
    v_mfma_f32_32x32x16_bf16 v[48:63], v[84:87], v[72:75], v[16:31]
    s_setprio 3
    s_waitcnt lgkmcnt(3)
    ds_read_b128 v[80:83], v142 offset:9728
    ds_read_b64_tr_b16 v[96:97], v144 offset:6656
    v_exp_f32 v32, v32
    v_exp_f32 v33, v33
    v_exp_f32 v34, v34
    v_exp_f32 v35, v35
    v_cvt_pk_bf16_f32 v64, v32, v33
    v_cvt_pk_bf16_f32 v65, v34, v35
    v_mfma_f32_32x32x16_bf16 v[0:15], v[104:107], v[68:71], v[0:15]
    s_setprio 2
    s_waitcnt lgkmcnt(4)
    ds_read_b64_tr_b16 v[98:99], v144 offset:6976
    s_mov_b32 m0, s41
    s_add_u32 s41, s41, 1088
    buffer_load_dwordx4 v149, s[16:19], 0 offen lds
    v_exp_f32 v36, v36
    v_exp_f32 v37, v37
    v_exp_f32 v38, v38
    v_exp_f32 v39, v39
    v_cvt_pk_bf16_f32 v66, v36, v37
    v_cvt_pk_bf16_f32 v67, v38, v39
    v_mfma_f32_32x32x8_bf16 v[48:63], v[90:91], v[76:77], v[48:63]
    s_setprio 1
    s_waitcnt lgkmcnt(3)
    ds_read_b32 v88, v143 offset:10752
    ds_read_b64_tr_b16 v[100:101], v144 offset:8448
    v_exp_f32 v40, v40
    v_exp_f32 v41, v41
    v_exp_f32 v42, v42
    v_exp_f32 v43, v43
    v_cvt_pk_bf16_f32 v68, v40, v41
    v_cvt_pk_bf16_f32 v69, v42, v43
    v_mfma_f32_32x32x16_bf16 v[0:15], v[92:95], v[64:67], v[0:15]
    s_setprio 0
    s_waitcnt lgkmcnt(4)
    ds_read_b64_tr_b16 v[102:103], v144 offset:8768
    s_mov_b32 m0, s41
    s_add_u32 s41, s41, 1088
    buffer_load_dwordx4 v149, s[16:19], s20 offen lds
    v_exp_f32 v44, v44
    v_exp_f32 v45, v45
    v_exp_f32 v46, v46
    v_exp_f32 v47, v47
    v_cvt_pk_bf16_f32 v70, v44, v45
    v_cvt_pk_bf16_f32 v71, v46, v47
    v_mfma_f32_32x32x16_bf16 v[32:47], v[80:83], v[72:75], v[16:31]
    s_setprio 3
    s_waitcnt lgkmcnt(3)
    ds_read_b128 v[84:87], v142 offset:12160
    ds_read_b64_tr_b16 v[104:105], v144 offset:9088
    v_exp_f32 v48, v48
    v_exp_f32 v49, v49
    v_exp_f32 v50, v50
    v_exp_f32 v51, v51
    v_cvt_pk_bf16_f32 v64, v48, v49
    v_cvt_pk_bf16_f32 v65, v50, v51
    v_mfma_f32_32x32x16_bf16 v[0:15], v[96:99], v[68:71], v[0:15]
    s_setprio 2
    s_waitcnt lgkmcnt(4)
    ds_read_b64_tr_b16 v[106:107], v144 offset:9408
    s_mov_b32 m0, s41
    s_add_u32 s41, s41, 1088
    buffer_load_dwordx4 v149, s[16:19], s21 offen lds
    v_exp_f32 v52, v52
    v_exp_f32 v53, v53
    v_exp_f32 v54, v54
    v_exp_f32 v55, v55
    v_cvt_pk_bf16_f32 v66, v52, v53
    v_cvt_pk_bf16_f32 v67, v54, v55
    v_mfma_f32_32x32x8_bf16 v[32:47], v[88:89], v[76:77], v[32:47]
    s_setprio 1
    s_waitcnt lgkmcnt(3)
    ds_read_b32 v90, v143 offset:13184
    ds_read_b64_tr_b16 v[92:93], v144 offset:10880
    v_exp_f32 v56, v56
    v_exp_f32 v57, v57
    v_exp_f32 v58, v58
    v_exp_f32 v59, v59
    v_cvt_pk_bf16_f32 v68, v56, v57
    v_cvt_pk_bf16_f32 v69, v58, v59
    v_mfma_f32_32x32x16_bf16 v[0:15], v[100:103], v[64:67], v[0:15]
    s_setprio 0
    s_waitcnt lgkmcnt(4)
    ds_read_b64_tr_b16 v[94:95], v144 offset:11200
    s_mov_b32 m0, s41
    s_add_u32 s41, s41, 1088
    buffer_load_dwordx4 v149, s[16:19], s22 offen lds
    s_add_u32 s30, s30, 4
    v_exp_f32 v60, v60
    v_exp_f32 v61, v61
    v_exp_f32 v62, v62
    v_exp_f32 v63, v63
    v_cvt_pk_bf16_f32 v70, v60, v61
    v_cvt_pk_bf16_f32 v71, v62, v63
    v_add_u32 v142, 9728, v142
    v_add_u32 v143, 9728, v143
    v_add_u32 v144, 9728, v144
    s_branch attn_kernel_loop
attn_kernel_x5:
    s_cmp_lg_u32 s30, s42
    s_cbranch_scc1 attn_kernel_x4
    s_waitcnt vmcnt(0) lgkmcnt(0)
    ds_read_b64_tr_b16 v[108:109], v168 offset:0
    ds_read_b64_tr_b16 v[110:111], v168 offset:4352
    ds_read_b64_tr_b16 v[112:113], v168 offset:128
    ds_read_b64_tr_b16 v[114:115], v168 offset:4480
    ds_read_b64_tr_b16 v[116:117], v168 offset:256
    ds_read_b64_tr_b16 v[118:119], v168 offset:4608
    ds_read_b64_tr_b16 v[120:121], v168 offset:384
    ds_read_b64_tr_b16 v[122:123], v168 offset:4736
    ds_read_b64_tr_b16 v[124:125], v168 offset:512
    ds_read_b64_tr_b16 v[126:127], v168 offset:4864
    ds_read_b64_tr_b16 v[128:129], v168 offset:640
    ds_read_b64_tr_b16 v[130:131], v168 offset:4992
    ds_read_b64_tr_b16 v[132:133], v168 offset:768
    ds_read_b64_tr_b16 v[134:135], v168 offset:5120
    s_waitcnt lgkmcnt(8)
    ds_read_b64_tr_b16 v[136:137], v168 offset:896
    ds_read_b64_tr_b16 v[138:139], v168 offset:5248
    v_mfma_f32_32x32x16_bf16 v[48:63], v[84:87], v[72:75], v[16:31]
    s_setprio 3
    s_waitcnt lgkmcnt(3)
    ds_read_b128 v[80:83], v142 offset:4864
    ds_read_b64_tr_b16 v[96:97], v144 offset:1792
    v_exp_f32 v32, v32
    v_exp_f32 v33, v33
    v_exp_f32 v34, v34
    v_exp_f32 v35, v35
    v_cvt_pk_bf16_f32 v64, v32, v33
    v_cvt_pk_bf16_f32 v65, v34, v35
    v_mfma_f32_32x32x16_bf16 v[0:15], v[104:107], v[68:71], v[0:15]
    s_setprio 2
    s_waitcnt lgkmcnt(4)
    ds_read_b64_tr_b16 v[98:99], v144 offset:2112
    buffer_store_dwordx4 v[108:111], v160, s[12:15], 0 offen sc1
    v_exp_f32 v36, v36
    v_exp_f32 v37, v37
    v_exp_f32 v38, v38
    v_exp_f32 v39, v39
    v_cvt_pk_bf16_f32 v66, v36, v37
    v_cvt_pk_bf16_f32 v67, v38, v39
    v_mfma_f32_32x32x8_bf16 v[48:63], v[90:91], v[76:77], v[48:63]
    s_setprio 1
    s_waitcnt lgkmcnt(3)
    ds_read_b32 v88, v143 offset:5888
    ds_read_b64_tr_b16 v[100:101], v144 offset:3584
    v_exp_f32 v40, v40
    v_exp_f32 v41, v41
    v_exp_f32 v42, v42
    v_exp_f32 v43, v43
    v_cvt_pk_bf16_f32 v68, v40, v41
    v_cvt_pk_bf16_f32 v69, v42, v43
    v_mfma_f32_32x32x16_bf16 v[0:15], v[92:95], v[64:67], v[0:15]
    s_setprio 0
    s_waitcnt lgkmcnt(4)
    ds_read_b64_tr_b16 v[102:103], v144 offset:3904
    buffer_store_dwordx4 v[112:115], v161, s[12:15], 0 offen sc1
    v_exp_f32 v44, v44
    v_exp_f32 v45, v45
    v_exp_f32 v46, v46
    v_exp_f32 v47, v47
    v_cvt_pk_bf16_f32 v70, v44, v45
    v_cvt_pk_bf16_f32 v71, v46, v47
    v_mfma_f32_32x32x16_bf16 v[32:47], v[80:83], v[72:75], v[16:31]
    s_setprio 3
    s_waitcnt lgkmcnt(3)
    ds_read_b128 v[84:87], v142 offset:7296
    ds_read_b64_tr_b16 v[104:105], v144 offset:4224
    v_exp_f32 v48, v48
    v_exp_f32 v49, v49
    v_exp_f32 v50, v50
    v_exp_f32 v51, v51
    v_cvt_pk_bf16_f32 v64, v48, v49
    v_cvt_pk_bf16_f32 v65, v50, v51
    v_mfma_f32_32x32x16_bf16 v[0:15], v[96:99], v[68:71], v[0:15]
    s_setprio 2
    s_waitcnt lgkmcnt(4)
    ds_read_b64_tr_b16 v[106:107], v144 offset:4544
    buffer_store_dwordx4 v[116:119], v162, s[12:15], 0 offen sc1
    v_exp_f32 v52, v52
    v_exp_f32 v53, v53
    v_exp_f32 v54, v54
    v_exp_f32 v55, v55
    v_cvt_pk_bf16_f32 v66, v52, v53
    v_cvt_pk_bf16_f32 v67, v54, v55
    v_mfma_f32_32x32x8_bf16 v[32:47], v[88:89], v[76:77], v[32:47]
    s_setprio 1
    s_waitcnt lgkmcnt(3)
    ds_read_b32 v90, v143 offset:8320
    ds_read_b64_tr_b16 v[92:93], v144 offset:6016
    v_exp_f32 v56, v56
    v_exp_f32 v57, v57
    v_exp_f32 v58, v58
    v_exp_f32 v59, v59
    v_cvt_pk_bf16_f32 v68, v56, v57
    v_cvt_pk_bf16_f32 v69, v58, v59
    v_mfma_f32_32x32x16_bf16 v[0:15], v[100:103], v[64:67], v[0:15]
    s_setprio 0
    s_waitcnt lgkmcnt(4)
    ds_read_b64_tr_b16 v[94:95], v144 offset:6336
    buffer_store_dwordx4 v[120:123], v163, s[12:15], 0 offen sc1
    v_exp_f32 v60, v60
    v_exp_f32 v61, v61
    v_exp_f32 v62, v62
    v_exp_f32 v63, v63
    v_cvt_pk_bf16_f32 v70, v60, v61
    v_cvt_pk_bf16_f32 v71, v62, v63
    v_mfma_f32_32x32x16_bf16 v[48:63], v[84:87], v[72:75], v[16:31]
    s_setprio 3
    s_waitcnt lgkmcnt(3)
    ds_read_b128 v[80:83], v142 offset:9728
    ds_read_b64_tr_b16 v[96:97], v144 offset:6656
    v_exp_f32 v32, v32
    v_exp_f32 v33, v33
    v_exp_f32 v34, v34
    v_exp_f32 v35, v35
    v_cvt_pk_bf16_f32 v64, v32, v33
    v_cvt_pk_bf16_f32 v65, v34, v35
    v_mfma_f32_32x32x16_bf16 v[0:15], v[104:107], v[68:71], v[0:15]
    s_setprio 2
    s_waitcnt lgkmcnt(4)
    ds_read_b64_tr_b16 v[98:99], v144 offset:6976
    buffer_store_dwordx4 v[124:127], v164, s[12:15], 0 offen sc1
    v_exp_f32 v36, v36
    v_exp_f32 v37, v37
    v_exp_f32 v38, v38
    v_exp_f32 v39, v39
    v_cvt_pk_bf16_f32 v66, v36, v37
    v_cvt_pk_bf16_f32 v67, v38, v39
    v_mfma_f32_32x32x8_bf16 v[48:63], v[90:91], v[76:77], v[48:63]
    s_setprio 1
    s_waitcnt lgkmcnt(3)
    ds_read_b32 v88, v143 offset:10752
    ds_read_b64_tr_b16 v[100:101], v144 offset:8448
    v_exp_f32 v40, v40
    v_exp_f32 v41, v41
    v_exp_f32 v42, v42
    v_exp_f32 v43, v43
    v_cvt_pk_bf16_f32 v68, v40, v41
    v_cvt_pk_bf16_f32 v69, v42, v43
    v_mfma_f32_32x32x16_bf16 v[0:15], v[92:95], v[64:67], v[0:15]
    s_setprio 0
    s_waitcnt lgkmcnt(4)
    ds_read_b64_tr_b16 v[102:103], v144 offset:8768
    buffer_store_dwordx4 v[128:131], v165, s[12:15], 0 offen sc1
    v_exp_f32 v44, v44
    v_exp_f32 v45, v45
    v_exp_f32 v46, v46
    v_exp_f32 v47, v47
    v_cvt_pk_bf16_f32 v70, v44, v45
    v_cvt_pk_bf16_f32 v71, v46, v47
    v_mfma_f32_32x32x16_bf16 v[32:47], v[80:83], v[72:75], v[16:31]
    s_setprio 3
    s_waitcnt lgkmcnt(3)
    ds_read_b128 v[84:87], v142 offset:12160
    ds_read_b64_tr_b16 v[104:105], v144 offset:9088
    v_exp_f32 v48, v48
    v_exp_f32 v49, v49
    v_exp_f32 v50, v50
    v_exp_f32 v51, v51
    v_cvt_pk_bf16_f32 v64, v48, v49
    v_cvt_pk_bf16_f32 v65, v50, v51
    v_mfma_f32_32x32x16_bf16 v[0:15], v[96:99], v[68:71], v[0:15]
    s_setprio 2
    s_waitcnt lgkmcnt(4)
    ds_read_b64_tr_b16 v[106:107], v144 offset:9408
    buffer_store_dwordx4 v[132:135], v166, s[12:15], 0 offen sc1
    v_exp_f32 v52, v52
    v_exp_f32 v53, v53
    v_exp_f32 v54, v54
    v_exp_f32 v55, v55
    v_cvt_pk_bf16_f32 v66, v52, v53
    v_cvt_pk_bf16_f32 v67, v54, v55
    v_mfma_f32_32x32x8_bf16 v[32:47], v[88:89], v[76:77], v[32:47]
    s_setprio 1
    s_waitcnt lgkmcnt(3)
    ds_read_b32 v90, v143 offset:13184
    ds_read_b64_tr_b16 v[92:93], v144 offset:10880
    v_exp_f32 v56, v56
    v_exp_f32 v57, v57
    v_exp_f32 v58, v58
    v_exp_f32 v59, v59
    v_cvt_pk_bf16_f32 v68, v56, v57
    v_cvt_pk_bf16_f32 v69, v58, v59
    v_mfma_f32_32x32x16_bf16 v[0:15], v[100:103], v[64:67], v[0:15]
    s_setprio 0
    s_waitcnt lgkmcnt(4)
    ds_read_b64_tr_b16 v[94:95], v144 offset:11200
    buffer_store_dwordx4 v[136:139], v167, s[12:15], 0 offen sc1
    s_add_u32 s30, s30, 4
    v_exp_f32 v60, v60
    v_exp_f32 v61, v61
    v_exp_f32 v62, v62
    v_exp_f32 v63, v63
    v_cvt_pk_bf16_f32 v70, v60, v61
    v_cvt_pk_bf16_f32 v71, v62, v63
    v_add_u32 v142, 9728, v142
    v_add_u32 v143, 9728, v143
    v_add_u32 v144, 9728, v144
    s_branch attn_kernel_chk
.globl ffn_kernel
.p2align 8
.type ffn_kernel,@function
ffn_kernel:
    s_cmp_ge_u32 s2, 256
    s_cbranch_scc1 ffn_kernel_end
    s_load_dwordx2 s[12:13], s[0:1], 80
    s_load_dwordx2 s[8:9], s[0:1], 0
    s_load_dwordx2 s[4:5], s[0:1], 40
    s_load_dwordx2 s[56:57], s[0:1], 56
    s_load_dwordx2 s[60:61], s[0:1], 64
    s_mov_b32 s14, 44826624
    s_mov_b32 s15, 0x20000
    s_mov_b32 s10, 2359296
    s_mov_b32 s11, 0x20000
    s_mov_b32 s6, 9216
    s_mov_b32 s7, 0x20000
    s_mov_b32 s58, 1152
    s_mov_b32 s59, 0x20000
    s_mov_b32 s62, 2359296
    s_mov_b32 s63, 0x20000
    v_lshrrev_b32 v250, 6, v0
    v_and_b32 v251, 63, v0
    v_readfirstlane_b32 s16, v250
    s_bfe_u32 s17, s2, 65536
    s_lshl_b32 s17, s17, 2
    s_bfe_u32 s19, s2, 131075
    s_add_u32 s17, s17, s19
    s_bfe_u32 s18, s2, 131073
    s_lshl_b32 s18, s18, 3
    s_lshr_b32 s19, s2, 5
    s_add_u32 s18, s18, s19
    v_lshlrev_b32 v241, 4, v251
    v_and_b32 v242, 15, v251
    v_lshrrev_b32 v243, 4, v251
    v_lshlrev_b32 v248, 4, v242
    v_lshl_add_u32 v248, v243, 10, v248
    s_mul_i32 s21, s18, 73728
    s_lshl_b32 s19, s16, 8
    s_add_u32 s19, s19, 42336256
    s_lshl_b32 s22, s21, 3
    s_add_u32 s21, s21, s19
    s_lshl_b32 s19, s17, 2
    s_add_u32 s19, s19, s16
    s_mul_i32 s20, s19, 331776
    s_add_u32 s20, s20, 12845056
    s_lshl_b32 s28, s16, 10
    s_mul_i32 s29, s17, 92160
    s_add_u32 s29, s29, s28
    s_add_u32 s29, s29, 9699328
    s_lshl_b32 s19, s18, 2
    s_add_u32 s19, s19, s16
    s_lshl_b32 s19, s19, 4
    v_add_u32 v250, s19, v242
    v_lshrrev_b32 v251, 1, v243
    v_lshlrev_b32 v149, 16, v251
    v_lshl_add_u32 v149, v242, 4, v149
    s_lshl_b32 s19, s19, 5
    v_add_u32 v149, s19, v149
    v_and_b32 v251, 1, v243
    v_lshl_add_u32 v149, v251, 8, v149
    v_lshlrev_b32 v150, 15, v243
    v_lshl_add_u32 v150, v250, 4, v150
    v_mul_u32_u24 v151, 1152, v250
    v_lshl_add_u32 v152, v251, 3, v151
    v_lshl_add_u32 v151, v243, 4, v151
    v_mov_b32 v148, v241
    s_mul_i32 s31, s17, 144
    s_mov_b32 s30, 7340032
    s_waitcnt lgkmcnt(0)
    s_mov_b32 m0, s28
    s_add_u32 s28, s28, 4096
    buffer_load_dwordx4 v148, s[12:15], s29 offen lds
    s_add_u32 s29, s29, 4096
    s_mov_b32 m0, s28
    s_add_u32 s28, s28, 4096
    buffer_load_dwordx4 v148, s[12:15], s29 offen lds
    s_add_u32 s29, s29, 4096
    s_mov_b32 m0, s28
    s_add_u32 s28, s28, 4096
    buffer_load_dwordx4 v148, s[12:15], s29 offen lds
    s_add_u32 s29, s29, 4096
    s_mov_b32 m0, s28
    s_add_u32 s28, s28, 4096
    buffer_load_dwordx4 v148, s[12:15], s29 offen lds
    s_add_u32 s29, s29, 4096
    s_mov_b32 m0, s28
    s_add_u32 s28, s28, 4096
    buffer_load_dwordx4 v148, s[12:15], s29 offen lds
    s_add_u32 s29, s29, 4096
    s_mov_b32 m0, s28
    s_add_u32 s28, s28, 4096
    buffer_load_dwordx4 v148, s[12:15], s29 offen lds
    s_add_u32 s29, s29, 4096
    s_mov_b32 m0, s28
    s_add_u32 s28, s28, 4096
    buffer_load_dwordx4 v148, s[12:15], s29 offen lds
    s_add_u32 s29, s29, 4096
    s_mov_b32 m0, s28
    s_add_u32 s28, s28, 4096
    buffer_load_dwordx4 v148, s[12:15], s29 offen lds
    s_add_u32 s29, s29, 4096
    buffer_load_dwordx4 v[24:27], v149, s[12:15], s30 offen
    s_add_u32 s30, s30, 131072
    buffer_load_dwordx4 v[28:31], v149, s[12:15], s30 offen
    s_add_u32 s30, s30, 131072
    buffer_load_dwordx4 v[32:35], v149, s[12:15], s30 offen
    s_add_u32 s30, s30, 131072
    buffer_load_dwordx4 v[36:39], v149, s[12:15], s30 offen
    s_add_u32 s30, s30, 131072
    buffer_load_dwordx4 v[40:43], v149, s[12:15], s30 offen
    s_add_u32 s30, s30, 131072
    buffer_load_dwordx4 v[44:47], v149, s[12:15], s30 offen
    s_add_u32 s30, s30, 131072
    s_mov_b32 m0, s28
    s_add_u32 s28, s28, 4096
    buffer_load_dwordx4 v148, s[12:15], s29 offen lds
    s_add_u32 s29, s29, 4096
    s_mov_b32 m0, s28
    s_add_u32 s28, s28, 4096
    buffer_load_dwordx4 v148, s[12:15], s29 offen lds
    s_add_u32 s29, s29, 4096
    s_mov_b32 m0, s28
    s_add_u32 s28, s28, 4096
    buffer_load_dwordx4 v148, s[12:15], s29 offen lds
    s_add_u32 s29, s29, 4096
    s_mov_b32 m0, s28
    s_add_u32 s28, s28, 4096
    buffer_load_dwordx4 v148, s[12:15], s29 offen lds
    s_add_u32 s29, s29, 4096
    s_mov_b32 m0, s28
    s_add_u32 s28, s28, 4096
    buffer_load_dwordx4 v148, s[12:15], s29 offen lds
    s_add_u32 s29, s29, 4096
    s_mov_b32 m0, s28
    s_add_u32 s28, s28, 4096
    buffer_load_dwordx4 v148, s[12:15], s29 offen lds
    s_add_u32 s29, s29, 4096
    s_mov_b32 m0, s28
    s_add_u32 s28, s28, 4096
    buffer_load_dwordx4 v148, s[12:15], s29 offen lds
    s_add_u32 s29, s29, 4096
    buffer_load_dwordx4 v[48:51], v149, s[12:15], s30 offen
    s_add_u32 s30, s30, 131072
    buffer_load_dwordx4 v[52:55], v149, s[12:15], s30 offen
    s_add_u32 s30, s30, 131072
    buffer_load_dwordx4 v[56:59], v149, s[12:15], s30 offen
    s_add_u32 s30, s30, 131072
    buffer_load_dwordx4 v[60:63], v149, s[12:15], s30 offen
    s_add_u32 s30, s30, 131072
    buffer_load_dwordx4 v[64:67], v149, s[12:15], s30 offen
    s_add_u32 s30, s30, 131072
    buffer_load_dwordx4 v[68:71], v149, s[12:15], s30 offen
    s_add_u32 s30, s30, 131072
    s_mov_b32 m0, s28
    s_add_u32 s28, s28, 4096
    buffer_load_dwordx4 v148, s[12:15], s29 offen lds
    s_add_u32 s29, s29, 4096
    s_mov_b32 m0, s28
    s_add_u32 s28, s28, 4096
    buffer_load_dwordx4 v148, s[12:15], s29 offen lds
    s_add_u32 s29, s29, 4096
    s_mov_b32 m0, s28
    s_add_u32 s28, s28, 4096
    buffer_load_dwordx4 v148, s[12:15], s29 offen lds
    s_add_u32 s29, s29, 4096
    s_mov_b32 m0, s28
    s_add_u32 s28, s28, 4096
    buffer_load_dwordx4 v148, s[12:15], s29 offen lds
    s_add_u32 s29, s29, 4096
    s_mov_b32 m0, s28
    s_add_u32 s28, s28, 4096
    buffer_load_dwordx4 v148, s[12:15], s29 offen lds
    s_add_u32 s29, s29, 4096
    s_mov_b32 m0, s28
    s_add_u32 s28, s28, 4096
    buffer_load_dwordx4 v148, s[12:15], s29 offen lds
    s_add_u32 s29, s29, 4096
    s_mov_b32 m0, s28
    s_add_u32 s28, s28, 4096
    buffer_load_dwordx4 v148, s[12:15], s29 offen lds
    s_add_u32 s29, s29, 4096
    s_mov_b32 m0, s28
    s_add_u32 s28, s28, 4096
    buffer_load_dwordx4 v148, s[12:15], s29 offen lds
    s_add_u32 s29, s29, 4096
    buffer_load_dwordx4 v[72:75], v149, s[12:15], s30 offen
    s_add_u32 s30, s30, 131072
    buffer_load_dwordx4 v[76:79], v149, s[12:15], s30 offen
    s_add_u32 s30, s30, 131072
    buffer_load_dwordx4 v[80:83], v149, s[12:15], s30 offen
    s_add_u32 s30, s30, 131072
    buffer_load_dwordx4 v[84:87], v149, s[12:15], s30 offen
    s_add_u32 s30, s30, 131072
    buffer_load_dwordx4 v[88:91], v150, s[12:15], s30 offen
    s_add_u32 s30, s30, 131072
    buffer_load_dwordx4 v[92:95], v150, s[12:15], s30 offen
    s_add_u32 s30, s30, 131072
    v_lshlrev_b32 v251, 3, v251
    buffer_load_dwordx4 v[136:139], v151, s[8:11], s31 offen
    buffer_load_dwordx4 v[140:143], v151, s[8:11], s31 offen offset:64
    buffer_load_dwordx2 v[144:145], v152, s[8:11], s31 offen offset:128
    v_and_b32 v1, 0x70, v241
    v_lshrrev_b32 v3, 7, v241
    v_cmp_gt_u32 vcc, 6, v3
    v_mul_u32_u24 v2, 72, v1
    v_lshl_add_u32 v1, v3, 10, v1
    v_lshlrev_b32 v3, 4, v3
    v_add_u32 v2, v2, v3
    v_bfrev_b32 v250, 2
    v_cndmask_b32 v1, v250, v1, vcc
    v_cndmask_b32 v2, v250, v2, vcc
    v_cndmask_b32 v3, v250, v3, vcc
    v_cndmask_b32 v186, v250, v241, vcc
    s_mul_i32 s38, s16, 18176
    s_add_u32 s38, s38, s21
    s_lshl_b32 s19, s17, 7
    s_add_u32 s38, s38, s19
    s_add_u32 s39, s38, 6144
    s_add_u32 s40, s38, 12288
    s_mul_i32 s42, s16, 288
    s_lshl3_add_u32 s19, s18, s17
    s_mul_i32 s41, s19, 9216
    s_add_u32 s41, s41, s42
    v_lshl_add_u32 v153, v242, 4, v251
    s_mul_i32 s32, s17, 9216
    s_add_u32 s32, s32, s21
    s_add_u32 s33, s32, 4096
    s_add_u32 s34, s32, 8192
    s_lshl2_add_u32 s35, s18, s16
    s_lshl_b32 s35, s35, 10
    s_add_u32 s35, s35, 44695552
    s_lshl_b32 s19, s17, 7
    s_add_u32 s36, s19, s35
    s_mul_i32 s23, s17, 1152
    s_lshl_b32 s19, s16, 5
    s_add_u32 s23, s23, s19
    s_add_u32 s19, s23, s19
    v_lshlrev_b32 v253, 3, v243
    s_mov_b32 s25, s19
    s_mul_i32 s19, s16, 18432
    s_add_u32 s22, s22, s19
    s_add_u32 s22, s22, 23461888
    s_mul_i32 s19, s17, 73728
    s_add_u32 s44, s22, s19
    s_add_u32 s45, s44, 6144
    s_add_u32 s46, s44, 12288
    s_mul_i32 s19, s17, 768
    s_add_u32 s22, s22, s19
    v_add_u32 v244, 0x10000, v241
    v_add_u32 v245, 0x20000, v241
    s_lshl_b32 s19, s16, 10
    v_add_u32 v252, s19, v241
    s_lshl_b32 s19, s16, 12
    s_add_u32 s19, s19, 73728
    v_add_u32 v246, s19, v241
    s_lshr_b32 s19, s16, 1
    s_lshl_b32 s19, s19, 12
    s_and_b32 s24, s16, 1
    s_lshl_b32 s24, s24, 3
    s_add_u32 s19, s19, s24
    s_add_u32 s19, s19, 90112
    v_add_u32 v247, s19, v241
    v_lshrrev_b32 v250, 1, v243
    v_add_u32 v250, 4, v250
    v_lshrrev_b32 v187, 3, v242
    v_mul_u32_u24 v187, 73600, v187
    v_lshl_add_u32 v187, v242, 4, v187
    v_lshl_add_u32 v249, v250, 7, v187
    v_lshl_add_u32 v187, v243, 7, v187
    v_and_b32 v250, 1, v243
    v_mul_u32_u24 v250, 147456, v250
    v_add_u32 v249, v250, v249
    v_mov_b32 v240, 0x409d30fc
    v_mov_b32 v200, 0x3f803f80
    v_mov_b32 v201, 0x3f803f80
    v_mov_b32 v202, 0x3f803f80
    v_mov_b32 v203, 0x3f803f80
    v_lshlrev_b32 v250, 2, v243
    v_sub_u32 v250, v242, v250
    v_cmp_eq_u32 s[48:49], 0, v250
    v_cmp_eq_u32 s[50:51], 1, v250
    v_cmp_eq_u32 s[52:53], 2, v250
    v_cmp_eq_u32 s[54:55], 3, v250
    buffer_load_dwordx2 v[180:181], v253, s[4:7], s25 offen offset:0
    buffer_load_dwordx2 v[182:183], v253, s[4:7], s25 offen offset:32
    buffer_load_dwordx2 v[184:185], v253, s[4:7], s23 offen offset:256
    s_waitcnt vmcnt(39)
    s_barrier
    ds_read_b128 v[96:99], v148 offset:0
    ds_read_b128 v[100:103], v148 offset:1024
    ds_read_b128 v[104:107], v148 offset:2048
    ds_read_b128 v[108:111], v148 offset:3072
    ds_read_b128 v[112:115], v148 offset:4096
    ds_read_b128 v[116:119], v148 offset:5120
    s_waitcnt vmcnt(38) lgkmcnt(5)
    v_mfma_f32_16x16x32_bf16 v[4:7], v[96:99], v[24:27], 0
    ds_read_b128 v[120:123], v148 offset:6144
    s_waitcnt lgkmcnt(5)
    v_mfma_f32_16x16x32_bf16 v[8:11], v[100:103], v[24:27], 0
    ds_read_b128 v[124:127], v148 offset:7168
    s_waitcnt lgkmcnt(5)
    v_mfma_f32_16x16x32_bf16 v[12:15], v[104:107], v[24:27], 0
    ds_read_b128 v[128:131], v148 offset:8192
    s_waitcnt lgkmcnt(5)
    v_mfma_f32_16x16x32_bf16 v[16:19], v[108:111], v[24:27], 0
    ds_read_b128 v[132:135], v148 offset:9216
    s_waitcnt lgkmcnt(5)
    v_mfma_f32_16x16x32_bf16 v[20:23], v[112:115], v[24:27], 0
    ds_read_b128 v[96:99], v148 offset:10240
    s_waitcnt vmcnt(37) lgkmcnt(5)
    v_mfma_f32_16x16x32_bf16 v[4:7], v[116:119], v[28:31], v[4:7]
    ds_read_b128 v[100:103], v148 offset:11264
    s_waitcnt lgkmcnt(5)
    v_mfma_f32_16x16x32_bf16 v[8:11], v[120:123], v[28:31], v[8:11]
    ds_read_b128 v[104:107], v148 offset:12288
    s_waitcnt lgkmcnt(5)
    v_mfma_f32_16x16x32_bf16 v[12:15], v[124:127], v[28:31], v[12:15]
    ds_read_b128 v[108:111], v148 offset:13312
    s_waitcnt lgkmcnt(5)
    v_mfma_f32_16x16x32_bf16 v[16:19], v[128:131], v[28:31], v[16:19]
    ds_read_b128 v[112:115], v148 offset:14336
    s_waitcnt lgkmcnt(5)
    v_mfma_f32_16x16x32_bf16 v[20:23], v[132:135], v[28:31], v[20:23]
    ds_read_b128 v[116:119], v148 offset:15360
    s_waitcnt vmcnt(36) lgkmcnt(5)
    v_mfma_f32_16x16x32_bf16 v[4:7], v[96:99], v[32:35], v[4:7]
    ds_read_b128 v[120:123], v148 offset:16384
    s_waitcnt lgkmcnt(5)
    v_mfma_f32_16x16x32_bf16 v[8:11], v[100:103], v[32:35], v[8:11]
    ds_read_b128 v[124:127], v148 offset:17408
    s_waitcnt lgkmcnt(5)
    v_mfma_f32_16x16x32_bf16 v[12:15], v[104:107], v[32:35], v[12:15]
    ds_read_b128 v[128:131], v148 offset:18432
    s_waitcnt lgkmcnt(5)
    v_mfma_f32_16x16x32_bf16 v[16:19], v[108:111], v[32:35], v[16:19]
    ds_read_b128 v[132:135], v148 offset:19456
    s_waitcnt lgkmcnt(5)
    v_mfma_f32_16x16x32_bf16 v[20:23], v[112:115], v[32:35], v[20:23]
    ds_read_b128 v[96:99], v148 offset:20480
    s_waitcnt vmcnt(35) lgkmcnt(5)
    v_mfma_f32_16x16x32_bf16 v[4:7], v[116:119], v[36:39], v[4:7]
    ds_read_b128 v[100:103], v148 offset:21504
    s_waitcnt lgkmcnt(5)
    v_mfma_f32_16x16x32_bf16 v[8:11], v[120:123], v[36:39], v[8:11]
    ds_read_b128 v[104:107], v148 offset:22528
    s_waitcnt lgkmcnt(5)
    v_mfma_f32_16x16x32_bf16 v[12:15], v[124:127], v[36:39], v[12:15]
    ds_read_b128 v[108:111], v148 offset:23552
    s_waitcnt lgkmcnt(5)
    v_mfma_f32_16x16x32_bf16 v[16:19], v[128:131], v[36:39], v[16:19]
    ds_read_b128 v[112:115], v148 offset:24576
    s_waitcnt lgkmcnt(5)
    v_mfma_f32_16x16x32_bf16 v[20:23], v[132:135], v[36:39], v[20:23]
    ds_read_b128 v[116:119], v148 offset:25600
    s_waitcnt vmcnt(34) lgkmcnt(5)
    v_mfma_f32_16x16x32_bf16 v[4:7], v[96:99], v[40:43], v[4:7]
    ds_read_b128 v[120:123], v148 offset:26624
    s_waitcnt lgkmcnt(5)
    v_mfma_f32_16x16x32_bf16 v[8:11], v[100:103], v[40:43], v[8:11]
    ds_read_b128 v[124:127], v148 offset:27648
    s_waitcnt lgkmcnt(5)
    v_mfma_f32_16x16x32_bf16 v[12:15], v[104:107], v[40:43], v[12:15]
    ds_read_b128 v[128:131], v148 offset:28672
    s_waitcnt lgkmcnt(5)
    v_mfma_f32_16x16x32_bf16 v[16:19], v[108:111], v[40:43], v[16:19]
    ds_read_b128 v[132:135], v148 offset:29696
    s_waitcnt lgkmcnt(5)
    v_mfma_f32_16x16x32_bf16 v[20:23], v[112:115], v[40:43], v[20:23]
    s_waitcnt vmcnt(26)
    s_barrier
    ds_read_b128 v[96:99], v148 offset:30720
    s_waitcnt lgkmcnt(5)
    v_mfma_f32_16x16x32_bf16 v[4:7], v[116:119], v[44:47], v[4:7]
    ds_read_b128 v[100:103], v148 offset:31744
    s_waitcnt lgkmcnt(5)
    v_mfma_f32_16x16x32_bf16 v[8:11], v[120:123], v[44:47], v[8:11]
    ds_read_b128 v[104:107], v148 offset:32768
    s_waitcnt lgkmcnt(5)
    v_mfma_f32_16x16x32_bf16 v[12:15], v[124:127], v[44:47], v[12:15]
    ds_read_b128 v[108:111], v148 offset:33792
    s_waitcnt lgkmcnt(5)
    v_mfma_f32_16x16x32_bf16 v[16:19], v[128:131], v[44:47], v[16:19]
    ds_read_b128 v[112:115], v148 offset:34816
    s_waitcnt lgkmcnt(5)
    v_mfma_f32_16x16x32_bf16 v[20:23], v[132:135], v[44:47], v[20:23]
    ds_read_b128 v[116:119], v148 offset:35840
    s_waitcnt vmcnt(25) lgkmcnt(5)
    v_mfma_f32_16x16x32_bf16 v[4:7], v[96:99], v[48:51], v[4:7]
    ds_read_b128 v[120:123], v148 offset:36864
    s_waitcnt lgkmcnt(5)
    v_mfma_f32_16x16x32_bf16 v[8:11], v[100:103], v[48:51], v[8:11]
    ds_read_b128 v[124:127], v148 offset:37888
    s_waitcnt lgkmcnt(5)
    v_mfma_f32_16x16x32_bf16 v[12:15], v[104:107], v[48:51], v[12:15]
    ds_read_b128 v[128:131], v148 offset:38912
    s_waitcnt lgkmcnt(5)
    v_mfma_f32_16x16x32_bf16 v[16:19], v[108:111], v[48:51], v[16:19]
    ds_read_b128 v[132:135], v148 offset:39936
    s_waitcnt lgkmcnt(5)
    v_mfma_f32_16x16x32_bf16 v[20:23], v[112:115], v[48:51], v[20:23]
    ds_read_b128 v[96:99], v148 offset:40960
    s_waitcnt vmcnt(24) lgkmcnt(5)
    v_mfma_f32_16x16x32_bf16 v[4:7], v[116:119], v[52:55], v[4:7]
    ds_read_b128 v[100:103], v148 offset:41984
    s_waitcnt lgkmcnt(5)
    v_mfma_f32_16x16x32_bf16 v[8:11], v[120:123], v[52:55], v[8:11]
    ds_read_b128 v[104:107], v148 offset:43008
    s_waitcnt lgkmcnt(5)
    v_mfma_f32_16x16x32_bf16 v[12:15], v[124:127], v[52:55], v[12:15]
    ds_read_b128 v[108:111], v148 offset:44032
    s_waitcnt lgkmcnt(5)
    v_mfma_f32_16x16x32_bf16 v[16:19], v[128:131], v[52:55], v[16:19]
    ds_read_b128 v[112:115], v148 offset:45056
    s_waitcnt lgkmcnt(5)
    v_mfma_f32_16x16x32_bf16 v[20:23], v[132:135], v[52:55], v[20:23]
    ds_read_b128 v[116:119], v148 offset:46080
    s_waitcnt vmcnt(23) lgkmcnt(5)
    v_mfma_f32_16x16x32_bf16 v[4:7], v[96:99], v[56:59], v[4:7]
    ds_read_b128 v[120:123], v148 offset:47104
    s_waitcnt lgkmcnt(5)
    v_mfma_f32_16x16x32_bf16 v[8:11], v[100:103], v[56:59], v[8:11]
    ds_read_b128 v[124:127], v148 offset:48128
    s_waitcnt lgkmcnt(5)
    v_mfma_f32_16x16x32_bf16 v[12:15], v[104:107], v[56:59], v[12:15]
    ds_read_b128 v[128:131], v148 offset:49152
    s_waitcnt lgkmcnt(5)
    v_mfma_f32_16x16x32_bf16 v[16:19], v[108:111], v[56:59], v[16:19]
    ds_read_b128 v[132:135], v148 offset:50176
    s_waitcnt lgkmcnt(5)
    v_mfma_f32_16x16x32_bf16 v[20:23], v[112:115], v[56:59], v[20:23]
    ds_read_b128 v[96:99], v148 offset:51200
    s_waitcnt vmcnt(22) lgkmcnt(5)
    v_mfma_f32_16x16x32_bf16 v[4:7], v[116:119], v[60:63], v[4:7]
    ds_read_b128 v[100:103], v148 offset:52224
    s_waitcnt lgkmcnt(5)
    v_mfma_f32_16x16x32_bf16 v[8:11], v[120:123], v[60:63], v[8:11]
    ds_read_b128 v[104:107], v148 offset:53248
    s_waitcnt lgkmcnt(5)
    v_mfma_f32_16x16x32_bf16 v[12:15], v[124:127], v[60:63], v[12:15]
    ds_read_b128 v[108:111], v148 offset:54272
    s_waitcnt lgkmcnt(5)
    v_mfma_f32_16x16x32_bf16 v[16:19], v[128:131], v[60:63], v[16:19]
    ds_read_b128 v[112:115], v148 offset:55296
    s_waitcnt lgkmcnt(5)
    v_mfma_f32_16x16x32_bf16 v[20:23], v[132:135], v[60:63], v[20:23]
    ds_read_b128 v[116:119], v148 offset:56320
    s_waitcnt vmcnt(21) lgkmcnt(5)
    v_mfma_f32_16x16x32_bf16 v[4:7], v[96:99], v[64:67], v[4:7]
    ds_read_b128 v[120:123], v148 offset:57344
    s_waitcnt lgkmcnt(5)
    v_mfma_f32_16x16x32_bf16 v[8:11], v[100:103], v[64:67], v[8:11]
    ds_read_b128 v[124:127], v148 offset:58368
    s_waitcnt lgkmcnt(5)
    v_mfma_f32_16x16x32_bf16 v[12:15], v[104:107], v[64:67], v[12:15]
    ds_read_b128 v[128:131], v148 offset:59392
    s_waitcnt lgkmcnt(5)
    v_mfma_f32_16x16x32_bf16 v[16:19], v[108:111], v[64:67], v[16:19]
    ds_read_b128 v[132:135], v148 offset:60416
    s_waitcnt lgkmcnt(5)
    v_mfma_f32_16x16x32_bf16 v[20:23], v[112:115], v[64:67], v[20:23]
    s_waitcnt vmcnt(12)
    s_barrier
    v_add_u32 v148, 61440, v148
    ds_read_b128 v[96:99], v148 offset:0
    s_waitcnt lgkmcnt(5)
    v_mfma_f32_16x16x32_bf16 v[4:7], v[116:119], v[68:71], v[4:7]
    ds_read_b128 v[100:103], v148 offset:1024
    s_waitcnt lgkmcnt(5)
    v_mfma_f32_16x16x32_bf16 v[8:11], v[120:123], v[68:71], v[8:11]
    ds_read_b128 v[104:107], v148 offset:2048
    s_waitcnt lgkmcnt(5)
    v_mfma_f32_16x16x32_bf16 v[12:15], v[124:127], v[68:71], v[12:15]
    ds_read_b128 v[108:111], v148 offset:3072
    s_waitcnt lgkmcnt(5)
    v_mfma_f32_16x16x32_bf16 v[16:19], v[128:131], v[68:71], v[16:19]
    ds_read_b128 v[112:115], v148 offset:4096
    s_waitcnt lgkmcnt(5)
    v_mfma_f32_16x16x32_bf16 v[20:23], v[132:135], v[68:71], v[20:23]
    ds_read_b128 v[116:119], v148 offset:5120
    s_waitcnt vmcnt(11) lgkmcnt(5)
    v_mfma_f32_16x16x32_bf16 v[4:7], v[96:99], v[72:75], v[4:7]
    ds_read_b128 v[120:123], v148 offset:6144
    s_waitcnt lgkmcnt(5)
    v_mfma_f32_16x16x32_bf16 v[8:11], v[100:103], v[72:75], v[8:11]
    ds_read_b128 v[124:127], v148 offset:7168
    s_waitcnt lgkmcnt(5)
    v_mfma_f32_16x16x32_bf16 v[12:15], v[104:107], v[72:75], v[12:15]
    ds_read_b128 v[128:131], v148 offset:8192
    s_waitcnt lgkmcnt(5)
    v_mfma_f32_16x16x32_bf16 v[16:19], v[108:111], v[72:75], v[16:19]
    ds_read_b128 v[132:135], v148 offset:9216
    s_waitcnt lgkmcnt(5)
    v_mfma_f32_16x16x32_bf16 v[20:23], v[112:115], v[72:75], v[20:23]
    ds_read_b128 v[96:99], v148 offset:10240
    s_waitcnt vmcnt(10) lgkmcnt(5)
    v_mfma_f32_16x16x32_bf16 v[4:7], v[116:119], v[76:79], v[4:7]
    ds_read_b128 v[100:103], v148 offset:11264
    s_waitcnt lgkmcnt(5)
    v_mfma_f32_16x16x32_bf16 v[8:11], v[120:123], v[76:79], v[8:11]
    ds_read_b128 v[104:107], v148 offset:12288
    s_waitcnt lgkmcnt(5)
    v_mfma_f32_16x16x32_bf16 v[12:15], v[124:127], v[76:79], v[12:15]
    ds_read_b128 v[108:111], v148 offset:13312
    s_waitcnt lgkmcnt(5)
    v_mfma_f32_16x16x32_bf16 v[16:19], v[128:131], v[76:79], v[16:19]
    ds_read_b128 v[112:115], v148 offset:14336
    s_waitcnt lgkmcnt(5)
    v_mfma_f32_16x16x32_bf16 v[20:23], v[132:135], v[76:79], v[20:23]
    ds_read_b128 v[116:119], v148 offset:15360
    s_waitcnt vmcnt(9) lgkmcnt(5)
    v_mfma_f32_16x16x32_bf16 v[4:7], v[96:99], v[80:83], v[4:7]
    ds_read_b128 v[120:123], v148 offset:16384
    s_waitcnt lgkmcnt(5)
    v_mfma_f32_16x16x32_bf16 v[8:11], v[100:103], v[80:83], v[8:11]
    ds_read_b128 v[124:127], v148 offset:17408
    s_waitcnt lgkmcnt(5)
    v_mfma_f32_16x16x32_bf16 v[12:15], v[104:107], v[80:83], v[12:15]
    ds_read_b128 v[128:131], v148 offset:18432
    s_waitcnt lgkmcnt(5)
    v_mfma_f32_16x16x32_bf16 v[16:19], v[108:111], v[80:83], v[16:19]
    ds_read_b128 v[132:135], v148 offset:19456
    s_waitcnt lgkmcnt(5)
    v_mfma_f32_16x16x32_bf16 v[20:23], v[112:115], v[80:83], v[20:23]
    ds_read_b128 v[96:99], v148 offset:20480
    s_waitcnt vmcnt(8) lgkmcnt(5)
    v_mfma_f32_16x16x32_bf16 v[4:7], v[116:119], v[84:87], v[4:7]
    ds_read_b128 v[100:103], v148 offset:21504
    s_waitcnt lgkmcnt(5)
    v_mfma_f32_16x16x32_bf16 v[8:11], v[120:123], v[84:87], v[8:11]
    ds_read_b128 v[104:107], v148 offset:22528
    s_waitcnt lgkmcnt(5)
    v_mfma_f32_16x16x32_bf16 v[12:15], v[124:127], v[84:87], v[12:15]
    ds_read_b128 v[108:111], v148 offset:23552
    s_waitcnt lgkmcnt(5)
    v_mfma_f32_16x16x32_bf16 v[16:19], v[128:131], v[84:87], v[16:19]
    ds_read_b128 v[112:115], v148 offset:24576
    s_waitcnt lgkmcnt(5)
    v_mfma_f32_16x16x32_bf16 v[20:23], v[132:135], v[84:87], v[20:23]
    ds_read_b128 v[116:119], v148 offset:25600
    s_waitcnt vmcnt(7) lgkmcnt(5)
    v_mfma_f32_16x16x32_bf16 v[4:7], v[96:99], v[88:91], v[4:7]
    ds_read_b128 v[120:123], v148 offset:26624
    s_waitcnt lgkmcnt(5)
    v_mfma_f32_16x16x32_bf16 v[8:11], v[100:103], v[88:91], v[8:11]
    ds_read_b128 v[124:127], v148 offset:27648
    s_waitcnt lgkmcnt(5)
    v_mfma_f32_16x16x32_bf16 v[12:15], v[104:107], v[88:91], v[12:15]
    ds_read_b128 v[128:131], v148 offset:28672
    s_waitcnt lgkmcnt(5)
    v_mfma_f32_16x16x32_bf16 v[16:19], v[108:111], v[88:91], v[16:19]
    ds_read_b128 v[132:135], v148 offset:29696
    s_waitcnt lgkmcnt(5)
    v_mfma_f32_16x16x32_bf16 v[20:23], v[112:115], v[88:91], v[20:23]
    s_waitcnt vmcnt(6) lgkmcnt(4)
    v_mfma_f32_16x16x32_bf16 v[4:7], v[116:119], v[92:95], v[4:7]
    s_waitcnt lgkmcnt(3)
    v_mfma_f32_16x16x32_bf16 v[8:11], v[120:123], v[92:95], v[8:11]
    s_waitcnt lgkmcnt(2)
    v_mfma_f32_16x16x32_bf16 v[12:15], v[124:127], v[92:95], v[12:15]
    s_waitcnt lgkmcnt(1)
    v_mfma_f32_16x16x32_bf16 v[16:19], v[128:131], v[92:95], v[16:19]
    s_waitcnt lgkmcnt(0)
    v_mfma_f32_16x16x32_bf16 v[20:23], v[132:135], v[92:95], v[20:23]
    s_waitcnt vmcnt(5)
    v_lshlrev_b32 v24, 16, v136
    v_and_b32 v25, 0xffff0000, v136
    v_lshlrev_b32 v26, 16, v137
    v_and_b32 v27, 0xffff0000, v137
    v_lshlrev_b32 v28, 16, v138
    v_and_b32 v29, 0xffff0000, v138
    v_lshlrev_b32 v30, 16, v139
    v_and_b32 v31, 0xffff0000, v139
    s_waitcnt vmcnt(4)
    v_lshlrev_b32 v32, 16, v140
    v_and_b32 v33, 0xffff0000, v140
    v_lshlrev_b32 v34, 16, v141
    v_and_b32 v35, 0xffff0000, v141
    v_lshlrev_b32 v36, 16, v142
    v_and_b32 v37, 0xffff0000, v142
    v_lshlrev_b32 v38, 16, v143
    v_and_b32 v39, 0xffff0000, v143
    s_waitcnt vmcnt(3)
    v_lshlrev_b32 v40, 16, v144
    v_and_b32 v41, 0xffff0000, v144
    v_lshlrev_b32 v42, 16, v145
    v_and_b32 v43, 0xffff0000, v145
    v_add_f32 v24, v24, v4
    v_add_f32 v25, v25, v5
    v_add_f32 v26, v26, v6
    v_add_f32 v27, v27, v7
    v_add_f32 v28, v28, v8
    v_add_f32 v29, v29, v9
    v_add_f32 v30, v30, v10
    v_add_f32 v31, v31, v11
    v_add_f32 v32, v32, v12
    v_add_f32 v33, v33, v13
    v_add_f32 v34, v34, v14
    v_add_f32 v35, v35, v15
    v_add_f32 v36, v36, v16
    v_add_f32 v37, v37, v17
    v_add_f32 v38, v38, v18
    v_add_f32 v39, v39, v19
    v_add_f32 v40, v40, v20
    v_add_f32 v41, v41, v21
    v_add_f32 v42, v42, v22
    v_add_f32 v43, v43, v23
    v_cvt_pk_bf16_f32 v136, v24, v25
    v_cvt_pk_bf16_f32 v137, v26, v27
    v_cvt_pk_bf16_f32 v138, v28, v29
    v_cvt_pk_bf16_f32 v139, v30, v31
    v_cvt_pk_bf16_f32 v140, v32, v33
    v_cvt_pk_bf16_f32 v141, v34, v35
    v_cvt_pk_bf16_f32 v142, v36, v37
    v_cvt_pk_bf16_f32 v143, v38, v39
    v_cvt_pk_bf16_f32 v144, v40, v41
    v_cvt_pk_bf16_f32 v145, v42, v43
    buffer_store_dwordx4 v[136:139], v248, s[12:15], s32 offen sc1
    buffer_store_dwordx4 v[140:143], v248, s[12:15], s33 offen sc1
    s_mov_b32 exec_hi, 0
    buffer_store_dwordx2 v[144:145], v153, s[12:15], s34 offen sc1
    s_mov_b32 exec_hi, -1
    v_lshrrev_b32 v0, 2, v241
    v_and_b32 v251, 7, v242
    v_lshlrev_b32 v251, 7, v251
    buffer_load_dwordx4 a[0:3], v241, s[12:15], s20 offen offset:0
    buffer_load_dwordx4 a[4:7], v241, s[12:15], s20 offen offset:1024
    buffer_load_dwordx4 a[8:11], v241, s[12:15], s20 offen offset:2048
    buffer_load_dwordx4 a[12:15], v241, s[12:15], s20 offen offset:3072
    s_add_u32 s20, s20, 4096
    buffer_load_dwordx4 a[16:19], v241, s[12:15], s20 offen offset:0
    buffer_load_dwordx4 a[20:23], v241, s[12:15], s20 offen offset:1024
    buffer_load_dwordx4 a[24:27], v241, s[12:15], s20 offen offset:2048
    buffer_load_dwordx4 a[28:31], v241, s[12:15], s20 offen offset:3072
    s_add_u32 s20, s20, 4096
    buffer_load_dwordx4 a[32:35], v241, s[12:15], s20 offen offset:0
    s_barrier
    s_waitcnt vmcnt(9)
    buffer_load_dwordx4 a[36:39], v241, s[12:15], s20 offen offset:1024
    buffer_load_dwordx4 a[40:43], v241, s[12:15], s20 offen offset:2048
    buffer_load_dwordx4 a[44:47], v241, s[12:15], s20 offen offset:3072
    s_add_u32 s20, s20, 4096
    buffer_load_dwordx4 a[48:51], v241, s[12:15], s20 offen offset:0
    buffer_load_dwordx4 a[52:55], v241, s[12:15], s20 offen offset:1024
    buffer_load_dwordx4 a[56:59], v241, s[12:15], s20 offen offset:2048
    buffer_load_dwordx4 a[60:63], v241, s[12:15], s20 offen offset:3072
    s_add_u32 s20, s20, 4096
    buffer_load_dwordx4 a[64:67], v241, s[12:15], s20 offen offset:0
    buffer_load_dwordx4 a[68:71], v241, s[12:15], s20 offen offset:1024
    buffer_load_dwordx4 v[8:11], v248, s[12:15], s21 offen sc1
    s_add_u32 s21, s21, 4096
    buffer_load_dwordx4 v[12:15], v248, s[12:15], s21 offen sc1
    s_add_u32 s21, s21, 4096
    buffer_load_dwordx4 v[16:19], v248, s[12:15], s21 offen sc1
    s_add_u32 s21, s21, 4096
    buffer_load_dwordx4 v[20:23], v248, s[12:15], s21 offen sc1
    s_add_u32 s21, s21, 4096
    buffer_load_dwordx4 v[24:27], v248, s[12:15], s21 offen sc1
    s_add_u32 s21, s21, 4096
    buffer_load_dwordx4 v[28:31], v248, s[12:15], s21 offen sc1
    s_add_u32 s21, s21, 4096
    buffer_load_dwordx4 v[32:35], v248, s[12:15], s21 offen sc1
    s_add_u32 s21, s21, 4096
    buffer_load_dwordx4 v[36:39], v248, s[12:15], s21 offen sc1
    s_add_u32 s21, s21, 4096
    buffer_load_dwordx4 v[40:43], v248, s[12:15], s21 offen sc1
    s_add_u32 s21, s21, 4096
    buffer_load_dwordx4 v[44:47], v248, s[12:15], s21 offen sc1
    s_add_u32 s21, s21, 4096
    buffer_load_dwordx4 v[48:51], v248, s[12:15], s21 offen sc1
    s_add_u32 s21, s21, 4096
    buffer_load_dwordx4 v[52:55], v248, s[12:15], s21 offen sc1
    s_add_u32 s21, s21, 4096
    buffer_load_dwordx4 v[56:59], v248, s[12:15], s21 offen sc1
    s_add_u32 s21, s21, 4096
    buffer_load_dwordx4 v[60:63], v248, s[12:15], s21 offen sc1
    s_add_u32 s21, s21, 4096
    buffer_load_dwordx4 v[64:67], v248, s[12:15], s21 offen sc1
    s_add_u32 s21, s21, 4096
    buffer_load_dwordx4 v[68:71], v248, s[12:15], s21 offen sc1
    s_add_u32 s21, s21, 4096
    buffer_load_dwordx4 v[72:75], v248, s[12:15], s21 offen sc1
    s_add_u32 s21, s21, 4096
    buffer_load_dwordx4 v[76:79], v248, s[12:15], s21 offen sc1
    s_add_u32 s21, s21, 4096
    s_waitcnt vmcnt(17)
    v_mfma_f32_16x16x32_bf16 v[204:207], v[200:203], v[8:11], 0
    v_mfma_f32_16x16x32_bf16 v[208:211], v[8:11], v[8:11], 0
    buffer_load_dwordx4 a[72:75], v241, s[12:15], s20 offen offset:2048
    s_waitcnt vmcnt(17)
    v_mfma_f32_16x16x32_bf16 v[204:207], v[200:203], v[12:15], v[204:207]
    v_mfma_f32_16x16x32_bf16 v[208:211], v[12:15], v[12:15], v[208:211]
    buffer_load_dwordx4 a[76:79], v241, s[12:15], s20 offen offset:3072
    s_waitcnt vmcnt(17)
    v_mfma_f32_16x16x32_bf16 v[204:207], v[200:203], v[16:19], v[204:207]
    v_mfma_f32_16x16x32_bf16 v[208:211], v[16:19], v[16:19], v[208:211]
    s_add_u32 s20, s20, 4096
    buffer_load_dwordx4 a[80:83], v241, s[12:15], s20 offen offset:0
    s_waitcnt vmcnt(17)
    v_mfma_f32_16x16x32_bf16 v[204:207], v[200:203], v[20:23], v[204:207]
    v_mfma_f32_16x16x32_bf16 v[208:211], v[20:23], v[20:23], v[208:211]
    buffer_load_dwordx4 a[84:87], v241, s[12:15], s20 offen offset:1024
    s_waitcnt vmcnt(17)
    v_mfma_f32_16x16x32_bf16 v[204:207], v[200:203], v[24:27], v[204:207]
    v_mfma_f32_16x16x32_bf16 v[208:211], v[24:27], v[24:27], v[208:211]
    buffer_load_dwordx4 a[88:91], v241, s[12:15], s20 offen offset:2048
    s_waitcnt vmcnt(17)
    v_mfma_f32_16x16x32_bf16 v[204:207], v[200:203], v[28:31], v[204:207]
    v_mfma_f32_16x16x32_bf16 v[208:211], v[28:31], v[28:31], v[208:211]
    buffer_load_dwordx4 a[92:95], v241, s[12:15], s20 offen offset:3072
    s_waitcnt vmcnt(17)
    v_mfma_f32_16x16x32_bf16 v[204:207], v[200:203], v[32:35], v[204:207]
    v_mfma_f32_16x16x32_bf16 v[208:211], v[32:35], v[32:35], v[208:211]
    s_add_u32 s20, s20, 4096
    buffer_load_dwordx4 a[96:99], v241, s[12:15], s20 offen offset:0
    s_waitcnt vmcnt(17)
    v_mfma_f32_16x16x32_bf16 v[204:207], v[200:203], v[36:39], v[204:207]
    v_mfma_f32_16x16x32_bf16 v[208:211], v[36:39], v[36:39], v[208:211]
    buffer_load_dwordx4 a[100:103], v241, s[12:15], s20 offen offset:1024
    s_waitcnt vmcnt(17)
    v_mfma_f32_16x16x32_bf16 v[204:207], v[200:203], v[40:43], v[204:207]
    v_mfma_f32_16x16x32_bf16 v[208:211], v[40:43], v[40:43], v[208:211]
    buffer_load_dwordx4 a[104:107], v241, s[12:15], s20 offen offset:2048
    s_waitcnt vmcnt(17)
    v_mfma_f32_16x16x32_bf16 v[204:207], v[200:203], v[44:47], v[204:207]
    v_mfma_f32_16x16x32_bf16 v[208:211], v[44:47], v[44:47], v[208:211]
    buffer_load_dwordx4 a[108:111], v241, s[12:15], s20 offen offset:3072
    s_waitcnt vmcnt(17)
    v_mfma_f32_16x16x32_bf16 v[204:207], v[200:203], v[48:51], v[204:207]
    v_mfma_f32_16x16x32_bf16 v[208:211], v[48:51], v[48:51], v[208:211]
    s_add_u32 s20, s20, 4096
    buffer_load_dwordx4 a[112:115], v241, s[12:15], s20 offen offset:0
    s_waitcnt vmcnt(17)
    v_mfma_f32_16x16x32_bf16 v[204:207], v[200:203], v[52:55], v[204:207]
    v_mfma_f32_16x16x32_bf16 v[208:211], v[52:55], v[52:55], v[208:211]
    buffer_load_dwordx4 a[116:119], v241, s[12:15], s20 offen offset:1024
    s_waitcnt vmcnt(17)
    v_mfma_f32_16x16x32_bf16 v[204:207], v[200:203], v[56:59], v[204:207]
    v_mfma_f32_16x16x32_bf16 v[208:211], v[56:59], v[56:59], v[208:211]
    buffer_load_dwordx4 a[120:123], v241, s[12:15], s20 offen offset:2048
    s_waitcnt vmcnt(17)
    v_mfma_f32_16x16x32_bf16 v[204:207], v[200:203], v[60:63], v[204:207]
    v_mfma_f32_16x16x32_bf16 v[208:211], v[60:63], v[60:63], v[208:211]
    buffer_load_dwordx4 a[124:127], v241, s[12:15], s20 offen offset:3072
    s_waitcnt vmcnt(17)
    v_mfma_f32_16x16x32_bf16 v[204:207], v[200:203], v[64:67], v[204:207]
    v_mfma_f32_16x16x32_bf16 v[208:211], v[64:67], v[64:67], v[208:211]
    s_add_u32 s20, s20, 4096
    buffer_load_dwordx4 a[128:131], v241, s[12:15], s20 offen offset:0
    s_waitcnt vmcnt(17)
    v_mfma_f32_16x16x32_bf16 v[204:207], v[200:203], v[68:71], v[204:207]
    v_mfma_f32_16x16x32_bf16 v[208:211], v[68:71], v[68:71], v[208:211]
    buffer_load_dwordx4 a[132:135], v241, s[12:15], s20 offen offset:1024
    s_waitcnt vmcnt(17)
    v_mfma_f32_16x16x32_bf16 v[204:207], v[200:203], v[72:75], v[204:207]
    v_mfma_f32_16x16x32_bf16 v[208:211], v[72:75], v[72:75], v[208:211]
    buffer_load_dwordx4 a[136:139], v241, s[12:15], s20 offen offset:2048
    s_waitcnt vmcnt(17)
    v_mfma_f32_16x16x32_bf16 v[204:207], v[200:203], v[76:79], v[204:207]
    v_mfma_f32_16x16x32_bf16 v[208:211], v[76:79], v[76:79], v[208:211]
    buffer_load_dwordx4 a[140:143], v241, s[12:15], s20 offen offset:3072
    s_nop 7
    s_mov_b32 s37, 65536
ffn_kernel_s0a:
    v_cmp_u_f32 vcc, v204, v204
    s_sub_u32 s37, s37, 1
    s_cbranch_scc1 ffn_kernel_s0b
    s_nop 2
    s_cbranch_vccz ffn_kernel_s0b
    s_sub_u32 s21, s21, 73728
    buffer_load_dwordx4 v[8:11], v248, s[12:15], s21 offen sc1
    s_add_u32 s21, s21, 4096
    buffer_load_dwordx4 v[12:15], v248, s[12:15], s21 offen sc1
    s_add_u32 s21, s21, 4096
    buffer_load_dwordx4 v[16:19], v248, s[12:15], s21 offen sc1
    s_add_u32 s21, s21, 4096
    buffer_load_dwordx4 v[20:23], v248, s[12:15], s21 offen sc1
    s_add_u32 s21, s21, 4096
    buffer_load_dwordx4 v[24:27], v248, s[12:15], s21 offen sc1
    s_add_u32 s21, s21, 4096
    buffer_load_dwordx4 v[28:31], v248, s[12:15], s21 offen sc1
    s_add_u32 s21, s21, 4096
    buffer_load_dwordx4 v[32:35], v248, s[12:15], s21 offen sc1
    s_add_u32 s21, s21, 4096
    buffer_load_dwordx4 v[36:39], v248, s[12:15], s21 offen sc1
    s_add_u32 s21, s21, 4096
    buffer_load_dwordx4 v[40:43], v248, s[12:15], s21 offen sc1
    s_add_u32 s21, s21, 4096
    buffer_load_dwordx4 v[44:47], v248, s[12:15], s21 offen sc1
    s_add_u32 s21, s21, 4096
    buffer_load_dwordx4 v[48:51], v248, s[12:15], s21 offen sc1
    s_add_u32 s21, s21, 4096
    buffer_load_dwordx4 v[52:55], v248, s[12:15], s21 offen sc1
    s_add_u32 s21, s21, 4096
    buffer_load_dwordx4 v[56:59], v248, s[12:15], s21 offen sc1
    s_add_u32 s21, s21, 4096
    buffer_load_dwordx4 v[60:63], v248, s[12:15], s21 offen sc1
    s_add_u32 s21, s21, 4096
    buffer_load_dwordx4 v[64:67], v248, s[12:15], s21 offen sc1
    s_add_u32 s21, s21, 4096
    buffer_load_dwordx4 v[68:71], v248, s[12:15], s21 offen sc1
    s_add_u32 s21, s21, 4096
    buffer_load_dwordx4 v[72:75], v248, s[12:15], s21 offen sc1
    s_add_u32 s21, s21, 4096
    buffer_load_dwordx4 v[76:79], v248, s[12:15], s21 offen sc1
    s_add_u32 s21, s21, 4096
    s_waitcnt vmcnt(17)
    v_mfma_f32_16x16x32_bf16 v[204:207], v[200:203], v[8:11], 0
    v_mfma_f32_16x16x32_bf16 v[208:211], v[8:11], v[8:11], 0
    s_waitcnt vmcnt(16)
    v_mfma_f32_16x16x32_bf16 v[204:207], v[200:203], v[12:15], v[204:207]
    v_mfma_f32_16x16x32_bf16 v[208:211], v[12:15], v[12:15], v[208:211]
    s_waitcnt vmcnt(15)
    v_mfma_f32_16x16x32_bf16 v[204:207], v[200:203], v[16:19], v[204:207]
    v_mfma_f32_16x16x32_bf16 v[208:211], v[16:19], v[16:19], v[208:211]
    s_waitcnt vmcnt(14)
    v_mfma_f32_16x16x32_bf16 v[204:207], v[200:203], v[20:23], v[204:207]
    v_mfma_f32_16x16x32_bf16 v[208:211], v[20:23], v[20:23], v[208:211]
    s_waitcnt vmcnt(13)
    v_mfma_f32_16x16x32_bf16 v[204:207], v[200:203], v[24:27], v[204:207]
    v_mfma_f32_16x16x32_bf16 v[208:211], v[24:27], v[24:27], v[208:211]
    s_waitcnt vmcnt(12)
    v_mfma_f32_16x16x32_bf16 v[204:207], v[200:203], v[28:31], v[204:207]
    v_mfma_f32_16x16x32_bf16 v[208:211], v[28:31], v[28:31], v[208:211]
    s_waitcnt vmcnt(11)
    v_mfma_f32_16x16x32_bf16 v[204:207], v[200:203], v[32:35], v[204:207]
    v_mfma_f32_16x16x32_bf16 v[208:211], v[32:35], v[32:35], v[208:211]
    s_waitcnt vmcnt(10)
    v_mfma_f32_16x16x32_bf16 v[204:207], v[200:203], v[36:39], v[204:207]
    v_mfma_f32_16x16x32_bf16 v[208:211], v[36:39], v[36:39], v[208:211]
    s_waitcnt vmcnt(9)
    v_mfma_f32_16x16x32_bf16 v[204:207], v[200:203], v[40:43], v[204:207]
    v_mfma_f32_16x16x32_bf16 v[208:211], v[40:43], v[40:43], v[208:211]
    s_waitcnt vmcnt(8)
    v_mfma_f32_16x16x32_bf16 v[204:207], v[200:203], v[44:47], v[204:207]
    v_mfma_f32_16x16x32_bf16 v[208:211], v[44:47], v[44:47], v[208:211]
    s_waitcnt vmcnt(7)
    v_mfma_f32_16x16x32_bf16 v[204:207], v[200:203], v[48:51], v[204:207]
    v_mfma_f32_16x16x32_bf16 v[208:211], v[48:51], v[48:51], v[208:211]
    s_waitcnt vmcnt(6)
    v_mfma_f32_16x16x32_bf16 v[204:207], v[200:203], v[52:55], v[204:207]
    v_mfma_f32_16x16x32_bf16 v[208:211], v[52:55], v[52:55], v[208:211]
    s_waitcnt vmcnt(5)
    v_mfma_f32_16x16x32_bf16 v[204:207], v[200:203], v[56:59], v[204:207]
    v_mfma_f32_16x16x32_bf16 v[208:211], v[56:59], v[56:59], v[208:211]
    s_waitcnt vmcnt(4)
    v_mfma_f32_16x16x32_bf16 v[204:207], v[200:203], v[60:63], v[204:207]
    v_mfma_f32_16x16x32_bf16 v[208:211], v[60:63], v[60:63], v[208:211]
    s_waitcnt vmcnt(3)
    v_mfma_f32_16x16x32_bf16 v[204:207], v[200:203], v[64:67], v[204:207]
    v_mfma_f32_16x16x32_bf16 v[208:211], v[64:67], v[64:67], v[208:211]
    s_waitcnt vmcnt(2)
    v_mfma_f32_16x16x32_bf16 v[204:207], v[200:203], v[68:71], v[204:207]
    v_mfma_f32_16x16x32_bf16 v[208:211], v[68:71], v[68:71], v[208:211]
    s_waitcnt vmcnt(1)
    v_mfma_f32_16x16x32_bf16 v[204:207], v[200:203], v[72:75], v[204:207]
    v_mfma_f32_16x16x32_bf16 v[208:211], v[72:75], v[72:75], v[208:211]
    s_waitcnt vmcnt(0)
    v_mfma_f32_16x16x32_bf16 v[204:207], v[200:203], v[76:79], v[204:207]
    v_mfma_f32_16x16x32_bf16 v[208:211], v[76:79], v[76:79], v[208:211]
    s_nop 7
    s_branch ffn_kernel_s0a
ffn_kernel_s0b:
    v_cndmask_b32 v212, 0, v208, s[48:49]
    v_cndmask_b32 v212, v212, v209, s[50:51]
    v_cndmask_b32 v212, v212, v210, s[52:53]
    v_cndmask_b32 v212, v212, v211, s[54:55]
    v_mul_f32 v204, 0xbae38e39, v204
    v_mov_b32 v250, v212
    s_nop 1
    v_permlane16_swap_b32 v212, v250
    v_add_f32 v212, v212, v250
    v_mov_b32 v250, v212
    s_nop 1
    v_permlane32_swap_b32 v212, v250
    v_add_f32 v212, v212, v250
    v_mul_f32 v250, v204, v204
    s_mov_b32 s24, 0x3ae38e39
    v_fma_f32 v250, v212, s24, -v250
    v_max_f32 v250, 0, v250
    v_add_f32 v250, 0x3727c5ac, v250
    v_rsq_f32 v214, v250
    s_add_u32 s20, s20, 4096
    buffer_load_dwordx4 a[144:147], v241, s[12:15], s20 offen offset:0
    v_mul_f32 v214, 0x3eeff558, v214
    v_mul_f32 v204, v204, v214
    v_lshlrev_b32 v216, 16, v8
    v_and_b32 v217, 0xffff0000, v8
    v_lshlrev_b32 v218, 16, v9
    v_and_b32 v219, 0xffff0000, v9
    v_lshlrev_b32 v220, 16, v10
    v_and_b32 v221, 0xffff0000, v10
    v_lshlrev_b32 v222, 16, v11
    v_and_b32 v223, 0xffff0000, v11
    v_pk_fma_f32 v[216:217], v[216:217], v[214:215], v[204:205] op_sel_hi:[1,0,0]
    v_pk_fma_f32 v[218:219], v[218:219], v[214:215], v[204:205] op_sel_hi:[1,0,0]
    v_pk_fma_f32 v[220:221], v[220:221], v[214:215], v[204:205] op_sel_hi:[1,0,0]
    v_pk_fma_f32 v[222:223], v[222:223], v[214:215], v[204:205] op_sel_hi:[1,0,0]
    v_cvt_pk_bf16_f32 v8, v216, v217
    v_cvt_pk_bf16_f32 v9, v218, v219
    v_cvt_pk_bf16_f32 v10, v220, v221
    v_cvt_pk_bf16_f32 v11, v222, v223
    ds_write_b128 v252, v[8:11] offset:0
    v_lshlrev_b32 v224, 16, v12
    v_and_b32 v225, 0xffff0000, v12
    v_lshlrev_b32 v226, 16, v13
    v_and_b32 v227, 0xffff0000, v13
    v_lshlrev_b32 v228, 16, v14
    v_and_b32 v229, 0xffff0000, v14
    v_lshlrev_b32 v230, 16, v15
    v_and_b32 v231, 0xffff0000, v15
    buffer_load_dwordx4 a[148:151], v241, s[12:15], s20 offen offset:1024
    v_pk_fma_f32 v[224:225], v[224:225], v[214:215], v[204:205] op_sel_hi:[1,0,0]
    v_pk_fma_f32 v[226:227], v[226:227], v[214:215], v[204:205] op_sel_hi:[1,0,0]
    v_pk_fma_f32 v[228:229], v[228:229], v[214:215], v[204:205] op_sel_hi:[1,0,0]
    v_pk_fma_f32 v[230:231], v[230:231], v[214:215], v[204:205] op_sel_hi:[1,0,0]
    v_cvt_pk_bf16_f32 v12, v224, v225
    v_cvt_pk_bf16_f32 v13, v226, v227
    v_cvt_pk_bf16_f32 v14, v228, v229
    v_cvt_pk_bf16_f32 v15, v230, v231
    ds_write_b128 v252, v[12:15] offset:4096
    v_lshlrev_b32 v216, 16, v16
    v_and_b32 v217, 0xffff0000, v16
    v_lshlrev_b32 v218, 16, v17
    v_and_b32 v219, 0xffff0000, v17
    v_lshlrev_b32 v220, 16, v18
    v_and_b32 v221, 0xffff0000, v18
    v_lshlrev_b32 v222, 16, v19
    v_and_b32 v223, 0xffff0000, v19
    buffer_load_dwordx4 a[152:155], v241, s[12:15], s20 offen offset:2048
    v_pk_fma_f32 v[216:217], v[216:217], v[214:215], v[204:205] op_sel_hi:[1,0,0]
    v_pk_fma_f32 v[218:219], v[218:219], v[214:215], v[204:205] op_sel_hi:[1,0,0]
    v_pk_fma_f32 v[220:221], v[220:221], v[214:215], v[204:205] op_sel_hi:[1,0,0]
    v_pk_fma_f32 v[222:223], v[222:223], v[214:215], v[204:205] op_sel_hi:[1,0,0]
    v_cvt_pk_bf16_f32 v16, v216, v217
    v_cvt_pk_bf16_f32 v17, v218, v219
    v_cvt_pk_bf16_f32 v18, v220, v221
    v_cvt_pk_bf16_f32 v19, v222, v223
    ds_write_b128 v252, v[16:19] offset:8192
    v_lshlrev_b32 v224, 16, v20
    v_and_b32 v225, 0xffff0000, v20
    v_lshlrev_b32 v226, 16, v21
    v_and_b32 v227, 0xffff0000, v21
    v_lshlrev_b32 v228, 16, v22
    v_and_b32 v229, 0xffff0000, v22
    v_lshlrev_b32 v230, 16, v23
    v_and_b32 v231, 0xffff0000, v23
    buffer_load_dwordx4 a[156:159], v241, s[12:15], s20 offen offset:3072
    v_pk_fma_f32 v[224:225], v[224:225], v[214:215], v[204:205] op_sel_hi:[1,0,0]
    v_pk_fma_f32 v[226:227], v[226:227], v[214:215], v[204:205] op_sel_hi:[1,0,0]
    v_pk_fma_f32 v[228:229], v[228:229], v[214:215], v[204:205] op_sel_hi:[1,0,0]
    v_pk_fma_f32 v[230:231], v[230:231], v[214:215], v[204:205] op_sel_hi:[1,0,0]
    v_cvt_pk_bf16_f32 v20, v224, v225
    v_cvt_pk_bf16_f32 v21, v226, v227
    v_cvt_pk_bf16_f32 v22, v228, v229
    v_cvt_pk_bf16_f32 v23, v230, v231
    ds_write_b128 v252, v[20:23] offset:12288
    v_lshlrev_b32 v216, 16, v24
    v_and_b32 v217, 0xffff0000, v24
    v_lshlrev_b32 v218, 16, v25
    v_and_b32 v219, 0xffff0000, v25
    v_lshlrev_b32 v220, 16, v26
    v_and_b32 v221, 0xffff0000, v26
    v_lshlrev_b32 v222, 16, v27
    v_and_b32 v223, 0xffff0000, v27
    s_add_u32 s20, s20, 4096
    buffer_load_dwordx4 a[160:163], v241, s[12:15], s20 offen offset:0
    v_pk_fma_f32 v[216:217], v[216:217], v[214:215], v[204:205] op_sel_hi:[1,0,0]
    v_pk_fma_f32 v[218:219], v[218:219], v[214:215], v[204:205] op_sel_hi:[1,0,0]
    v_pk_fma_f32 v[220:221], v[220:221], v[214:215], v[204:205] op_sel_hi:[1,0,0]
    v_pk_fma_f32 v[222:223], v[222:223], v[214:215], v[204:205] op_sel_hi:[1,0,0]
    v_cvt_pk_bf16_f32 v24, v216, v217
    v_cvt_pk_bf16_f32 v25, v218, v219
    v_cvt_pk_bf16_f32 v26, v220, v221
    v_cvt_pk_bf16_f32 v27, v222, v223
    ds_write_b128 v252, v[24:27] offset:16384
    v_lshlrev_b32 v224, 16, v28
    v_and_b32 v225, 0xffff0000, v28
    v_lshlrev_b32 v226, 16, v29
    v_and_b32 v227, 0xffff0000, v29
    v_lshlrev_b32 v228, 16, v30
    v_and_b32 v229, 0xffff0000, v30
    v_lshlrev_b32 v230, 16, v31
    v_and_b32 v231, 0xffff0000, v31
    buffer_load_dwordx4 a[164:167], v241, s[12:15], s20 offen offset:1024
    v_pk_fma_f32 v[224:225], v[224:225], v[214:215], v[204:205] op_sel_hi:[1,0,0]
    v_pk_fma_f32 v[226:227], v[226:227], v[214:215], v[204:205] op_sel_hi:[1,0,0]
    v_pk_fma_f32 v[228:229], v[228:229], v[214:215], v[204:205] op_sel_hi:[1,0,0]
    v_pk_fma_f32 v[230:231], v[230:231], v[214:215], v[204:205] op_sel_hi:[1,0,0]
    v_cvt_pk_bf16_f32 v28, v224, v225
    v_cvt_pk_bf16_f32 v29, v226, v227
    v_cvt_pk_bf16_f32 v30, v228, v229
    v_cvt_pk_bf16_f32 v31, v230, v231
    ds_write_b128 v252, v[28:31] offset:20480
    v_lshlrev_b32 v216, 16, v32
    v_and_b32 v217, 0xffff0000, v32
    v_lshlrev_b32 v218, 16, v33
    v_and_b32 v219, 0xffff0000, v33
    v_lshlrev_b32 v220, 16, v34
    v_and_b32 v221, 0xffff0000, v34
    v_lshlrev_b32 v222, 16, v35
    v_and_b32 v223, 0xffff0000, v35
    buffer_load_dwordx4 a[168:171], v241, s[12:15], s20 offen offset:2048
    v_pk_fma_f32 v[216:217], v[216:217], v[214:215], v[204:205] op_sel_hi:[1,0,0]
    v_pk_fma_f32 v[218:219], v[218:219], v[214:215], v[204:205] op_sel_hi:[1,0,0]
    v_pk_fma_f32 v[220:221], v[220:221], v[214:215], v[204:205] op_sel_hi:[1,0,0]
    v_pk_fma_f32 v[222:223], v[222:223], v[214:215], v[204:205] op_sel_hi:[1,0,0]
    v_cvt_pk_bf16_f32 v32, v216, v217
    v_cvt_pk_bf16_f32 v33, v218, v219
    v_cvt_pk_bf16_f32 v34, v220, v221
    v_cvt_pk_bf16_f32 v35, v222, v223
    ds_write_b128 v252, v[32:35] offset:24576
    v_lshlrev_b32 v224, 16, v36
    v_and_b32 v225, 0xffff0000, v36
    v_lshlrev_b32 v226, 16, v37
    v_and_b32 v227, 0xffff0000, v37
    v_lshlrev_b32 v228, 16, v38
    v_and_b32 v229, 0xffff0000, v38
    v_lshlrev_b32 v230, 16, v39
    v_and_b32 v231, 0xffff0000, v39
    buffer_load_dwordx4 a[172:175], v241, s[12:15], s20 offen offset:3072
    v_pk_fma_f32 v[224:225], v[224:225], v[214:215], v[204:205] op_sel_hi:[1,0,0]
    v_pk_fma_f32 v[226:227], v[226:227], v[214:215], v[204:205] op_sel_hi:[1,0,0]
    v_pk_fma_f32 v[228:229], v[228:229], v[214:215], v[204:205] op_sel_hi:[1,0,0]
    v_pk_fma_f32 v[230:231], v[230:231], v[214:215], v[204:205] op_sel_hi:[1,0,0]
    v_cvt_pk_bf16_f32 v36, v224, v225
    v_cvt_pk_bf16_f32 v37, v226, v227
    v_cvt_pk_bf16_f32 v38, v228, v229
    v_cvt_pk_bf16_f32 v39, v230, v231
    ds_write_b128 v252, v[36:39] offset:28672
    v_lshlrev_b32 v216, 16, v40
    v_and_b32 v217, 0xffff0000, v40
    v_lshlrev_b32 v218, 16, v41
    v_and_b32 v219, 0xffff0000, v41
    v_lshlrev_b32 v220, 16, v42
    v_and_b32 v221, 0xffff0000, v42
    v_lshlrev_b32 v222, 16, v43
    v_and_b32 v223, 0xffff0000, v43
    s_add_u32 s20, s20, 4096
    buffer_load_dwordx4 a[176:179], v241, s[12:15], s20 offen offset:0
    v_pk_fma_f32 v[216:217], v[216:217], v[214:215], v[204:205] op_sel_hi:[1,0,0]
    v_pk_fma_f32 v[218:219], v[218:219], v[214:215], v[204:205] op_sel_hi:[1,0,0]
    v_pk_fma_f32 v[220:221], v[220:221], v[214:215], v[204:205] op_sel_hi:[1,0,0]
    v_pk_fma_f32 v[222:223], v[222:223], v[214:215], v[204:205] op_sel_hi:[1,0,0]
    v_cvt_pk_bf16_f32 v40, v216, v217
    v_cvt_pk_bf16_f32 v41, v218, v219
    v_cvt_pk_bf16_f32 v42, v220, v221
    v_cvt_pk_bf16_f32 v43, v222, v223
    ds_write_b128 v252, v[40:43] offset:32768
    v_lshlrev_b32 v224, 16, v44
    v_and_b32 v225, 0xffff0000, v44
    v_lshlrev_b32 v226, 16, v45
    v_and_b32 v227, 0xffff0000, v45
    v_lshlrev_b32 v228, 16, v46
    v_and_b32 v229, 0xffff0000, v46
    v_lshlrev_b32 v230, 16, v47
    v_and_b32 v231, 0xffff0000, v47
    v_pk_fma_f32 v[224:225], v[224:225], v[214:215], v[204:205] op_sel_hi:[1,0,0]
    v_pk_fma_f32 v[226:227], v[226:227], v[214:215], v[204:205] op_sel_hi:[1,0,0]
    v_pk_fma_f32 v[228:229], v[228:229], v[214:215], v[204:205] op_sel_hi:[1,0,0]
    v_pk_fma_f32 v[230:231], v[230:231], v[214:215], v[204:205] op_sel_hi:[1,0,0]
    v_cvt_pk_bf16_f32 v44, v224, v225
    v_cvt_pk_bf16_f32 v45, v226, v227
    v_cvt_pk_bf16_f32 v46, v228, v229
    v_cvt_pk_bf16_f32 v47, v230, v231
    ds_write_b128 v252, v[44:47] offset:36864
    buffer_load_dwordx4 a[180:183], v241, s[12:15], s20 offen offset:1024
    v_lshlrev_b32 v216, 16, v48
    v_and_b32 v217, 0xffff0000, v48
    v_lshlrev_b32 v218, 16, v49
    v_and_b32 v219, 0xffff0000, v49
    v_lshlrev_b32 v220, 16, v50
    v_and_b32 v221, 0xffff0000, v50
    v_lshlrev_b32 v222, 16, v51
    v_and_b32 v223, 0xffff0000, v51
    v_pk_fma_f32 v[216:217], v[216:217], v[214:215], v[204:205] op_sel_hi:[1,0,0]
    v_pk_fma_f32 v[218:219], v[218:219], v[214:215], v[204:205] op_sel_hi:[1,0,0]
    v_pk_fma_f32 v[220:221], v[220:221], v[214:215], v[204:205] op_sel_hi:[1,0,0]
    v_pk_fma_f32 v[222:223], v[222:223], v[214:215], v[204:205] op_sel_hi:[1,0,0]
    v_cvt_pk_bf16_f32 v48, v216, v217
    v_cvt_pk_bf16_f32 v49, v218, v219
    v_cvt_pk_bf16_f32 v50, v220, v221
    v_cvt_pk_bf16_f32 v51, v222, v223
    ds_write_b128 v252, v[48:51] offset:40960
    buffer_load_dwordx4 a[184:187], v241, s[12:15], s20 offen offset:2048
    v_lshlrev_b32 v224, 16, v52
    v_and_b32 v225, 0xffff0000, v52
    v_lshlrev_b32 v226, 16, v53
    v_and_b32 v227, 0xffff0000, v53
    v_lshlrev_b32 v228, 16, v54
    v_and_b32 v229, 0xffff0000, v54
    v_lshlrev_b32 v230, 16, v55
    v_and_b32 v231, 0xffff0000, v55
    v_pk_fma_f32 v[224:225], v[224:225], v[214:215], v[204:205] op_sel_hi:[1,0,0]
    v_pk_fma_f32 v[226:227], v[226:227], v[214:215], v[204:205] op_sel_hi:[1,0,0]
    v_pk_fma_f32 v[228:229], v[228:229], v[214:215], v[204:205] op_sel_hi:[1,0,0]
    v_pk_fma_f32 v[230:231], v[230:231], v[214:215], v[204:205] op_sel_hi:[1,0,0]
    v_cvt_pk_bf16_f32 v52, v224, v225
    v_cvt_pk_bf16_f32 v53, v226, v227
    v_cvt_pk_bf16_f32 v54, v228, v229
    v_cvt_pk_bf16_f32 v55, v230, v231
    ds_write_b128 v252, v[52:55] offset:45056
    buffer_load_dwordx4 a[188:191], v241, s[12:15], s20 offen offset:3072
    v_lshlrev_b32 v216, 16, v56
    v_and_b32 v217, 0xffff0000, v56
    v_lshlrev_b32 v218, 16, v57
    v_and_b32 v219, 0xffff0000, v57
    v_lshlrev_b32 v220, 16, v58
    v_and_b32 v221, 0xffff0000, v58
    v_lshlrev_b32 v222, 16, v59
    v_and_b32 v223, 0xffff0000, v59
    v_pk_fma_f32 v[216:217], v[216:217], v[214:215], v[204:205] op_sel_hi:[1,0,0]
    v_pk_fma_f32 v[218:219], v[218:219], v[214:215], v[204:205] op_sel_hi:[1,0,0]
    v_pk_fma_f32 v[220:221], v[220:221], v[214:215], v[204:205] op_sel_hi:[1,0,0]
    v_pk_fma_f32 v[222:223], v[222:223], v[214:215], v[204:205] op_sel_hi:[1,0,0]
    v_cvt_pk_bf16_f32 v56, v216, v217
    v_cvt_pk_bf16_f32 v57, v218, v219
    v_cvt_pk_bf16_f32 v58, v220, v221
    v_cvt_pk_bf16_f32 v59, v222, v223
    ds_write_b128 v252, v[56:59] offset:49152
    s_add_u32 s20, s20, 4096
    buffer_load_dwordx4 a[192:195], v241, s[12:15], s20 offen offset:0
    v_lshlrev_b32 v224, 16, v60
    v_and_b32 v225, 0xffff0000, v60
    v_lshlrev_b32 v226, 16, v61
    v_and_b32 v227, 0xffff0000, v61
    v_lshlrev_b32 v228, 16, v62
    v_and_b32 v229, 0xffff0000, v62
    v_lshlrev_b32 v230, 16, v63
    v_and_b32 v231, 0xffff0000, v63
    v_pk_fma_f32 v[224:225], v[224:225], v[214:215], v[204:205] op_sel_hi:[1,0,0]
    v_pk_fma_f32 v[226:227], v[226:227], v[214:215], v[204:205] op_sel_hi:[1,0,0]
    v_pk_fma_f32 v[228:229], v[228:229], v[214:215], v[204:205] op_sel_hi:[1,0,0]
    v_pk_fma_f32 v[230:231], v[230:231], v[214:215], v[204:205] op_sel_hi:[1,0,0]
    v_cvt_pk_bf16_f32 v60, v224, v225
    v_cvt_pk_bf16_f32 v61, v226, v227
    v_cvt_pk_bf16_f32 v62, v228, v229
    v_cvt_pk_bf16_f32 v63, v230, v231
    ds_write_b128 v252, v[60:63] offset:53248
    buffer_load_dwordx4 a[196:199], v241, s[12:15], s20 offen offset:1024
    v_lshlrev_b32 v216, 16, v64
    v_and_b32 v217, 0xffff0000, v64
    v_lshlrev_b32 v218, 16, v65
    v_and_b32 v219, 0xffff0000, v65
    v_lshlrev_b32 v220, 16, v66
    v_and_b32 v221, 0xffff0000, v66
    v_lshlrev_b32 v222, 16, v67
    v_and_b32 v223, 0xffff0000, v67
    v_pk_fma_f32 v[216:217], v[216:217], v[214:215], v[204:205] op_sel_hi:[1,0,0]
    v_pk_fma_f32 v[218:219], v[218:219], v[214:215], v[204:205] op_sel_hi:[1,0,0]
    v_pk_fma_f32 v[220:221], v[220:221], v[214:215], v[204:205] op_sel_hi:[1,0,0]
    v_pk_fma_f32 v[222:223], v[222:223], v[214:215], v[204:205] op_sel_hi:[1,0,0]
    v_cvt_pk_bf16_f32 v64, v216, v217
    v_cvt_pk_bf16_f32 v65, v218, v219
    v_cvt_pk_bf16_f32 v66, v220, v221
    v_cvt_pk_bf16_f32 v67, v222, v223
    ds_write_b128 v252, v[64:67] offset:57344
    buffer_load_dwordx4 a[200:203], v241, s[12:15], s20 offen offset:2048
    v_lshlrev_b32 v224, 16, v68
    v_and_b32 v225, 0xffff0000, v68
    v_lshlrev_b32 v226, 16, v69
    v_and_b32 v227, 0xffff0000, v69
    v_lshlrev_b32 v228, 16, v70
    v_and_b32 v229, 0xffff0000, v70
    v_lshlrev_b32 v230, 16, v71
    v_and_b32 v231, 0xffff0000, v71
    v_pk_fma_f32 v[224:225], v[224:225], v[214:215], v[204:205] op_sel_hi:[1,0,0]
    v_pk_fma_f32 v[226:227], v[226:227], v[214:215], v[204:205] op_sel_hi:[1,0,0]
    v_pk_fma_f32 v[228:229], v[228:229], v[214:215], v[204:205] op_sel_hi:[1,0,0]
    v_pk_fma_f32 v[230:231], v[230:231], v[214:215], v[204:205] op_sel_hi:[1,0,0]
    v_cvt_pk_bf16_f32 v68, v224, v225
    v_cvt_pk_bf16_f32 v69, v226, v227
    v_cvt_pk_bf16_f32 v70, v228, v229
    v_cvt_pk_bf16_f32 v71, v230, v231
    ds_write_b128 v252, v[68:71] offset:61440
    buffer_load_dwordx4 a[204:207], v241, s[12:15], s20 offen offset:3072
    v_lshlrev_b32 v216, 16, v72
    v_and_b32 v217, 0xffff0000, v72
    v_lshlrev_b32 v218, 16, v73
    v_and_b32 v219, 0xffff0000, v73
    v_lshlrev_b32 v220, 16, v74
    v_and_b32 v221, 0xffff0000, v74
    v_lshlrev_b32 v222, 16, v75
    v_and_b32 v223, 0xffff0000, v75
    v_pk_fma_f32 v[216:217], v[216:217], v[214:215], v[204:205] op_sel_hi:[1,0,0]
    v_pk_fma_f32 v[218:219], v[218:219], v[214:215], v[204:205] op_sel_hi:[1,0,0]
    v_pk_fma_f32 v[220:221], v[220:221], v[214:215], v[204:205] op_sel_hi:[1,0,0]
    v_pk_fma_f32 v[222:223], v[222:223], v[214:215], v[204:205] op_sel_hi:[1,0,0]
    v_cvt_pk_bf16_f32 v72, v216, v217
    v_cvt_pk_bf16_f32 v73, v218, v219
    v_cvt_pk_bf16_f32 v74, v220, v221
    v_cvt_pk_bf16_f32 v75, v222, v223
    v_add_u32 v252, 0x10000, v252
    ds_write_b128 v252, v[72:75] offset:0
    s_add_u32 s20, s20, 4096
    buffer_load_dwordx4 a[208:211], v241, s[12:15], s20 offen offset:0
    v_lshlrev_b32 v224, 16, v76
    v_and_b32 v225, 0xffff0000, v76
    v_lshlrev_b32 v226, 16, v77
    v_and_b32 v227, 0xffff0000, v77
    v_lshlrev_b32 v228, 16, v78
    v_and_b32 v229, 0xffff0000, v78
    v_lshlrev_b32 v230, 16, v79
    v_and_b32 v231, 0xffff0000, v79
    v_pk_fma_f32 v[224:225], v[224:225], v[214:215], v[204:205] op_sel_hi:[1,0,0]
    v_pk_fma_f32 v[226:227], v[226:227], v[214:215], v[204:205] op_sel_hi:[1,0,0]
    v_pk_fma_f32 v[228:229], v[228:229], v[214:215], v[204:205] op_sel_hi:[1,0,0]
    v_pk_fma_f32 v[230:231], v[230:231], v[214:215], v[204:205] op_sel_hi:[1,0,0]
    v_cvt_pk_bf16_f32 v76, v224, v225
    v_cvt_pk_bf16_f32 v77, v226, v227
    v_cvt_pk_bf16_f32 v78, v228, v229
    v_cvt_pk_bf16_f32 v79, v230, v231
    ds_write_b128 v252, v[76:79] offset:4096
    buffer_load_dwordx4 a[212:215], v241, s[12:15], s20 offen offset:1024
    v_lshlrev_b32 v188, 16, v180
    v_and_b32 v189, 0xffff0000, v180
    v_lshlrev_b32 v190, 16, v181
    v_and_b32 v191, 0xffff0000, v181
    v_mul_f32 v188, 0x3eeff558, v188
    v_mul_f32 v189, 0x3eeff558, v189
    v_mul_f32 v190, 0x3eeff558, v190
    v_mul_f32 v191, 0x3eeff558, v191
    v_lshlrev_b32 v192, 16, v182
    v_and_b32 v193, 0xffff0000, v182
    v_lshlrev_b32 v194, 16, v183
    v_and_b32 v195, 0xffff0000, v183
    v_mul_f32 v192, 0x3eeff558, v192
    v_mul_f32 v193, 0x3eeff558, v193
    v_mul_f32 v194, 0x3eeff558, v194
    v_mul_f32 v195, 0x3eeff558, v195
    v_lshlrev_b32 v196, 16, v184
    v_and_b32 v197, 0xffff0000, v184
    v_lshlrev_b32 v198, 16, v185
    v_and_b32 v199, 0xffff0000, v185
    v_mul_f32 v196, 0x3eeff558, v196
    v_mul_f32 v197, 0x3eeff558, v197
    v_mul_f32 v198, 0x3eeff558, v198
    v_mul_f32 v199, 0x3eeff558, v199
    s_waitcnt lgkmcnt(0)
    s_barrier
    ds_read_b128 v[148:151], v241 offset:0
    ds_read_b128 v[152:155], v241 offset:1024
    ds_read_b128 v[156:159], v241 offset:2048
    ds_read_b128 v[160:163], v241 offset:3072
    s_waitcnt lgkmcnt(3)
    v_mfma_f32_16x16x32_bf16 v[4:7], a[0:3], v[148:151], v[188:191]
    s_waitcnt lgkmcnt(2)
    v_mfma_f32_16x16x32_bf16 v[8:11], a[0:3], v[152:155], v[188:191]
    ds_read_b128 v[164:167], v241 offset:4096
    s_waitcnt lgkmcnt(2)
    v_mfma_f32_16x16x32_bf16 v[12:15], a[0:3], v[156:159], v[188:191]
    ds_read_b128 v[168:171], v241 offset:5120
    s_waitcnt lgkmcnt(2)
    v_mfma_f32_16x16x32_bf16 v[16:19], a[0:3], v[160:163], v[188:191]
    ds_read_b128 v[172:175], v241 offset:6144
    v_mfma_f32_16x16x32_bf16 v[20:23], a[4:7], v[148:151], v[192:195]
    buffer_load_dwordx4 a[0:3], v241, s[12:15], s20 offen offset:2048
    v_mfma_f32_16x16x32_bf16 v[24:27], a[4:7], v[152:155], v[192:195]
    ds_read_b128 v[176:179], v241 offset:7168
    v_mfma_f32_16x16x32_bf16 v[28:31], a[4:7], v[156:159], v[192:195]
    v_mfma_f32_16x16x32_bf16 v[32:35], a[4:7], v[160:163], v[192:195]
    v_mfma_f32_16x16x32_bf16 v[36:39], a[8:11], v[148:151], v[196:199]
    buffer_load_dwordx4 a[4:7], v241, s[12:15], s20 offen offset:3072
    v_mfma_f32_16x16x32_bf16 v[40:43], a[8:11], v[152:155], v[196:199]
    v_mfma_f32_16x16x32_bf16 v[44:47], a[8:11], v[156:159], v[196:199]
    v_mfma_f32_16x16x32_bf16 v[48:51], a[8:11], v[160:163], v[196:199]
    s_waitcnt lgkmcnt(0)
    v_mfma_f32_16x16x32_bf16 v[4:7], a[12:15], v[164:167], v[4:7]
    s_add_u32 s20, s20, 4096
    buffer_load_dwordx4 a[8:11], v241, s[12:15], s20 offen offset:0
    v_mfma_f32_16x16x32_bf16 v[8:11], a[12:15], v[168:171], v[8:11]
    ds_read_b128 v[148:151], v241 offset:8192
    v_mfma_f32_16x16x32_bf16 v[12:15], a[12:15], v[172:175], v[12:15]
    ds_read_b128 v[152:155], v241 offset:9216
    v_mfma_f32_16x16x32_bf16 v[16:19], a[12:15], v[176:179], v[16:19]
    ds_read_b128 v[156:159], v241 offset:10240
    v_mfma_f32_16x16x32_bf16 v[20:23], a[16:19], v[164:167], v[20:23]
    buffer_load_dwordx4 a[12:15], v241, s[12:15], s20 offen offset:1024
    v_mfma_f32_16x16x32_bf16 v[24:27], a[16:19], v[168:171], v[24:27]
    ds_read_b128 v[160:163], v241 offset:11264
    v_mfma_f32_16x16x32_bf16 v[28:31], a[16:19], v[172:175], v[28:31]
    buffer_load_dwordx2 v[180:181], v253, s[4:7], s25 offen offset:384
    v_mfma_f32_16x16x32_bf16 v[32:35], a[16:19], v[176:179], v[32:35]
    v_mfma_f32_16x16x32_bf16 v[36:39], a[20:23], v[164:167], v[36:39]
    buffer_load_dwordx4 a[16:19], v241, s[12:15], s20 offen offset:2048
    v_mfma_f32_16x16x32_bf16 v[40:43], a[20:23], v[168:171], v[40:43]
    v_mfma_f32_16x16x32_bf16 v[44:47], a[20:23], v[172:175], v[44:47]
    v_mfma_f32_16x16x32_bf16 v[48:51], a[20:23], v[176:179], v[48:51]
    s_waitcnt lgkmcnt(0)
    v_mfma_f32_16x16x32_bf16 v[4:7], a[24:27], v[148:151], v[4:7]
    v_mfma_f32_16x16x32_bf16 v[8:11], a[24:27], v[152:155], v[8:11]
    ds_read_b128 v[164:167], v241 offset:12288
    v_mfma_f32_16x16x32_bf16 v[12:15], a[24:27], v[156:159], v[12:15]
    ds_read_b128 v[168:171], v241 offset:13312
    v_mfma_f32_16x16x32_bf16 v[16:19], a[24:27], v[160:163], v[16:19]
    ds_read_b128 v[172:175], v241 offset:14336
    v_mfma_f32_16x16x32_bf16 v[20:23], a[28:31], v[148:151], v[20:23]
    buffer_load_dwordx4 a[20:23], v241, s[12:15], s20 offen offset:3072
    v_mfma_f32_16x16x32_bf16 v[24:27], a[28:31], v[152:155], v[24:27]
    ds_read_b128 v[176:179], v241 offset:15360
    v_mfma_f32_16x16x32_bf16 v[28:31], a[28:31], v[156:159], v[28:31]
    buffer_load_dwordx2 v[182:183], v253, s[4:7], s25 offen offset:416
    v_mfma_f32_16x16x32_bf16 v[32:35], a[28:31], v[160:163], v[32:35]
    v_mfma_f32_16x16x32_bf16 v[36:39], a[32:35], v[148:151], v[36:39]
    s_add_u32 s20, s20, 4096
    buffer_load_dwordx4 a[24:27], v241, s[12:15], s20 offen offset:0
    v_mfma_f32_16x16x32_bf16 v[40:43], a[32:35], v[152:155], v[40:43]
    v_mfma_f32_16x16x32_bf16 v[44:47], a[32:35], v[156:159], v[44:47]
    v_mfma_f32_16x16x32_bf16 v[48:51], a[32:35], v[160:163], v[48:51]
    s_waitcnt lgkmcnt(0)
    v_mfma_f32_16x16x32_bf16 v[4:7], a[36:39], v[164:167], v[4:7]
    buffer_load_dwordx4 a[28:31], v241, s[12:15], s20 offen offset:1024
    v_mfma_f32_16x16x32_bf16 v[8:11], a[36:39], v[168:171], v[8:11]
    ds_read_b128 v[148:151], v241 offset:16384
    v_mfma_f32_16x16x32_bf16 v[12:15], a[36:39], v[172:175], v[12:15]
    ds_read_b128 v[152:155], v241 offset:17408
    v_mfma_f32_16x16x32_bf16 v[16:19], a[36:39], v[176:179], v[16:19]
    ds_read_b128 v[156:159], v241 offset:18432
    v_mfma_f32_16x16x32_bf16 v[20:23], a[40:43], v[164:167], v[20:23]
    buffer_load_dwordx4 a[32:35], v241, s[12:15], s20 offen offset:2048
    v_mfma_f32_16x16x32_bf16 v[24:27], a[40:43], v[168:171], v[24:27]
    ds_read_b128 v[160:163], v241 offset:19456
    v_mfma_f32_16x16x32_bf16 v[28:31], a[40:43], v[172:175], v[28:31]
    buffer_load_dwordx2 v[184:185], v253, s[4:7], s23 offen offset:640
    v_mfma_f32_16x16x32_bf16 v[32:35], a[40:43], v[176:179], v[32:35]
    v_mfma_f32_16x16x32_bf16 v[36:39], a[44:47], v[164:167], v[36:39]
    v_mfma_f32_16x16x32_bf16 v[40:43], a[44:47], v[168:171], v[40:43]
    v_mfma_f32_16x16x32_bf16 v[44:47], a[44:47], v[172:175], v[44:47]
    v_mfma_f32_16x16x32_bf16 v[48:51], a[44:47], v[176:179], v[48:51]
    s_waitcnt lgkmcnt(0)
    v_mfma_f32_16x16x32_bf16 v[4:7], a[48:51], v[148:151], v[4:7]
    buffer_load_dwordx4 a[36:39], v241, s[12:15], s20 offen offset:3072
    v_mfma_f32_16x16x32_bf16 v[8:11], a[48:51], v[152:155], v[8:11]
    ds_read_b128 v[164:167], v241 offset:20480
    v_mfma_f32_16x16x32_bf16 v[12:15], a[48:51], v[156:159], v[12:15]
    ds_read_b128 v[168:171], v241 offset:21504
    v_mfma_f32_16x16x32_bf16 v[16:19], a[48:51], v[160:163], v[16:19]
    ds_read_b128 v[172:175], v241 offset:22528
    v_mfma_f32_16x16x32_bf16 v[20:23], a[52:55], v[148:151], v[20:23]
    s_add_u32 s20, s20, 4096
    buffer_load_dwordx4 a[40:43], v241, s[12:15], s20 offen offset:0
    v_mfma_f32_16x16x32_bf16 v[24:27], a[52:55], v[152:155], v[24:27]
    ds_read_b128 v[176:179], v241 offset:23552
    v_mfma_f32_16x16x32_bf16 v[28:31], a[52:55], v[156:159], v[28:31]
    buffer_load_dwordx4 a[216:219], v1, s[12:15], s38 offen sc1
    v_mfma_f32_16x16x32_bf16 v[32:35], a[52:55], v[160:163], v[32:35]
    v_mfma_f32_16x16x32_bf16 v[36:39], a[56:59], v[148:151], v[36:39]
    buffer_load_dwordx4 a[44:47], v241, s[12:15], s20 offen offset:1024
    v_mfma_f32_16x16x32_bf16 v[40:43], a[56:59], v[152:155], v[40:43]
    v_mfma_f32_16x16x32_bf16 v[44:47], a[56:59], v[156:159], v[44:47]
    v_mfma_f32_16x16x32_bf16 v[48:51], a[56:59], v[160:163], v[48:51]
    s_waitcnt lgkmcnt(0)
    v_mfma_f32_16x16x32_bf16 v[4:7], a[60:63], v[164:167], v[4:7]
    buffer_load_dwordx4 a[48:51], v241, s[12:15], s20 offen offset:2048
    v_mfma_f32_16x16x32_bf16 v[8:11], a[60:63], v[168:171], v[8:11]
    ds_read_b128 v[148:151], v241 offset:24576
    v_mfma_f32_16x16x32_bf16 v[12:15], a[60:63], v[172:175], v[12:15]
    ds_read_b128 v[152:155], v241 offset:25600
    v_mfma_f32_16x16x32_bf16 v[16:19], a[60:63], v[176:179], v[16:19]
    ds_read_b128 v[156:159], v241 offset:26624
    v_mfma_f32_16x16x32_bf16 v[20:23], a[64:67], v[164:167], v[20:23]
    buffer_load_dwordx4 a[52:55], v241, s[12:15], s20 offen offset:3072
    v_mfma_f32_16x16x32_bf16 v[24:27], a[64:67], v[168:171], v[24:27]
    ds_read_b128 v[160:163], v241 offset:27648
    v_mfma_f32_16x16x32_bf16 v[28:31], a[64:67], v[172:175], v[28:31]
    buffer_load_dwordx4 a[220:223], v1, s[12:15], s39 offen sc1
    v_mfma_f32_16x16x32_bf16 v[32:35], a[64:67], v[176:179], v[32:35]
    v_mfma_f32_16x16x32_bf16 v[36:39], a[68:71], v[164:167], v[36:39]
    v_mfma_f32_16x16x32_bf16 v[40:43], a[68:71], v[168:171], v[40:43]
    v_mfma_f32_16x16x32_bf16 v[44:47], a[68:71], v[172:175], v[44:47]
    v_mfma_f32_16x16x32_bf16 v[48:51], a[68:71], v[176:179], v[48:51]
    s_waitcnt vmcnt(52) lgkmcnt(0)
    v_mfma_f32_16x16x32_bf16 v[4:7], a[72:75], v[148:151], v[4:7]
    s_add_u32 s20, s20, 4096
    buffer_load_dwordx4 a[56:59], v241, s[12:15], s20 offen offset:0
    v_mfma_f32_16x16x32_bf16 v[8:11], a[72:75], v[152:155], v[8:11]
    ds_read_b128 v[164:167], v241 offset:28672
    v_mfma_f32_16x16x32_bf16 v[12:15], a[72:75], v[156:159], v[12:15]
    ds_read_b128 v[168:171], v241 offset:29696
    v_mfma_f32_16x16x32_bf16 v[16:19], a[72:75], v[160:163], v[16:19]
    ds_read_b128 v[172:175], v241 offset:30720
    v_mfma_f32_16x16x32_bf16 v[20:23], a[76:79], v[148:151], v[20:23]
    buffer_load_dwordx4 a[60:63], v241, s[12:15], s20 offen offset:1024
    v_mfma_f32_16x16x32_bf16 v[24:27], a[76:79], v[152:155], v[24:27]
    ds_read_b128 v[176:179], v241 offset:31744
    v_mfma_f32_16x16x32_bf16 v[28:31], a[76:79], v[156:159], v[28:31]
    buffer_load_dwordx4 a[224:227], v1, s[12:15], s40 offen sc1
    v_mfma_f32_16x16x32_bf16 v[32:35], a[76:79], v[160:163], v[32:35]
    v_mfma_f32_16x16x32_bf16 v[36:39], a[80:83], v[148:151], v[36:39]
    buffer_load_dwordx4 a[64:67], v241, s[12:15], s20 offen offset:2048
    v_mfma_f32_16x16x32_bf16 v[40:43], a[80:83], v[152:155], v[40:43]
    v_mfma_f32_16x16x32_bf16 v[44:47], a[80:83], v[156:159], v[44:47]
    v_mfma_f32_16x16x32_bf16 v[48:51], a[80:83], v[160:163], v[48:51]
    s_waitcnt vmcnt(53) lgkmcnt(0)
    v_mfma_f32_16x16x32_bf16 v[4:7], a[84:87], v[164:167], v[4:7]
    buffer_load_dwordx4 a[68:71], v241, s[12:15], s20 offen offset:3072
    v_mfma_f32_16x16x32_bf16 v[8:11], a[84:87], v[168:171], v[8:11]
    ds_read_b128 v[148:151], v241 offset:32768
    v_mfma_f32_16x16x32_bf16 v[12:15], a[84:87], v[172:175], v[12:15]
    ds_read_b128 v[152:155], v241 offset:33792
    v_mfma_f32_16x16x32_bf16 v[16:19], a[84:87], v[176:179], v[16:19]
    ds_read_b128 v[156:159], v241 offset:34816
    v_mfma_f32_16x16x32_bf16 v[20:23], a[88:91], v[164:167], v[20:23]
    v_mfma_f32_16x16x32_bf16 v[24:27], a[88:91], v[168:171], v[24:27]
    ds_read_b128 v[160:163], v241 offset:35840
    v_mfma_f32_16x16x32_bf16 v[28:31], a[88:91], v[172:175], v[28:31]
    buffer_load_dwordx4 a[228:231], v3, s[56:59], s42 offen offset:0
    v_mfma_f32_16x16x32_bf16 v[32:35], a[88:91], v[176:179], v[32:35]
    v_mfma_f32_16x16x32_bf16 v[36:39], a[92:95], v[164:167], v[36:39]
    s_add_u32 s20, s20, 4096
    buffer_load_dwordx4 a[72:75], v241, s[12:15], s20 offen offset:0
    v_mfma_f32_16x16x32_bf16 v[40:43], a[92:95], v[168:171], v[40:43]
    v_mfma_f32_16x16x32_bf16 v[44:47], a[92:95], v[172:175], v[44:47]
    v_mfma_f32_16x16x32_bf16 v[48:51], a[92:95], v[176:179], v[48:51]
    s_waitcnt vmcnt(53) lgkmcnt(0)
    v_mfma_f32_16x16x32_bf16 v[4:7], a[96:99], v[148:151], v[4:7]
    buffer_load_dwordx4 a[76:79], v241, s[12:15], s20 offen offset:1024
    v_mfma_f32_16x16x32_bf16 v[8:11], a[96:99], v[152:155], v[8:11]
    ds_read_b128 v[164:167], v241 offset:36864
    s_waitcnt vmcnt(22)
    v_lshlrev_b32 v188, 16, v180
    v_mfma_f32_16x16x32_bf16 v[12:15], a[96:99], v[156:159], v[12:15]
    ds_read_b128 v[168:171], v241 offset:37888
    v_mfma_f32_16x16x32_bf16 v[16:19], a[96:99], v[160:163], v[16:19]
    ds_read_b128 v[172:175], v241 offset:38912
    v_mfma_f32_16x16x32_bf16 v[20:23], a[100:103], v[148:151], v[20:23]
    buffer_load_dwordx4 a[80:83], v241, s[12:15], s20 offen offset:2048
    v_and_b32 v189, 0xffff0000, v180
    v_mfma_f32_16x16x32_bf16 v[24:27], a[100:103], v[152:155], v[24:27]
    ds_read_b128 v[176:179], v241 offset:39936
    v_mfma_f32_16x16x32_bf16 v[28:31], a[100:103], v[156:159], v[28:31]
    buffer_load_dwordx4 a[232:235], v3, s[56:59], s42 offen offset:96
    v_mfma_f32_16x16x32_bf16 v[32:35], a[100:103], v[160:163], v[32:35]
    v_mfma_f32_16x16x32_bf16 v[36:39], a[104:107], v[148:151], v[36:39]
    buffer_load_dwordx4 a[84:87], v241, s[12:15], s20 offen offset:3072
    v_mfma_f32_16x16x32_bf16 v[40:43], a[104:107], v[152:155], v[40:43]
    v_lshlrev_b32 v190, 16, v181
    v_mfma_f32_16x16x32_bf16 v[44:47], a[104:107], v[156:159], v[44:47]
    v_mfma_f32_16x16x32_bf16 v[48:51], a[104:107], v[160:163], v[48:51]
    s_waitcnt lgkmcnt(0)
    v_mfma_f32_16x16x32_bf16 v[4:7], a[108:111], v[164:167], v[4:7]
    v_mfma_f32_16x16x32_bf16 v[8:11], a[108:111], v[168:171], v[8:11]
    ds_read_b128 v[148:151], v241 offset:40960
    v_and_b32 v191, 0xffff0000, v181
    v_mfma_f32_16x16x32_bf16 v[12:15], a[108:111], v[172:175], v[12:15]
    ds_read_b128 v[152:155], v241 offset:41984
    v_mfma_f32_16x16x32_bf16 v[16:19], a[108:111], v[176:179], v[16:19]
    ds_read_b128 v[156:159], v241 offset:43008
    v_mfma_f32_16x16x32_bf16 v[20:23], a[112:115], v[164:167], v[20:23]
    s_add_u32 s20, s20, 4096
    buffer_load_dwordx4 a[88:91], v241, s[12:15], s20 offen offset:0
    v_mul_f32 v188, 0x3eeff558, v188
    v_mfma_f32_16x16x32_bf16 v[24:27], a[112:115], v[168:171], v[24:27]
    ds_read_b128 v[160:163], v241 offset:44032
    v_mfma_f32_16x16x32_bf16 v[28:31], a[112:115], v[172:175], v[28:31]
    buffer_load_dwordx4 a[236:239], v3, s[56:59], s42 offen offset:192
    v_mfma_f32_16x16x32_bf16 v[32:35], a[112:115], v[176:179], v[32:35]
    v_mfma_f32_16x16x32_bf16 v[36:39], a[116:119], v[164:167], v[36:39]
    buffer_load_dwordx4 a[92:95], v241, s[12:15], s20 offen offset:1024
    v_mfma_f32_16x16x32_bf16 v[40:43], a[116:119], v[168:171], v[40:43]
    v_mul_f32 v189, 0x3eeff558, v189
    v_mfma_f32_16x16x32_bf16 v[44:47], a[116:119], v[172:175], v[44:47]
    v_mfma_f32_16x16x32_bf16 v[48:51], a[116:119], v[176:179], v[48:51]
    s_waitcnt lgkmcnt(0)
    v_mfma_f32_16x16x32_bf16 v[4:7], a[120:123], v[148:151], v[4:7]
    buffer_load_dwordx4 a[96:99], v241, s[12:15], s20 offen offset:2048
    v_mfma_f32_16x16x32_bf16 v[8:11], a[120:123], v[152:155], v[8:11]
    ds_read_b128 v[164:167], v241 offset:45056
    v_mul_f32 v190, 0x3eeff558, v190
    v_mfma_f32_16x16x32_bf16 v[12:15], a[120:123], v[156:159], v[12:15]
    ds_read_b128 v[168:171], v241 offset:46080
    v_mfma_f32_16x16x32_bf16 v[16:19], a[120:123], v[160:163], v[16:19]
    ds_read_b128 v[172:175], v241 offset:47104
    v_mfma_f32_16x16x32_bf16 v[20:23], a[124:127], v[148:151], v[20:23]
    buffer_load_dwordx4 a[100:103], v241, s[12:15], s20 offen offset:3072
    v_mul_f32 v191, 0x3eeff558, v191
    v_mfma_f32_16x16x32_bf16 v[24:27], a[124:127], v[152:155], v[24:27]
    ds_read_b128 v[176:179], v241 offset:48128
    v_mfma_f32_16x16x32_bf16 v[28:31], a[124:127], v[156:159], v[28:31]
    v_mfma_f32_16x16x32_bf16 v[32:35], a[124:127], v[160:163], v[32:35]
    v_mfma_f32_16x16x32_bf16 v[36:39], a[128:131], v[148:151], v[36:39]
    s_add_u32 s20, s20, 4096
    buffer_load_dwordx4 a[104:107], v241, s[12:15], s20 offen offset:0
    v_mfma_f32_16x16x32_bf16 v[40:43], a[128:131], v[152:155], v[40:43]
    s_waitcnt vmcnt(28)
    v_lshlrev_b32 v192, 16, v182
    v_mfma_f32_16x16x32_bf16 v[44:47], a[128:131], v[156:159], v[44:47]
    v_mfma_f32_16x16x32_bf16 v[48:51], a[128:131], v[160:163], v[48:51]
    s_waitcnt lgkmcnt(0)
    v_mfma_f32_16x16x32_bf16 v[4:7], a[132:135], v[164:167], v[4:7]
    v_mfma_f32_16x16x32_bf16 v[8:11], a[132:135], v[168:171], v[8:11]
    ds_read_b128 v[148:151], v241 offset:49152
    v_and_b32 v193, 0xffff0000, v182
    v_mfma_f32_16x16x32_bf16 v[12:15], a[132:135], v[172:175], v[12:15]
    ds_read_b128 v[152:155], v241 offset:50176
    v_mfma_f32_16x16x32_bf16 v[16:19], a[132:135], v[176:179], v[16:19]
    ds_read_b128 v[156:159], v241 offset:51200
    v_mfma_f32_16x16x32_bf16 v[20:23], a[136:139], v[164:167], v[20:23]
    buffer_load_dwordx4 a[108:111], v241, s[12:15], s20 offen offset:1024
    v_lshlrev_b32 v194, 16, v183
    v_mfma_f32_16x16x32_bf16 v[24:27], a[136:139], v[168:171], v[24:27]
    ds_read_b128 v[160:163], v241 offset:52224
    v_mfma_f32_16x16x32_bf16 v[28:31], a[136:139], v[172:175], v[28:31]
    v_mfma_f32_16x16x32_bf16 v[32:35], a[136:139], v[176:179], v[32:35]
    v_mfma_f32_16x16x32_bf16 v[36:39], a[140:143], v[164:167], v[36:39]
    buffer_load_dwordx4 a[112:115], v241, s[12:15], s20 offen offset:2048
    v_mfma_f32_16x16x32_bf16 v[40:43], a[140:143], v[168:171], v[40:43]
    v_and_b32 v195, 0xffff0000, v183
    v_mfma_f32_16x16x32_bf16 v[44:47], a[140:143], v[172:175], v[44:47]
    v_mfma_f32_16x16x32_bf16 v[48:51], a[140:143], v[176:179], v[48:51]
    s_waitcnt lgkmcnt(0)
    v_mfma_f32_16x16x32_bf16 v[4:7], a[144:147], v[148:151], v[4:7]
    buffer_load_dwordx4 a[116:119], v241, s[12:15], s20 offen offset:3072
    v_mfma_f32_16x16x32_bf16 v[8:11], a[144:147], v[152:155], v[8:11]
    ds_read_b128 v[164:167], v241 offset:53248
    v_mul_f32 v192, 0x3eeff558, v192
    v_mfma_f32_16x16x32_bf16 v[12:15], a[144:147], v[156:159], v[12:15]
    ds_read_b128 v[168:171], v241 offset:54272
    v_mfma_f32_16x16x32_bf16 v[16:19], a[144:147], v[160:163], v[16:19]
    ds_read_b128 v[172:175], v241 offset:55296
    v_mfma_f32_16x16x32_bf16 v[20:23], a[148:151], v[148:151], v[20:23]
    s_add_u32 s20, s20, 4096
    buffer_load_dwordx4 a[120:123], v241, s[12:15], s20 offen offset:0
    v_mul_f32 v193, 0x3eeff558, v193
    v_mfma_f32_16x16x32_bf16 v[24:27], a[148:151], v[152:155], v[24:27]
    ds_read_b128 v[176:179], v241 offset:56320
    v_mfma_f32_16x16x32_bf16 v[28:31], a[148:151], v[156:159], v[28:31]
    v_mfma_f32_16x16x32_bf16 v[32:35], a[148:151], v[160:163], v[32:35]
    v_mfma_f32_16x16x32_bf16 v[36:39], a[152:155], v[148:151], v[36:39]
    v_mfma_f32_16x16x32_bf16 v[40:43], a[152:155], v[152:155], v[40:43]
    v_mul_f32 v194, 0x3eeff558, v194
    v_mfma_f32_16x16x32_bf16 v[44:47], a[152:155], v[156:159], v[44:47]
    v_mfma_f32_16x16x32_bf16 v[48:51], a[152:155], v[160:163], v[48:51]
    s_waitcnt lgkmcnt(0)
    v_mfma_f32_16x16x32_bf16 v[4:7], a[156:159], v[164:167], v[4:7]
    buffer_load_dwordx4 a[124:127], v241, s[12:15], s20 offen offset:1024
    v_mfma_f32_16x16x32_bf16 v[8:11], a[156:159], v[168:171], v[8:11]
    ds_read_b128 v[148:151], v241 offset:57344
    v_mul_f32 v195, 0x3eeff558, v195
    v_mfma_f32_16x16x32_bf16 v[12:15], a[156:159], v[172:175], v[12:15]
    ds_read_b128 v[152:155], v241 offset:58368
    v_mfma_f32_16x16x32_bf16 v[16:19], a[156:159], v[176:179], v[16:19]
    ds_read_b128 v[156:159], v241 offset:59392
    v_mfma_f32_16x16x32_bf16 v[20:23], a[160:163], v[164:167], v[20:23]
    buffer_load_dwordx4 a[128:131], v241, s[12:15], s20 offen offset:2048
    v_mfma_f32_16x16x32_bf16 v[24:27], a[160:163], v[168:171], v[24:27]
    ds_read_b128 v[160:163], v241 offset:60416
    s_waitcnt vmcnt(30)
    v_lshlrev_b32 v196, 16, v184
    v_mfma_f32_16x16x32_bf16 v[28:31], a[160:163], v[172:175], v[28:31]
    v_mfma_f32_16x16x32_bf16 v[32:35], a[160:163], v[176:179], v[32:35]
    v_mfma_f32_16x16x32_bf16 v[36:39], a[164:167], v[164:167], v[36:39]
    buffer_load_dwordx4 a[132:135], v241, s[12:15], s20 offen offset:3072
    v_mfma_f32_16x16x32_bf16 v[40:43], a[164:167], v[168:171], v[40:43]
    v_and_b32 v197, 0xffff0000, v184
    v_mfma_f32_16x16x32_bf16 v[44:47], a[164:167], v[172:175], v[44:47]
    v_mfma_f32_16x16x32_bf16 v[48:51], a[164:167], v[176:179], v[48:51]
    s_waitcnt lgkmcnt(0)
    v_mfma_f32_16x16x32_bf16 v[4:7], a[168:171], v[148:151], v[4:7]
    s_add_u32 s20, s20, 4096
    buffer_load_dwordx4 a[136:139], v241, s[12:15], s20 offen offset:0
    v_mfma_f32_16x16x32_bf16 v[8:11], a[168:171], v[152:155], v[8:11]
    ds_read_b128 v[164:167], v241 offset:61440
    v_lshlrev_b32 v198, 16, v185
    v_mfma_f32_16x16x32_bf16 v[12:15], a[168:171], v[156:159], v[12:15]
    ds_read_b128 v[168:171], v241 offset:62464
    v_mfma_f32_16x16x32_bf16 v[16:19], a[168:171], v[160:163], v[16:19]
    ds_read_b128 v[172:175], v241 offset:63488
    v_mfma_f32_16x16x32_bf16 v[20:23], a[172:175], v[148:151], v[20:23]
    buffer_load_dwordx4 a[140:143], v241, s[12:15], s20 offen offset:1024
    v_mfma_f32_16x16x32_bf16 v[24:27], a[172:175], v[152:155], v[24:27]
    ds_read_b128 v[176:179], v241 offset:64512
    v_and_b32 v199, 0xffff0000, v185
    v_mfma_f32_16x16x32_bf16 v[28:31], a[172:175], v[156:159], v[28:31]
    v_mfma_f32_16x16x32_bf16 v[32:35], a[172:175], v[160:163], v[32:35]
    v_mfma_f32_16x16x32_bf16 v[36:39], a[176:179], v[148:151], v[36:39]
    v_mfma_f32_16x16x32_bf16 v[40:43], a[176:179], v[152:155], v[40:43]
    v_mul_f32 v196, 0x3eeff558, v196
    v_mfma_f32_16x16x32_bf16 v[44:47], a[176:179], v[156:159], v[44:47]
    v_mfma_f32_16x16x32_bf16 v[48:51], a[176:179], v[160:163], v[48:51]
    s_waitcnt lgkmcnt(0)
    v_mfma_f32_16x16x32_bf16 v[4:7], a[180:183], v[164:167], v[4:7]
    buffer_load_dwordx4 a[144:147], v241, s[12:15], s20 offen offset:2048
    v_mfma_f32_16x16x32_bf16 v[8:11], a[180:183], v[168:171], v[8:11]
    ds_read_b128 v[148:151], v244 offset:0
    v_mul_f32 v197, 0x3eeff558, v197
    v_mfma_f32_16x16x32_bf16 v[12:15], a[180:183], v[172:175], v[12:15]
    ds_read_b128 v[152:155], v244 offset:1024
    v_mfma_f32_16x16x32_bf16 v[16:19], a[180:183], v[176:179], v[16:19]
    ds_read_b128 v[156:159], v244 offset:2048
    v_mfma_f32_16x16x32_bf16 v[20:23], a[184:187], v[164:167], v[20:23]
    buffer_load_dwordx4 a[148:151], v241, s[12:15], s20 offen offset:3072
    v_mfma_f32_16x16x32_bf16 v[24:27], a[184:187], v[168:171], v[24:27]
    ds_read_b128 v[160:163], v244 offset:3072
    v_mul_f32 v198, 0x3eeff558, v198
    v_mfma_f32_16x16x32_bf16 v[28:31], a[184:187], v[172:175], v[28:31]
    v_mfma_f32_16x16x32_bf16 v[32:35], a[184:187], v[176:179], v[32:35]
    v_mfma_f32_16x16x32_bf16 v[36:39], a[188:191], v[164:167], v[36:39]
    s_add_u32 s20, s20, 4096
    buffer_load_dwordx4 a[152:155], v241, s[12:15], s20 offen offset:0
    v_mfma_f32_16x16x32_bf16 v[40:43], a[188:191], v[168:171], v[40:43]
    v_mul_f32 v199, 0x3eeff558, v199
    v_mfma_f32_16x16x32_bf16 v[44:47], a[188:191], v[172:175], v[44:47]
    v_mfma_f32_16x16x32_bf16 v[48:51], a[188:191], v[176:179], v[48:51]
    s_waitcnt lgkmcnt(0)
    v_mfma_f32_16x16x32_bf16 v[4:7], a[192:195], v[148:151], v[4:7]
    buffer_load_dwordx4 a[156:159], v241, s[12:15], s20 offen offset:1024
    v_mfma_f32_16x16x32_bf16 v[8:11], a[192:195], v[152:155], v[8:11]
    ds_read_b128 v[164:167], v244 offset:4096
    v_mfma_f32_16x16x32_bf16 v[12:15], a[192:195], v[156:159], v[12:15]
    ds_read_b128 v[168:171], v244 offset:5120
    v_mfma_f32_16x16x32_bf16 v[16:19], a[192:195], v[160:163], v[16:19]
    ds_read_b128 v[172:175], v244 offset:6144
    v_mfma_f32_16x16x32_bf16 v[20:23], a[196:199], v[148:151], v[20:23]
    v_mfma_f32_16x16x32_bf16 v[24:27], a[196:199], v[152:155], v[24:27]
    ds_read_b128 v[176:179], v244 offset:7168
    v_mfma_f32_16x16x32_bf16 v[28:31], a[196:199], v[156:159], v[28:31]
    v_mfma_f32_16x16x32_bf16 v[32:35], a[196:199], v[160:163], v[32:35]
    v_mfma_f32_16x16x32_bf16 v[36:39], a[200:203], v[148:151], v[36:39]
    buffer_load_dwordx4 a[160:163], v241, s[12:15], s20 offen offset:2048
    v_mfma_f32_16x16x32_bf16 v[40:43], a[200:203], v[152:155], v[40:43]
    v_mfma_f32_16x16x32_bf16 v[44:47], a[200:203], v[156:159], v[44:47]
    v_mfma_f32_16x16x32_bf16 v[48:51], a[200:203], v[160:163], v[48:51]
    s_waitcnt lgkmcnt(0)
    v_mfma_f32_16x16x32_bf16 v[4:7], a[204:207], v[164:167], v[4:7]
    buffer_load_dwordx4 a[164:167], v241, s[12:15], s20 offen offset:3072
    v_mfma_f32_16x16x32_bf16 v[8:11], a[204:207], v[168:171], v[8:11]
    ds_read_b128 v[148:151], v241 offset:0
    v_mfma_f32_16x16x32_bf16 v[12:15], a[204:207], v[172:175], v[12:15]
    ds_read_b128 v[152:155], v241 offset:1024
    v_mfma_f32_16x16x32_bf16 v[16:19], a[204:207], v[176:179], v[16:19]
    ds_read_b128 v[156:159], v241 offset:2048
    v_mfma_f32_16x16x32_bf16 v[20:23], a[208:211], v[164:167], v[20:23]
    s_add_u32 s20, s20, 4096
    buffer_load_dwordx4 a[168:171], v241, s[12:15], s20 offen offset:0
    v_mfma_f32_16x16x32_bf16 v[24:27], a[208:211], v[168:171], v[24:27]
    ds_read_b128 v[160:163], v241 offset:3072
    v_mfma_f32_16x16x32_bf16 v[28:31], a[208:211], v[172:175], v[28:31]
    v_mfma_f32_16x16x32_bf16 v[32:35], a[208:211], v[176:179], v[32:35]
    v_mfma_f32_16x16x32_bf16 v[36:39], a[212:215], v[164:167], v[36:39]
    buffer_load_dwordx4 a[172:175], v241, s[12:15], s20 offen offset:1024
    v_mfma_f32_16x16x32_bf16 v[40:43], a[212:215], v[168:171], v[40:43]
    v_mfma_f32_16x16x32_bf16 v[44:47], a[212:215], v[172:175], v[44:47]
    v_mfma_f32_16x16x32_bf16 v[48:51], a[212:215], v[176:179], v[48:51]
    s_waitcnt lgkmcnt(0)
    v_mfma_f32_16x16x32_bf16 v[52:55], a[0:3], v[148:151], v[188:191]
    v_mfma_f32_16x16x32_bf16 v[56:59], a[0:3], v[152:155], v[188:191]
    ds_read_b128 v[164:167], v241 offset:4096
    v_mfma_f32_16x16x32_bf16 v[60:63], a[0:3], v[156:159], v[188:191]
    ds_read_b128 v[168:171], v241 offset:5120
    v_mfma_f32_16x16x32_bf16 v[64:67], a[0:3], v[160:163], v[188:191]
    ds_read_b128 v[172:175], v241 offset:6144
    v_mfma_f32_16x16x32_bf16 v[68:71], a[4:7], v[148:151], v[192:195]
    buffer_load_dwordx4 a[176:179], v241, s[12:15], s20 offen offset:2048
    v_fma_f32 v200, v4, v4, v240
    v_mfma_f32_16x16x32_bf16 v[72:75], a[4:7], v[152:155], v[192:195]
    ds_read_b128 v[176:179], v241 offset:7168
    v_fma_f32 v201, v5, v5, v240
    v_fma_f32 v202, v6, v6, v240
    v_mfma_f32_16x16x32_bf16 v[76:79], a[4:7], v[156:159], v[192:195]
    v_fma_f32 v203, v7, v7, v240
    v_mul_f32 v200, v200, v4
    v_mfma_f32_16x16x32_bf16 v[80:83], a[4:7], v[160:163], v[192:195]
    v_mul_f32 v201, v201, v5
    v_mul_f32 v202, v202, v6
    v_mfma_f32_16x16x32_bf16 v[84:87], a[8:11], v[148:151], v[196:199]
    buffer_load_dwordx4 a[180:183], v241, s[12:15], s20 offen offset:3072
    v_mul_f32 v203, v203, v7
    v_exp_f32 v200, -v200
    v_mfma_f32_16x16x32_bf16 v[88:91], a[8:11], v[152:155], v[196:199]
    v_mfma_f32_16x16x32_bf16 v[92:95], a[8:11], v[156:159], v[196:199]
    v_exp_f32 v201, -v201
    v_mfma_f32_16x16x32_bf16 v[96:99], a[8:11], v[160:163], v[196:199]
    s_waitcnt lgkmcnt(0)
    v_exp_f32 v202, -v202
    v_mfma_f32_16x16x32_bf16 v[52:55], a[12:15], v[164:167], v[52:55]
    s_add_u32 s20, s20, 4096
    buffer_load_dwordx4 a[184:187], v241, s[12:15], s20 offen offset:0
    v_exp_f32 v203, -v203
    v_mfma_f32_16x16x32_bf16 v[56:59], a[12:15], v[168:171], v[56:59]
    ds_read_b128 v[148:151], v241 offset:8192
    v_add_f32 v200, 1.0, v200
    v_add_f32 v201, 1.0, v201
    v_mfma_f32_16x16x32_bf16 v[60:63], a[12:15], v[172:175], v[60:63]
    ds_read_b128 v[152:155], v241 offset:9216
    v_add_f32 v202, 1.0, v202
    v_mfma_f32_16x16x32_bf16 v[64:67], a[12:15], v[176:179], v[64:67]
    ds_read_b128 v[156:159], v241 offset:10240
    v_add_f32 v203, 1.0, v203
    v_rcp_f32 v200, v200
    v_mfma_f32_16x16x32_bf16 v[68:71], a[16:19], v[164:167], v[68:71]
    buffer_load_dwordx4 a[188:191], v241, s[12:15], s20 offen offset:1024
    v_rcp_f32 v201, v201
    v_mfma_f32_16x16x32_bf16 v[72:75], a[16:19], v[168:171], v[72:75]
    ds_read_b128 v[160:163], v241 offset:11264
    v_rcp_f32 v202, v202
    v_mfma_f32_16x16x32_bf16 v[76:79], a[16:19], v[172:175], v[76:79]
    buffer_load_dwordx2 v[180:181], v253, s[4:7], s25 offen offset:768
    v_rcp_f32 v203, v203
    v_mfma_f32_16x16x32_bf16 v[80:83], a[16:19], v[176:179], v[80:83]
    v_mul_f32 v200, v200, v4
    v_mfma_f32_16x16x32_bf16 v[84:87], a[20:23], v[164:167], v[84:87]
    buffer_load_dwordx4 a[192:195], v241, s[12:15], s20 offen offset:2048
    v_mul_f32 v201, v201, v5
    v_mfma_f32_16x16x32_bf16 v[88:91], a[20:23], v[168:171], v[88:91]
    v_mul_f32 v202, v202, v6
    v_mul_f32 v203, v203, v7
    v_mfma_f32_16x16x32_bf16 v[92:95], a[20:23], v[172:175], v[92:95]
    v_cvt_pk_bf16_f32 v216, v200, v201
    v_cvt_pk_bf16_f32 v217, v202, v203
    v_mfma_f32_16x16x32_bf16 v[96:99], a[20:23], v[176:179], v[96:99]
    s_waitcnt lgkmcnt(0)
    v_fma_f32 v204, v20, v20, v240
    v_fma_f32 v205, v21, v21, v240
    v_mfma_f32_16x16x32_bf16 v[52:55], a[24:27], v[148:151], v[52:55]
    buffer_load_dwordx4 a[196:199], v241, s[12:15], s20 offen offset:3072
    v_fma_f32 v206, v22, v22, v240
    v_fma_f32 v207, v23, v23, v240
    v_mfma_f32_16x16x32_bf16 v[56:59], a[24:27], v[152:155], v[56:59]
    ds_read_b128 v[164:167], v241 offset:12288
    v_mul_f32 v204, v204, v20
    v_mul_f32 v205, v205, v21
    v_mfma_f32_16x16x32_bf16 v[60:63], a[24:27], v[156:159], v[60:63]
    ds_read_b128 v[168:171], v241 offset:13312
    v_mul_f32 v206, v206, v22
    v_mfma_f32_16x16x32_bf16 v[64:67], a[24:27], v[160:163], v[64:67]
    ds_read_b128 v[172:175], v241 offset:14336
    v_mul_f32 v207, v207, v23
    v_exp_f32 v204, -v204
    v_mfma_f32_16x16x32_bf16 v[68:71], a[28:31], v[148:151], v[68:71]
    s_add_u32 s20, s20, 4096
    buffer_load_dwordx4 a[200:203], v241, s[12:15], s20 offen offset:0
    v_exp_f32 v205, -v205
    v_mfma_f32_16x16x32_bf16 v[72:75], a[28:31], v[152:155], v[72:75]
    ds_read_b128 v[176:179], v241 offset:15360
    v_exp_f32 v206, -v206
    v_mfma_f32_16x16x32_bf16 v[76:79], a[28:31], v[156:159], v[76:79]
    buffer_load_dwordx2 v[182:183], v253, s[4:7], s25 offen offset:800
    v_exp_f32 v207, -v207
    v_mfma_f32_16x16x32_bf16 v[80:83], a[28:31], v[160:163], v[80:83]
    v_mfma_f32_16x16x32_bf16 v[84:87], a[32:35], v[148:151], v[84:87]
    buffer_load_dwordx4 a[204:207], v241, s[12:15], s20 offen offset:1024
    v_add_f32 v204, 1.0, v204
    v_add_f32 v205, 1.0, v205
    v_mfma_f32_16x16x32_bf16 v[88:91], a[32:35], v[152:155], v[88:91]
    v_add_f32 v206, 1.0, v206
    v_add_f32 v207, 1.0, v207
    v_mfma_f32_16x16x32_bf16 v[92:95], a[32:35], v[156:159], v[92:95]
    v_rcp_f32 v204, v204
    v_mfma_f32_16x16x32_bf16 v[96:99], a[32:35], v[160:163], v[96:99]
    s_waitcnt vmcnt(47) lgkmcnt(0)
    v_rcp_f32 v205, v205
    v_mfma_f32_16x16x32_bf16 v[52:55], a[36:39], v[164:167], v[52:55]
    buffer_load_dwordx4 a[208:211], v241, s[12:15], s20 offen offset:2048
    v_rcp_f32 v206, v206
    v_mfma_f32_16x16x32_bf16 v[56:59], a[36:39], v[168:171], v[56:59]
    ds_read_b128 v[148:151], v241 offset:16384
    v_rcp_f32 v207, v207
    v_mfma_f32_16x16x32_bf16 v[60:63], a[36:39], v[172:175], v[60:63]
    ds_read_b128 v[152:155], v241 offset:17408
    v_mul_f32 v204, v204, v20
    v_mfma_f32_16x16x32_bf16 v[64:67], a[36:39], v[176:179], v[64:67]
    ds_read_b128 v[156:159], v241 offset:18432
    v_mul_f32 v205, v205, v21
    v_mul_f32 v206, v206, v22
    v_mfma_f32_16x16x32_bf16 v[68:71], a[40:43], v[164:167], v[68:71]
    buffer_load_dwordx4 a[212:215], v241, s[12:15], s20 offen offset:3072
    v_mul_f32 v207, v207, v23
    v_cvt_pk_bf16_f32 v218, v204, v205
    v_mfma_f32_16x16x32_bf16 v[72:75], a[40:43], v[168:171], v[72:75]
    ds_read_b128 v[160:163], v241 offset:19456
    v_cvt_pk_bf16_f32 v219, v206, v207
    v_mfma_f32_16x16x32_bf16 v[76:79], a[40:43], v[172:175], v[76:79]
    buffer_load_dwordx2 v[184:185], v253, s[4:7], s23 offen offset:1024
    v_mfma_f32_16x16x32_bf16 v[80:83], a[40:43], v[176:179], v[80:83]
    ds_write_b128 v246, v[216:219] offset:0
    v_fma_f32 v200, v36, v36, v240
    v_fma_f32 v201, v37, v37, v240
    v_fma_f32 v202, v38, v38, v240
    v_mfma_f32_16x16x32_bf16 v[84:87], a[44:47], v[164:167], v[84:87]
    s_add_u32 s20, s20, 4096
    buffer_load_dwordx4 a[0:3], v241, s[12:15], s20 offen offset:0
    v_fma_f32 v203, v39, v39, v240
    v_mul_f32 v200, v200, v36
    v_mfma_f32_16x16x32_bf16 v[88:91], a[44:47], v[168:171], v[88:91]
    v_mul_f32 v201, v201, v37
    v_mul_f32 v202, v202, v38
    v_mfma_f32_16x16x32_bf16 v[92:95], a[44:47], v[172:175], v[92:95]
    buffer_load_dwordx4 a[4:7], v241, s[12:15], s20 offen offset:1024
    v_mul_f32 v203, v203, v39
    v_exp_f32 v200, -v200
    v_mfma_f32_16x16x32_bf16 v[96:99], a[44:47], v[176:179], v[96:99]
    s_waitcnt vmcnt(48) lgkmcnt(1)
    v_exp_f32 v201, -v201
    v_mfma_f32_16x16x32_bf16 v[52:55], a[48:51], v[148:151], v[52:55]
    buffer_load_dwordx4 a[8:11], v241, s[12:15], s20 offen offset:2048
    v_mfma_f32_16x16x32_bf16 v[56:59], a[48:51], v[152:155], v[56:59]
    ds_read_b128 v[164:167], v241 offset:20480
    v_exp_f32 v202, -v202
    v_mfma_f32_16x16x32_bf16 v[60:63], a[48:51], v[156:159], v[60:63]
    ds_read_b128 v[168:171], v241 offset:21504
    v_exp_f32 v203, -v203
    v_mfma_f32_16x16x32_bf16 v[64:67], a[48:51], v[160:163], v[64:67]
    ds_read_b128 v[172:175], v241 offset:22528
    v_add_f32 v200, 1.0, v200
    v_add_f32 v201, 1.0, v201
    v_mfma_f32_16x16x32_bf16 v[68:71], a[52:55], v[148:151], v[68:71]
    buffer_load_dwordx4 a[12:15], v241, s[12:15], s20 offen offset:3072
    v_add_f32 v202, 1.0, v202
    v_add_f32 v203, 1.0, v203
    v_mfma_f32_16x16x32_bf16 v[72:75], a[52:55], v[152:155], v[72:75]
    ds_read_b128 v[176:179], v241 offset:23552
    v_rcp_f32 v200, v200
    v_mfma_f32_16x16x32_bf16 v[76:79], a[52:55], v[156:159], v[76:79]
    v_rcp_f32 v201, v201
    v_mfma_f32_16x16x32_bf16 v[80:83], a[52:55], v[160:163], v[80:83]
    v_rcp_f32 v202, v202
    v_mfma_f32_16x16x32_bf16 v[84:87], a[56:59], v[148:151], v[84:87]
    s_add_u32 s20, s20, 4096
    buffer_load_dwordx4 a[16:19], v241, s[12:15], s20 offen offset:0
    v_rcp_f32 v203, v203
    v_mfma_f32_16x16x32_bf16 v[88:91], a[56:59], v[152:155], v[88:91]
    v_mul_f32 v200, v200, v36
    v_mfma_f32_16x16x32_bf16 v[92:95], a[56:59], v[156:159], v[92:95]
    v_mul_f32 v201, v201, v37
    v_mul_f32 v202, v202, v38
    v_mfma_f32_16x16x32_bf16 v[96:99], a[56:59], v[160:163], v[96:99]
    s_waitcnt vmcnt(47) lgkmcnt(0)
    v_mul_f32 v203, v203, v39
    v_cvt_pk_bf16_f32 v220, v200, v201
    v_mfma_f32_16x16x32_bf16 v[52:55], a[60:63], v[164:167], v[52:55]
    buffer_load_dwordx4 a[20:23], v241, s[12:15], s20 offen offset:1024
    v_cvt_pk_bf16_f32 v221, v202, v203
    v_mfma_f32_16x16x32_bf16 v[56:59], a[60:63], v[168:171], v[56:59]
    ds_read_b128 v[148:151], v241 offset:24576
    v_mfma_f32_16x16x32_bf16 v[60:63], a[60:63], v[172:175], v[60:63]
    ds_read_b128 v[152:155], v241 offset:25600
    v_mfma_f32_16x16x32_bf16 v[64:67], a[60:63], v[176:179], v[64:67]
    ds_read_b128 v[156:159], v241 offset:26624
    v_mfma_f32_16x16x32_bf16 v[68:71], a[64:67], v[164:167], v[68:71]
    buffer_load_dwordx4 a[24:27], v241, s[12:15], s20 offen offset:2048
    v_mfma_f32_16x16x32_bf16 v[72:75], a[64:67], v[168:171], v[72:75]
    ds_read_b128 v[160:163], v241 offset:27648
    v_mfma_f32_16x16x32_bf16 v[76:79], a[64:67], v[172:175], v[76:79]
    ds_write_b64 v247, v[220:221] offset:0
    v_fma_f32 v204, v8, v8, v240
    v_fma_f32 v205, v9, v9, v240
    v_fma_f32 v206, v10, v10, v240
    v_fma_f32 v207, v11, v11, v240
    v_mul_f32 v204, v204, v8
    v_mul_f32 v205, v205, v9
    v_mul_f32 v206, v206, v10
    v_mul_f32 v207, v207, v11
    v_exp_f32 v204, -v204
    v_mfma_f32_16x16x32_bf16 v[80:83], a[64:67], v[176:179], v[80:83]
    v_exp_f32 v205, -v205
    v_mfma_f32_16x16x32_bf16 v[84:87], a[68:71], v[164:167], v[84:87]
    buffer_load_dwordx4 a[28:31], v241, s[12:15], s20 offen offset:3072
    v_exp_f32 v206, -v206
    v_mfma_f32_16x16x32_bf16 v[88:91], a[68:71], v[168:171], v[88:91]
    v_exp_f32 v207, -v207
    v_mfma_f32_16x16x32_bf16 v[92:95], a[68:71], v[172:175], v[92:95]
    v_add_f32 v204, 1.0, v204
    v_add_f32 v205, 1.0, v205
    v_mfma_f32_16x16x32_bf16 v[96:99], a[68:71], v[176:179], v[96:99]
    s_waitcnt vmcnt(46) lgkmcnt(1)
    v_add_f32 v206, 1.0, v206
    v_mfma_f32_16x16x32_bf16 v[52:55], a[72:75], v[148:151], v[52:55]
    s_add_u32 s20, s20, 4096
    buffer_load_dwordx4 a[32:35], v241, s[12:15], s20 offen offset:0
    v_add_f32 v207, 1.0, v207
    v_rcp_f32 v204, v204
    v_mfma_f32_16x16x32_bf16 v[56:59], a[72:75], v[152:155], v[56:59]
    ds_read_b128 v[164:167], v241 offset:28672
    v_rcp_f32 v205, v205
    v_mfma_f32_16x16x32_bf16 v[60:63], a[72:75], v[156:159], v[60:63]
    ds_read_b128 v[168:171], v241 offset:29696
    v_rcp_f32 v206, v206
    v_mfma_f32_16x16x32_bf16 v[64:67], a[72:75], v[160:163], v[64:67]
    ds_read_b128 v[172:175], v241 offset:30720
    v_rcp_f32 v207, v207
    v_mfma_f32_16x16x32_bf16 v[68:71], a[76:79], v[148:151], v[68:71]
    buffer_load_dwordx4 a[36:39], v241, s[12:15], s20 offen offset:1024
    v_mul_f32 v204, v204, v8
    v_mfma_f32_16x16x32_bf16 v[72:75], a[76:79], v[152:155], v[72:75]
    ds_read_b128 v[176:179], v241 offset:31744
    v_mul_f32 v205, v205, v9
    v_mfma_f32_16x16x32_bf16 v[76:79], a[76:79], v[156:159], v[76:79]
    v_mul_f32 v206, v206, v10
    v_mul_f32 v207, v207, v11
    v_mfma_f32_16x16x32_bf16 v[80:83], a[76:79], v[160:163], v[80:83]
    v_cvt_pk_bf16_f32 v224, v204, v205
    v_cvt_pk_bf16_f32 v225, v206, v207
    v_mfma_f32_16x16x32_bf16 v[84:87], a[80:83], v[148:151], v[84:87]
    buffer_load_dwordx4 a[40:43], v241, s[12:15], s20 offen offset:2048
    v_fma_f32 v200, v24, v24, v240
    v_fma_f32 v201, v25, v25, v240
    v_mfma_f32_16x16x32_bf16 v[88:91], a[80:83], v[152:155], v[88:91]
    v_fma_f32 v202, v26, v26, v240
    v_fma_f32 v203, v27, v27, v240
    v_mfma_f32_16x16x32_bf16 v[92:95], a[80:83], v[156:159], v[92:95]
    v_mul_f32 v200, v200, v24
    v_mul_f32 v201, v201, v25
    v_mfma_f32_16x16x32_bf16 v[96:99], a[80:83], v[160:163], v[96:99]
    s_waitcnt vmcnt(44) lgkmcnt(0)
    v_mul_f32 v202, v202, v26
    v_mfma_f32_16x16x32_bf16 v[52:55], a[84:87], v[164:167], v[52:55]
    buffer_load_dwordx4 a[44:47], v241, s[12:15], s20 offen offset:3072
    v_mul_f32 v203, v203, v27
    v_exp_f32 v200, -v200
    v_mfma_f32_16x16x32_bf16 v[56:59], a[84:87], v[168:171], v[56:59]
    ds_read_b128 v[148:151], v241 offset:32768
    v_exp_f32 v201, -v201
    v_mfma_f32_16x16x32_bf16 v[60:63], a[84:87], v[172:175], v[60:63]
    ds_read_b128 v[152:155], v241 offset:33792
    v_exp_f32 v202, -v202
    v_mfma_f32_16x16x32_bf16 v[64:67], a[84:87], v[176:179], v[64:67]
    ds_read_b128 v[156:159], v241 offset:34816
    v_exp_f32 v203, -v203
    v_mfma_f32_16x16x32_bf16 v[68:71], a[88:91], v[164:167], v[68:71]
    s_add_u32 s20, s20, 4096
    buffer_load_dwordx4 a[48:51], v241, s[12:15], s20 offen offset:0
    v_mfma_f32_16x16x32_bf16 v[72:75], a[88:91], v[168:171], v[72:75]
    ds_read_b128 v[160:163], v241 offset:35840
    v_add_f32 v200, 1.0, v200
    v_add_f32 v201, 1.0, v201
    v_mfma_f32_16x16x32_bf16 v[76:79], a[88:91], v[172:175], v[76:79]
    v_add_f32 v202, 1.0, v202
    v_add_f32 v203, 1.0, v203
    v_mfma_f32_16x16x32_bf16 v[80:83], a[88:91], v[176:179], v[80:83]
    v_rcp_f32 v200, v200
    v_mfma_f32_16x16x32_bf16 v[84:87], a[92:95], v[164:167], v[84:87]
    buffer_load_dwordx4 a[52:55], v241, s[12:15], s20 offen offset:1024
    v_rcp_f32 v201, v201
    v_mfma_f32_16x16x32_bf16 v[88:91], a[92:95], v[168:171], v[88:91]
    v_rcp_f32 v202, v202
    v_mfma_f32_16x16x32_bf16 v[92:95], a[92:95], v[172:175], v[92:95]
    v_rcp_f32 v203, v203
    v_mfma_f32_16x16x32_bf16 v[96:99], a[92:95], v[176:179], v[96:99]
    s_waitcnt vmcnt(44) lgkmcnt(0)
    v_mul_f32 v200, v200, v24
    v_mfma_f32_16x16x32_bf16 v[52:55], a[96:99], v[148:151], v[52:55]
    buffer_load_dwordx4 a[56:59], v241, s[12:15], s20 offen offset:2048
    v_mul_f32 v201, v201, v25
    v_mul_f32 v202, v202, v26
    v_mfma_f32_16x16x32_bf16 v[56:59], a[96:99], v[152:155], v[56:59]
    ds_read_b128 v[164:167], v241 offset:36864
    v_mul_f32 v203, v203, v27
    v_cvt_pk_bf16_f32 v226, v200, v201
    v_mfma_f32_16x16x32_bf16 v[60:63], a[96:99], v[156:159], v[60:63]
    ds_read_b128 v[168:171], v241 offset:37888
    v_cvt_pk_bf16_f32 v227, v202, v203
    v_mfma_f32_16x16x32_bf16 v[64:67], a[96:99], v[160:163], v[64:67]
    ds_read_b128 v[172:175], v241 offset:38912
    v_mfma_f32_16x16x32_bf16 v[68:71], a[100:103], v[148:151], v[68:71]
    buffer_load_dwordx4 a[60:63], v241, s[12:15], s20 offen offset:3072
    v_mfma_f32_16x16x32_bf16 v[72:75], a[100:103], v[152:155], v[72:75]
    ds_read_b128 v[176:179], v241 offset:39936
    v_mfma_f32_16x16x32_bf16 v[76:79], a[100:103], v[156:159], v[76:79]
    ds_write_b128 v246, v[224:227] offset:1024
    v_fma_f32 v204, v40, v40, v240
    v_fma_f32 v205, v41, v41, v240
    v_fma_f32 v206, v42, v42, v240
    v_fma_f32 v207, v43, v43, v240
    v_mul_f32 v204, v204, v40
    v_mul_f32 v205, v205, v41
    v_mul_f32 v206, v206, v42
    v_mfma_f32_16x16x32_bf16 v[80:83], a[100:103], v[160:163], v[80:83]
    v_mul_f32 v207, v207, v43
    v_exp_f32 v204, -v204
    v_mfma_f32_16x16x32_bf16 v[84:87], a[104:107], v[148:151], v[84:87]
    s_add_u32 s20, s20, 4096
    buffer_load_dwordx4 a[64:67], v241, s[12:15], s20 offen offset:0
    v_exp_f32 v205, -v205
    v_mfma_f32_16x16x32_bf16 v[88:91], a[104:107], v[152:155], v[88:91]
    v_mfma_f32_16x16x32_bf16 v[92:95], a[104:107], v[156:159], v[92:95]
    v_exp_f32 v206, -v206
    v_mfma_f32_16x16x32_bf16 v[96:99], a[104:107], v[160:163], v[96:99]
    s_waitcnt vmcnt(44) lgkmcnt(1)
    v_exp_f32 v207, -v207
    v_mfma_f32_16x16x32_bf16 v[52:55], a[108:111], v[164:167], v[52:55]
    buffer_load_dwordx4 a[68:71], v241, s[12:15], s20 offen offset:1024
    v_add_f32 v204, 1.0, v204
    v_add_f32 v205, 1.0, v205
    v_mfma_f32_16x16x32_bf16 v[56:59], a[108:111], v[168:171], v[56:59]
    ds_read_b128 v[148:151], v241 offset:40960
    v_add_f32 v206, 1.0, v206
    v_add_f32 v207, 1.0, v207
    v_mfma_f32_16x16x32_bf16 v[60:63], a[108:111], v[172:175], v[60:63]
    ds_read_b128 v[152:155], v241 offset:41984
    v_rcp_f32 v204, v204
    v_mfma_f32_16x16x32_bf16 v[64:67], a[108:111], v[176:179], v[64:67]
    ds_read_b128 v[156:159], v241 offset:43008
    v_rcp_f32 v205, v205
    v_mfma_f32_16x16x32_bf16 v[68:71], a[112:115], v[164:167], v[68:71]
    buffer_load_dwordx4 a[72:75], v241, s[12:15], s20 offen offset:2048
    v_rcp_f32 v206, v206
    v_mfma_f32_16x16x32_bf16 v[72:75], a[112:115], v[168:171], v[72:75]
    ds_read_b128 v[160:163], v241 offset:44032
    v_rcp_f32 v207, v207
    v_mfma_f32_16x16x32_bf16 v[76:79], a[112:115], v[172:175], v[76:79]
    v_mul_f32 v204, v204, v40
    v_mfma_f32_16x16x32_bf16 v[80:83], a[112:115], v[176:179], v[80:83]
    v_mul_f32 v205, v205, v41
    v_mul_f32 v206, v206, v42
    v_mfma_f32_16x16x32_bf16 v[84:87], a[116:119], v[164:167], v[84:87]
    buffer_load_dwordx4 a[76:79], v241, s[12:15], s20 offen offset:3072
    v_mul_f32 v207, v207, v43
    v_cvt_pk_bf16_f32 v228, v204, v205
    v_mfma_f32_16x16x32_bf16 v[88:91], a[116:119], v[168:171], v[88:91]
    v_cvt_pk_bf16_f32 v229, v206, v207
    v_mfma_f32_16x16x32_bf16 v[92:95], a[116:119], v[172:175], v[92:95]
    s_add_u32 s20, s20, 4096
    buffer_load_dwordx4 a[80:83], v241, s[12:15], s20 offen offset:0
    v_mfma_f32_16x16x32_bf16 v[96:99], a[116:119], v[176:179], v[96:99]
    s_waitcnt vmcnt(45) lgkmcnt(0)
    ds_write_b64 v247, v[228:229] offset:1024
    s_waitcnt vmcnt(29)
    v_lshlrev_b32 v188, 16, v180
    v_and_b32 v189, 0xffff0000, v180
    v_lshlrev_b32 v190, 16, v181
    v_mfma_f32_16x16x32_bf16 v[52:55], a[120:123], v[148:151], v[52:55]
    buffer_load_dwordx4 a[84:87], v241, s[12:15], s20 offen offset:1024
    v_and_b32 v191, 0xffff0000, v181
    v_mul_f32 v188, 0x3eeff558, v188
    v_mfma_f32_16x16x32_bf16 v[56:59], a[120:123], v[152:155], v[56:59]
    ds_read_b128 v[164:167], v241 offset:45056
    v_mul_f32 v189, 0x3eeff558, v189
    v_mul_f32 v190, 0x3eeff558, v190
    v_mfma_f32_16x16x32_bf16 v[60:63], a[120:123], v[156:159], v[60:63]
    ds_read_b128 v[168:171], v241 offset:46080
    v_mul_f32 v191, 0x3eeff558, v191
    v_mfma_f32_16x16x32_bf16 v[64:67], a[120:123], v[160:163], v[64:67]
    ds_read_b128 v[172:175], v241 offset:47104
    s_waitcnt vmcnt(26)
    v_lshlrev_b32 v192, 16, v182
    v_and_b32 v193, 0xffff0000, v182
    v_mfma_f32_16x16x32_bf16 v[68:71], a[124:127], v[148:151], v[68:71]
    buffer_load_dwordx4 a[88:91], v241, s[12:15], s20 offen offset:2048
    v_lshlrev_b32 v194, 16, v183
    v_and_b32 v195, 0xffff0000, v183
    v_mfma_f32_16x16x32_bf16 v[72:75], a[124:127], v[152:155], v[72:75]
    ds_read_b128 v[176:179], v241 offset:48128
    v_mul_f32 v192, 0x3eeff558, v192
    v_mul_f32 v193, 0x3eeff558, v193
    v_mfma_f32_16x16x32_bf16 v[76:79], a[124:127], v[156:159], v[76:79]
    v_mul_f32 v194, 0x3eeff558, v194
    v_mul_f32 v195, 0x3eeff558, v195
    v_mfma_f32_16x16x32_bf16 v[80:83], a[124:127], v[160:163], v[80:83]
    s_waitcnt vmcnt(23)
    v_lshlrev_b32 v196, 16, v184
    v_and_b32 v197, 0xffff0000, v184
    v_mfma_f32_16x16x32_bf16 v[84:87], a[128:131], v[148:151], v[84:87]
    buffer_load_dwordx4 a[92:95], v241, s[12:15], s20 offen offset:3072
    v_lshlrev_b32 v198, 16, v185
    v_mfma_f32_16x16x32_bf16 v[88:91], a[128:131], v[152:155], v[88:91]
    v_and_b32 v199, 0xffff0000, v185
    v_mul_f32 v196, 0x3eeff558, v196
    v_mfma_f32_16x16x32_bf16 v[92:95], a[128:131], v[156:159], v[92:95]
    v_mul_f32 v197, 0x3eeff558, v197
    v_mul_f32 v198, 0x3eeff558, v198
    v_mfma_f32_16x16x32_bf16 v[96:99], a[128:131], v[160:163], v[96:99]
    s_waitcnt lgkmcnt(0)
    v_mul_f32 v199, 0x3eeff558, v199
    v_fma_f32 v200, v12, v12, v240
    v_mfma_f32_16x16x32_bf16 v[52:55], a[132:135], v[164:167], v[52:55]
    s_add_u32 s20, s20, 4096
    buffer_load_dwordx4 a[96:99], v241, s[12:15], s20 offen offset:0
    v_fma_f32 v201, v13, v13, v240
    v_fma_f32 v202, v14, v14, v240
    v_mfma_f32_16x16x32_bf16 v[56:59], a[132:135], v[168:171], v[56:59]
    ds_read_b128 v[148:151], v241 offset:49152
    v_fma_f32 v203, v15, v15, v240
    v_mul_f32 v200, v200, v12
    v_mfma_f32_16x16x32_bf16 v[60:63], a[132:135], v[172:175], v[60:63]
    ds_read_b128 v[152:155], v241 offset:50176
    v_mul_f32 v201, v201, v13
    v_mfma_f32_16x16x32_bf16 v[64:67], a[132:135], v[176:179], v[64:67]
    ds_read_b128 v[156:159], v241 offset:51200
    v_mul_f32 v202, v202, v14
    v_mul_f32 v203, v203, v15
    v_mfma_f32_16x16x32_bf16 v[68:71], a[136:139], v[164:167], v[68:71]
    buffer_load_dwordx4 a[100:103], v241, s[12:15], s20 offen offset:1024
    v_exp_f32 v200, -v200
    v_mfma_f32_16x16x32_bf16 v[72:75], a[136:139], v[168:171], v[72:75]
    ds_read_b128 v[160:163], v241 offset:52224
    v_exp_f32 v201, -v201
    v_mfma_f32_16x16x32_bf16 v[76:79], a[136:139], v[172:175], v[76:79]
    v_exp_f32 v202, -v202
    v_mfma_f32_16x16x32_bf16 v[80:83], a[136:139], v[176:179], v[80:83]
    v_exp_f32 v203, -v203
    v_mfma_f32_16x16x32_bf16 v[84:87], a[140:143], v[164:167], v[84:87]
    buffer_load_dwordx4 a[104:107], v241, s[12:15], s20 offen offset:2048
    v_add_f32 v200, 1.0, v200
    v_mfma_f32_16x16x32_bf16 v[88:91], a[140:143], v[168:171], v[88:91]
    v_add_f32 v201, 1.0, v201
    v_add_f32 v202, 1.0, v202
    v_mfma_f32_16x16x32_bf16 v[92:95], a[140:143], v[172:175], v[92:95]
    v_add_f32 v203, 1.0, v203
    v_rcp_f32 v200, v200
    v_mfma_f32_16x16x32_bf16 v[96:99], a[140:143], v[176:179], v[96:99]
    s_waitcnt lgkmcnt(0)
    v_rcp_f32 v201, v201
    v_mfma_f32_16x16x32_bf16 v[52:55], a[144:147], v[148:151], v[52:55]
    buffer_load_dwordx4 a[108:111], v241, s[12:15], s20 offen offset:3072
    v_rcp_f32 v202, v202
    v_mfma_f32_16x16x32_bf16 v[56:59], a[144:147], v[152:155], v[56:59]
    ds_read_b128 v[164:167], v241 offset:53248
    v_mfma_f32_16x16x32_bf16 v[60:63], a[144:147], v[156:159], v[60:63]
    ds_read_b128 v[168:171], v241 offset:54272
    v_rcp_f32 v203, v203
    v_mfma_f32_16x16x32_bf16 v[64:67], a[144:147], v[160:163], v[64:67]
    ds_read_b128 v[172:175], v241 offset:55296
    v_mul_f32 v200, v200, v12
    v_mul_f32 v201, v201, v13
    v_mfma_f32_16x16x32_bf16 v[68:71], a[148:151], v[148:151], v[68:71]
    s_add_u32 s20, s20, 4096
    buffer_load_dwordx4 a[112:115], v241, s[12:15], s20 offen offset:0
    v_mul_f32 v202, v202, v14
    v_mul_f32 v203, v203, v15
    v_mfma_f32_16x16x32_bf16 v[72:75], a[148:151], v[152:155], v[72:75]
    ds_read_b128 v[176:179], v241 offset:56320
    v_cvt_pk_bf16_f32 v216, v200, v201
    v_cvt_pk_bf16_f32 v217, v202, v203
    v_mfma_f32_16x16x32_bf16 v[76:79], a[148:151], v[156:159], v[76:79]
    v_fma_f32 v204, v28, v28, v240
    v_fma_f32 v205, v29, v29, v240
    v_mfma_f32_16x16x32_bf16 v[80:83], a[148:151], v[160:163], v[80:83]
    v_fma_f32 v206, v30, v30, v240
    v_mfma_f32_16x16x32_bf16 v[84:87], a[152:155], v[148:151], v[84:87]
    buffer_load_dwordx4 a[116:119], v241, s[12:15], s20 offen offset:1024
    v_fma_f32 v207, v31, v31, v240
    v_mul_f32 v204, v204, v28
    v_mfma_f32_16x16x32_bf16 v[88:91], a[152:155], v[152:155], v[88:91]
    v_mul_f32 v205, v205, v29
    v_mul_f32 v206, v206, v30
    v_mfma_f32_16x16x32_bf16 v[92:95], a[152:155], v[156:159], v[92:95]
    v_mul_f32 v207, v207, v31
    v_exp_f32 v204, -v204
    v_mfma_f32_16x16x32_bf16 v[96:99], a[152:155], v[160:163], v[96:99]
    s_waitcnt lgkmcnt(0)
    v_exp_f32 v205, -v205
    v_mfma_f32_16x16x32_bf16 v[52:55], a[156:159], v[164:167], v[52:55]
    buffer_load_dwordx4 a[120:123], v241, s[12:15], s20 offen offset:2048
    v_exp_f32 v206, -v206
    v_mfma_f32_16x16x32_bf16 v[56:59], a[156:159], v[168:171], v[56:59]
    ds_read_b128 v[148:151], v241 offset:57344
    v_mfma_f32_16x16x32_bf16 v[60:63], a[156:159], v[172:175], v[60:63]
    ds_read_b128 v[152:155], v241 offset:58368
    v_exp_f32 v207, -v207
    v_mfma_f32_16x16x32_bf16 v[64:67], a[156:159], v[176:179], v[64:67]
    ds_read_b128 v[156:159], v241 offset:59392
    v_add_f32 v204, 1.0, v204
    v_add_f32 v205, 1.0, v205
    v_mfma_f32_16x16x32_bf16 v[68:71], a[160:163], v[164:167], v[68:71]
    buffer_load_dwordx4 a[124:127], v241, s[12:15], s20 offen offset:3072
    v_add_f32 v206, 1.0, v206
    v_add_f32 v207, 1.0, v207
    v_mfma_f32_16x16x32_bf16 v[72:75], a[160:163], v[168:171], v[72:75]
    ds_read_b128 v[160:163], v241 offset:60416
    v_rcp_f32 v204, v204
    v_mfma_f32_16x16x32_bf16 v[76:79], a[160:163], v[172:175], v[76:79]
    v_rcp_f32 v205, v205
    v_mfma_f32_16x16x32_bf16 v[80:83], a[160:163], v[176:179], v[80:83]
    v_rcp_f32 v206, v206
    v_mfma_f32_16x16x32_bf16 v[84:87], a[164:167], v[164:167], v[84:87]
    s_add_u32 s20, s20, 4096
    buffer_load_dwordx4 a[128:131], v241, s[12:15], s20 offen offset:0
    v_rcp_f32 v207, v207
    v_mfma_f32_16x16x32_bf16 v[88:91], a[164:167], v[168:171], v[88:91]
    v_mul_f32 v204, v204, v28
    v_mfma_f32_16x16x32_bf16 v[92:95], a[164:167], v[172:175], v[92:95]
    v_mul_f32 v205, v205, v29
    v_mul_f32 v206, v206, v30
    v_mfma_f32_16x16x32_bf16 v[96:99], a[164:167], v[176:179], v[96:99]
    s_waitcnt lgkmcnt(0)
    v_mul_f32 v207, v207, v31
    v_cvt_pk_bf16_f32 v218, v204, v205
    v_mfma_f32_16x16x32_bf16 v[52:55], a[168:171], v[148:151], v[52:55]
    buffer_load_dwordx4 a[132:135], v241, s[12:15], s20 offen offset:1024
    v_cvt_pk_bf16_f32 v219, v206, v207
    v_mfma_f32_16x16x32_bf16 v[56:59], a[168:171], v[152:155], v[56:59]
    ds_read_b128 v[164:167], v241 offset:61440
    v_mfma_f32_16x16x32_bf16 v[60:63], a[168:171], v[156:159], v[60:63]
    ds_read_b128 v[168:171], v241 offset:62464
    v_mfma_f32_16x16x32_bf16 v[64:67], a[168:171], v[160:163], v[64:67]
    ds_read_b128 v[172:175], v241 offset:63488
    v_mfma_f32_16x16x32_bf16 v[68:71], a[172:175], v[148:151], v[68:71]
    buffer_load_dwordx4 a[136:139], v241, s[12:15], s20 offen offset:2048
    v_mfma_f32_16x16x32_bf16 v[72:75], a[172:175], v[152:155], v[72:75]
    ds_read_b128 v[176:179], v241 offset:64512
    v_mfma_f32_16x16x32_bf16 v[76:79], a[172:175], v[156:159], v[76:79]
    ds_write_b128 v246, v[216:219] offset:2048
    v_fma_f32 v200, v44, v44, v240
    v_fma_f32 v201, v45, v45, v240
    v_fma_f32 v202, v46, v46, v240
    v_fma_f32 v203, v47, v47, v240
    v_mul_f32 v200, v200, v44
    v_mul_f32 v201, v201, v45
    v_mul_f32 v202, v202, v46
    v_mul_f32 v203, v203, v47
    v_exp_f32 v200, -v200
    v_mfma_f32_16x16x32_bf16 v[80:83], a[172:175], v[160:163], v[80:83]
    v_exp_f32 v201, -v201
    v_mfma_f32_16x16x32_bf16 v[84:87], a[176:179], v[148:151], v[84:87]
    buffer_load_dwordx4 a[140:143], v241, s[12:15], s20 offen offset:3072
    v_exp_f32 v202, -v202
    v_mfma_f32_16x16x32_bf16 v[88:91], a[176:179], v[152:155], v[88:91]
    v_exp_f32 v203, -v203
    v_mfma_f32_16x16x32_bf16 v[92:95], a[176:179], v[156:159], v[92:95]
    v_add_f32 v200, 1.0, v200
    v_add_f32 v201, 1.0, v201
    v_mfma_f32_16x16x32_bf16 v[96:99], a[176:179], v[160:163], v[96:99]
    s_waitcnt lgkmcnt(1)
    v_add_f32 v202, 1.0, v202
    v_mfma_f32_16x16x32_bf16 v[52:55], a[180:183], v[164:167], v[52:55]
    s_add_u32 s20, s20, 4096
    buffer_load_dwordx4 a[144:147], v241, s[12:15], s20 offen offset:0
    v_add_f32 v203, 1.0, v203
    v_rcp_f32 v200, v200
    v_mfma_f32_16x16x32_bf16 v[56:59], a[180:183], v[168:171], v[56:59]
    ds_read_b128 v[148:151], v244 offset:0
    v_rcp_f32 v201, v201
    v_mfma_f32_16x16x32_bf16 v[60:63], a[180:183], v[172:175], v[60:63]
    ds_read_b128 v[152:155], v244 offset:1024
    v_rcp_f32 v202, v202
    v_mfma_f32_16x16x32_bf16 v[64:67], a[180:183], v[176:179], v[64:67]
    ds_read_b128 v[156:159], v244 offset:2048
    v_rcp_f32 v203, v203
    v_mfma_f32_16x16x32_bf16 v[68:71], a[184:187], v[164:167], v[68:71]
    buffer_load_dwordx4 a[148:151], v241, s[12:15], s20 offen offset:1024
    v_mul_f32 v200, v200, v44
    v_mfma_f32_16x16x32_bf16 v[72:75], a[184:187], v[168:171], v[72:75]
    ds_read_b128 v[160:163], v244 offset:3072
    v_mul_f32 v201, v201, v45
    v_mfma_f32_16x16x32_bf16 v[76:79], a[184:187], v[172:175], v[76:79]
    v_mul_f32 v202, v202, v46
    v_mul_f32 v203, v203, v47
    v_mfma_f32_16x16x32_bf16 v[80:83], a[184:187], v[176:179], v[80:83]
    v_cvt_pk_bf16_f32 v220, v200, v201
    v_cvt_pk_bf16_f32 v221, v202, v203
    v_mfma_f32_16x16x32_bf16 v[84:87], a[188:191], v[164:167], v[84:87]
    buffer_load_dwordx4 a[152:155], v241, s[12:15], s20 offen offset:2048
    v_mfma_f32_16x16x32_bf16 v[88:91], a[188:191], v[168:171], v[88:91]
    ds_write_b64 v247, v[220:221] offset:2048
    v_fma_f32 v204, v16, v16, v240
    v_fma_f32 v205, v17, v17, v240
    v_fma_f32 v206, v18, v18, v240
    v_mfma_f32_16x16x32_bf16 v[92:95], a[188:191], v[172:175], v[92:95]
    buffer_load_dwordx4 a[156:159], v241, s[12:15], s20 offen offset:3072
    v_fma_f32 v207, v19, v19, v240
    v_mul_f32 v204, v204, v16
    v_mfma_f32_16x16x32_bf16 v[96:99], a[188:191], v[176:179], v[96:99]
    s_waitcnt lgkmcnt(1)
    v_mul_f32 v205, v205, v17
    v_mfma_f32_16x16x32_bf16 v[52:55], a[192:195], v[148:151], v[52:55]
    s_add_u32 s20, s20, 4096
    buffer_load_dwordx4 a[160:163], v241, s[12:15], s20 offen offset:0
    v_mul_f32 v206, v206, v18
    v_mul_f32 v207, v207, v19
    v_mfma_f32_16x16x32_bf16 v[56:59], a[192:195], v[152:155], v[56:59]
    ds_read_b128 v[164:167], v244 offset:4096
    v_exp_f32 v204, -v204
    v_mfma_f32_16x16x32_bf16 v[60:63], a[192:195], v[156:159], v[60:63]
    ds_read_b128 v[168:171], v244 offset:5120
    v_exp_f32 v205, -v205
    v_mfma_f32_16x16x32_bf16 v[64:67], a[192:195], v[160:163], v[64:67]
    ds_read_b128 v[172:175], v244 offset:6144
    v_exp_f32 v206, -v206
    v_mfma_f32_16x16x32_bf16 v[68:71], a[196:199], v[148:151], v[68:71]
    buffer_load_dwordx4 a[164:167], v241, s[12:15], s20 offen offset:1024
    v_exp_f32 v207, -v207
    v_mfma_f32_16x16x32_bf16 v[72:75], a[196:199], v[152:155], v[72:75]
    ds_read_b128 v[176:179], v244 offset:7168
    v_add_f32 v204, 1.0, v204
    v_mfma_f32_16x16x32_bf16 v[76:79], a[196:199], v[156:159], v[76:79]
    v_add_f32 v205, 1.0, v205
    v_add_f32 v206, 1.0, v206
    v_mfma_f32_16x16x32_bf16 v[80:83], a[196:199], v[160:163], v[80:83]
    v_add_f32 v207, 1.0, v207
    v_rcp_f32 v204, v204
    v_mfma_f32_16x16x32_bf16 v[84:87], a[200:203], v[148:151], v[84:87]
    buffer_load_dwordx4 a[168:171], v241, s[12:15], s20 offen offset:2048
    v_rcp_f32 v205, v205
    v_mfma_f32_16x16x32_bf16 v[88:91], a[200:203], v[152:155], v[88:91]
    v_rcp_f32 v206, v206
    v_mfma_f32_16x16x32_bf16 v[92:95], a[200:203], v[156:159], v[92:95]
    v_mfma_f32_16x16x32_bf16 v[96:99], a[200:203], v[160:163], v[96:99]
    s_waitcnt lgkmcnt(0)
    v_rcp_f32 v207, v207
    v_mfma_f32_16x16x32_bf16 v[52:55], a[204:207], v[164:167], v[52:55]
    buffer_load_dwordx4 a[172:175], v241, s[12:15], s20 offen offset:3072
    v_mul_f32 v204, v204, v16
    v_mul_f32 v205, v205, v17
    v_mfma_f32_16x16x32_bf16 v[56:59], a[204:207], v[168:171], v[56:59]
    ds_read_b128 v[148:151], v241 offset:0
    v_mul_f32 v206, v206, v18
    v_mul_f32 v207, v207, v19
    v_mfma_f32_16x16x32_bf16 v[60:63], a[204:207], v[172:175], v[60:63]
    ds_read_b128 v[152:155], v241 offset:1024
    v_cvt_pk_bf16_f32 v224, v204, v205
    v_cvt_pk_bf16_f32 v225, v206, v207
    v_mfma_f32_16x16x32_bf16 v[64:67], a[204:207], v[176:179], v[64:67]
    ds_read_b128 v[156:159], v241 offset:2048
    v_fma_f32 v200, v32, v32, v240
    v_fma_f32 v201, v33, v33, v240
    v_mfma_f32_16x16x32_bf16 v[68:71], a[208:211], v[164:167], v[68:71]
    s_add_u32 s20, s20, 4096
    buffer_load_dwordx4 a[176:179], v241, s[12:15], s20 offen offset:0
    v_fma_f32 v202, v34, v34, v240
    v_mfma_f32_16x16x32_bf16 v[72:75], a[208:211], v[168:171], v[72:75]
    ds_read_b128 v[160:163], v241 offset:3072
    v_fma_f32 v203, v35, v35, v240
    v_mul_f32 v200, v200, v32
    v_mfma_f32_16x16x32_bf16 v[76:79], a[208:211], v[172:175], v[76:79]
    v_mul_f32 v201, v201, v33
    v_mul_f32 v202, v202, v34
    v_mfma_f32_16x16x32_bf16 v[80:83], a[208:211], v[176:179], v[80:83]
    v_mul_f32 v203, v203, v35
    v_exp_f32 v200, -v200
    v_mfma_f32_16x16x32_bf16 v[84:87], a[212:215], v[164:167], v[84:87]
    buffer_load_dwordx4 a[180:183], v241, s[12:15], s20 offen offset:1024
    v_exp_f32 v201, -v201
    v_mfma_f32_16x16x32_bf16 v[88:91], a[212:215], v[168:171], v[88:91]
    v_mfma_f32_16x16x32_bf16 v[92:95], a[212:215], v[172:175], v[92:95]
    v_exp_f32 v202, -v202
    v_mfma_f32_16x16x32_bf16 v[96:99], a[212:215], v[176:179], v[96:99]
    s_waitcnt vmcnt(43) lgkmcnt(0)
    v_exp_f32 v203, -v203
    v_mfma_f32_16x16x32_bf16 v[100:103], a[0:3], v[148:151], v[188:191]
    buffer_load_dwordx4 a[184:187], v241, s[12:15], s20 offen offset:2048
    v_add_f32 v200, 1.0, v200
    v_add_f32 v201, 1.0, v201
    v_mfma_f32_16x16x32_bf16 v[104:107], a[0:3], v[152:155], v[188:191]
    ds_read_b128 v[164:167], v241 offset:4096
    v_add_f32 v202, 1.0, v202
    v_add_f32 v203, 1.0, v203
    v_mfma_f32_16x16x32_bf16 v[108:111], a[0:3], v[156:159], v[188:191]
    ds_read_b128 v[168:171], v241 offset:5120
    v_rcp_f32 v200, v200
    v_mfma_f32_16x16x32_bf16 v[112:115], a[0:3], v[160:163], v[188:191]
    ds_read_b128 v[172:175], v241 offset:6144
    v_rcp_f32 v201, v201
    v_mfma_f32_16x16x32_bf16 v[116:119], a[4:7], v[148:151], v[192:195]
    buffer_load_dwordx4 a[188:191], v241, s[12:15], s20 offen offset:3072
    v_rcp_f32 v202, v202
    v_mfma_f32_16x16x32_bf16 v[120:123], a[4:7], v[152:155], v[192:195]
    ds_read_b128 v[176:179], v241 offset:7168
    v_rcp_f32 v203, v203
    v_mfma_f32_16x16x32_bf16 v[124:127], a[4:7], v[156:159], v[192:195]
    v_mul_f32 v200, v200, v32
    v_mfma_f32_16x16x32_bf16 v[128:131], a[4:7], v[160:163], v[192:195]
    v_mul_f32 v201, v201, v33
    v_mul_f32 v202, v202, v34
    v_mfma_f32_16x16x32_bf16 v[132:135], a[8:11], v[148:151], v[196:199]
    s_add_u32 s20, s20, 4096
    buffer_load_dwordx4 a[192:195], v241, s[12:15], s20 offen offset:0
    v_mul_f32 v203, v203, v35
    v_cvt_pk_bf16_f32 v226, v200, v201
    v_mfma_f32_16x16x32_bf16 v[136:139], a[8:11], v[152:155], v[196:199]
    v_cvt_pk_bf16_f32 v227, v202, v203
    v_mfma_f32_16x16x32_bf16 v[140:143], a[8:11], v[156:159], v[196:199]
    ds_write_b128 v246, v[224:227] offset:3072
    v_fma_f32 v204, v48, v48, v240
    v_mfma_f32_16x16x32_bf16 v[144:147], a[8:11], v[160:163], v[196:199]
    s_waitcnt vmcnt(43) lgkmcnt(1)
    v_fma_f32 v205, v49, v49, v240
    v_fma_f32 v206, v50, v50, v240
    v_mfma_f32_16x16x32_bf16 v[100:103], a[12:15], v[164:167], v[100:103]
    buffer_load_dwordx4 a[196:199], v241, s[12:15], s20 offen offset:1024
    v_fma_f32 v207, v51, v51, v240
    v_mul_f32 v204, v204, v48
    v_mfma_f32_16x16x32_bf16 v[104:107], a[12:15], v[168:171], v[104:107]
    ds_read_b128 v[148:151], v241 offset:8192
    v_mul_f32 v205, v205, v49
    v_mul_f32 v206, v206, v50
    v_mfma_f32_16x16x32_bf16 v[108:111], a[12:15], v[172:175], v[108:111]
    ds_read_b128 v[152:155], v241 offset:9216
    v_mul_f32 v207, v207, v51
    v_mfma_f32_16x16x32_bf16 v[112:115], a[12:15], v[176:179], v[112:115]
    ds_read_b128 v[156:159], v241 offset:10240
    v_exp_f32 v204, -v204
    v_mfma_f32_16x16x32_bf16 v[116:119], a[16:19], v[164:167], v[116:119]
    buffer_load_dwordx4 a[200:203], v241, s[12:15], s20 offen offset:2048
    v_exp_f32 v205, -v205
    v_mfma_f32_16x16x32_bf16 v[120:123], a[16:19], v[168:171], v[120:123]
    ds_read_b128 v[160:163], v241 offset:11264
    v_exp_f32 v206, -v206
    v_mfma_f32_16x16x32_bf16 v[124:127], a[16:19], v[172:175], v[124:127]
    v_exp_f32 v207, -v207
    v_mfma_f32_16x16x32_bf16 v[128:131], a[16:19], v[176:179], v[128:131]
    v_add_f32 v204, 1.0, v204
    v_add_f32 v205, 1.0, v205
    v_mfma_f32_16x16x32_bf16 v[132:135], a[20:23], v[164:167], v[132:135]
    buffer_load_dwordx4 a[204:207], v241, s[12:15], s20 offen offset:3072
    v_add_f32 v206, 1.0, v206
    v_mfma_f32_16x16x32_bf16 v[136:139], a[20:23], v[168:171], v[136:139]
    v_add_f32 v207, 1.0, v207
    v_rcp_f32 v204, v204
    v_mfma_f32_16x16x32_bf16 v[140:143], a[20:23], v[172:175], v[140:143]
    v_rcp_f32 v205, v205
    v_mfma_f32_16x16x32_bf16 v[144:147], a[20:23], v[176:179], v[144:147]
    s_waitcnt vmcnt(43) lgkmcnt(0)
    v_rcp_f32 v206, v206
    v_mfma_f32_16x16x32_bf16 v[100:103], a[24:27], v[148:151], v[100:103]
    s_add_u32 s20, s20, 4096
    buffer_load_dwordx4 a[208:211], v241, s[12:15], s20 offen offset:0
    v_rcp_f32 v207, v207
    v_mfma_f32_16x16x32_bf16 v[104:107], a[24:27], v[152:155], v[104:107]
    ds_read_b128 v[164:167], v241 offset:12288
    v_mul_f32 v204, v204, v48
    v_mfma_f32_16x16x32_bf16 v[108:111], a[24:27], v[156:159], v[108:111]
    ds_read_b128 v[168:171], v241 offset:13312
    v_mul_f32 v205, v205, v49
    v_mfma_f32_16x16x32_bf16 v[112:115], a[24:27], v[160:163], v[112:115]
    ds_read_b128 v[172:175], v241 offset:14336
    v_mul_f32 v206, v206, v50
    v_mul_f32 v207, v207, v51
    v_mfma_f32_16x16x32_bf16 v[116:119], a[28:31], v[148:151], v[116:119]
    buffer_load_dwordx4 a[212:215], v241, s[12:15], s20 offen offset:1024
    v_cvt_pk_bf16_f32 v228, v204, v205
    v_cvt_pk_bf16_f32 v229, v206, v207
    v_mfma_f32_16x16x32_bf16 v[120:123], a[28:31], v[152:155], v[120:123]
    ds_read_b128 v[176:179], v241 offset:15360
    v_mfma_f32_16x16x32_bf16 v[124:127], a[28:31], v[156:159], v[124:127]
    ds_write_b64 v247, v[228:229] offset:3072
    v_fma_f32 v200, v52, v52, v240
    v_fma_f32 v201, v53, v53, v240
    v_fma_f32 v202, v54, v54, v240
    v_mfma_f32_16x16x32_bf16 v[128:131], a[28:31], v[160:163], v[128:131]
    v_fma_f32 v203, v55, v55, v240
    v_mul_f32 v200, v200, v52
    v_mfma_f32_16x16x32_bf16 v[132:135], a[32:35], v[148:151], v[132:135]
    buffer_load_dwordx4 a[0:3], v241, s[12:15], s20 offen offset:2048
    v_mul_f32 v201, v201, v53
    v_mfma_f32_16x16x32_bf16 v[136:139], a[32:35], v[152:155], v[136:139]
    v_mul_f32 v202, v202, v54
    v_mul_f32 v203, v203, v55
    v_mfma_f32_16x16x32_bf16 v[140:143], a[32:35], v[156:159], v[140:143]
    v_exp_f32 v200, -v200
    v_mfma_f32_16x16x32_bf16 v[144:147], a[32:35], v[160:163], v[144:147]
    s_waitcnt vmcnt(43) lgkmcnt(1)
    v_exp_f32 v201, -v201
    v_mfma_f32_16x16x32_bf16 v[100:103], a[36:39], v[164:167], v[100:103]
    buffer_load_dwordx4 a[4:7], v241, s[12:15], s20 offen offset:3072
    v_exp_f32 v202, -v202
    v_mfma_f32_16x16x32_bf16 v[104:107], a[36:39], v[168:171], v[104:107]
    ds_read_b128 v[148:151], v241 offset:16384
    v_exp_f32 v203, -v203
    v_mfma_f32_16x16x32_bf16 v[108:111], a[36:39], v[172:175], v[108:111]
    ds_read_b128 v[152:155], v241 offset:17408
    v_add_f32 v200, 1.0, v200
    v_mfma_f32_16x16x32_bf16 v[112:115], a[36:39], v[176:179], v[112:115]
    ds_read_b128 v[156:159], v241 offset:18432
    v_add_f32 v201, 1.0, v201
    v_add_f32 v202, 1.0, v202
    v_mfma_f32_16x16x32_bf16 v[116:119], a[40:43], v[164:167], v[116:119]
    s_add_u32 s20, s20, 4096
    buffer_load_dwordx4 a[8:11], v241, s[12:15], s20 offen offset:0
    v_add_f32 v203, 1.0, v203
    v_rcp_f32 v200, v200
    v_mfma_f32_16x16x32_bf16 v[120:123], a[40:43], v[168:171], v[120:123]
    ds_read_b128 v[160:163], v241 offset:19456
    v_rcp_f32 v201, v201
    v_mfma_f32_16x16x32_bf16 v[124:127], a[40:43], v[172:175], v[124:127]
    v_rcp_f32 v202, v202
    v_mfma_f32_16x16x32_bf16 v[128:131], a[40:43], v[176:179], v[128:131]
    v_mfma_f32_16x16x32_bf16 v[132:135], a[44:47], v[164:167], v[132:135]
    buffer_load_dwordx4 a[12:15], v241, s[12:15], s20 offen offset:1024
    v_rcp_f32 v203, v203
    v_mfma_f32_16x16x32_bf16 v[136:139], a[44:47], v[168:171], v[136:139]
    v_mul_f32 v200, v200, v52
    v_mul_f32 v201, v201, v53
    v_mfma_f32_16x16x32_bf16 v[140:143], a[44:47], v[172:175], v[140:143]
    buffer_load_dwordx4 a[16:19], v241, s[12:15], s20 offen offset:2048
    v_mul_f32 v202, v202, v54
    v_mul_f32 v203, v203, v55
    v_mfma_f32_16x16x32_bf16 v[144:147], a[44:47], v[176:179], v[144:147]
    s_waitcnt vmcnt(44) lgkmcnt(0)
    v_cvt_pk_bf16_f32 v216, v200, v201
    v_cvt_pk_bf16_f32 v217, v202, v203
    v_mfma_f32_16x16x32_bf16 v[100:103], a[48:51], v[148:151], v[100:103]
    buffer_load_dwordx4 a[20:23], v241, s[12:15], s20 offen offset:3072
    v_fma_f32 v204, v68, v68, v240
    v_fma_f32 v205, v69, v69, v240
    v_mfma_f32_16x16x32_bf16 v[104:107], a[48:51], v[152:155], v[104:107]
    ds_read_b128 v[164:167], v241 offset:20480
    v_fma_f32 v206, v70, v70, v240
    v_mfma_f32_16x16x32_bf16 v[108:111], a[48:51], v[156:159], v[108:111]
    ds_read_b128 v[168:171], v241 offset:21504
    v_fma_f32 v207, v71, v71, v240
    v_mul_f32 v204, v204, v68
    v_mfma_f32_16x16x32_bf16 v[112:115], a[48:51], v[160:163], v[112:115]
    ds_read_b128 v[172:175], v241 offset:22528
    v_mul_f32 v205, v205, v69
    v_mul_f32 v206, v206, v70
    v_mfma_f32_16x16x32_bf16 v[116:119], a[52:55], v[148:151], v[116:119]
    s_add_u32 s20, s20, 4096
    buffer_load_dwordx4 a[24:27], v241, s[12:15], s20 offen offset:0
    v_mul_f32 v207, v207, v71
    v_exp_f32 v204, -v204
    v_mfma_f32_16x16x32_bf16 v[120:123], a[52:55], v[152:155], v[120:123]
    ds_read_b128 v[176:179], v241 offset:23552
    v_exp_f32 v205, -v205
    v_mfma_f32_16x16x32_bf16 v[124:127], a[52:55], v[156:159], v[124:127]
    v_mfma_f32_16x16x32_bf16 v[128:131], a[52:55], v[160:163], v[128:131]
    v_exp_f32 v206, -v206
    v_mfma_f32_16x16x32_bf16 v[132:135], a[56:59], v[148:151], v[132:135]
    buffer_load_dwordx4 a[28:31], v241, s[12:15], s20 offen offset:1024
    v_exp_f32 v207, -v207
    v_mfma_f32_16x16x32_bf16 v[136:139], a[56:59], v[152:155], v[136:139]
    v_add_f32 v204, 1.0, v204
    v_add_f32 v205, 1.0, v205
    v_mfma_f32_16x16x32_bf16 v[140:143], a[56:59], v[156:159], v[140:143]
    v_add_f32 v206, 1.0, v206
    v_add_f32 v207, 1.0, v207
    v_mfma_f32_16x16x32_bf16 v[144:147], a[56:59], v[160:163], v[144:147]
    s_waitcnt vmcnt(44) lgkmcnt(0)
    v_rcp_f32 v204, v204
    v_mfma_f32_16x16x32_bf16 v[100:103], a[60:63], v[164:167], v[100:103]
    buffer_load_dwordx4 a[32:35], v241, s[12:15], s20 offen offset:2048
    v_rcp_f32 v205, v205
    v_mfma_f32_16x16x32_bf16 v[104:107], a[60:63], v[168:171], v[104:107]
    ds_read_b128 v[148:151], v241 offset:24576
    v_rcp_f32 v206, v206
    v_mfma_f32_16x16x32_bf16 v[108:111], a[60:63], v[172:175], v[108:111]
    ds_read_b128 v[152:155], v241 offset:25600
    v_rcp_f32 v207, v207
    v_mfma_f32_16x16x32_bf16 v[112:115], a[60:63], v[176:179], v[112:115]
    ds_read_b128 v[156:159], v241 offset:26624
    v_mul_f32 v204, v204, v68
    v_mfma_f32_16x16x32_bf16 v[116:119], a[64:67], v[164:167], v[116:119]
    buffer_load_dwordx4 a[36:39], v241, s[12:15], s20 offen offset:3072
    v_mul_f32 v205, v205, v69
    v_mul_f32 v206, v206, v70
    v_mfma_f32_16x16x32_bf16 v[120:123], a[64:67], v[168:171], v[120:123]
    ds_read_b128 v[160:163], v241 offset:27648
    v_mul_f32 v207, v207, v71
    v_cvt_pk_bf16_f32 v218, v204, v205
    v_mfma_f32_16x16x32_bf16 v[124:127], a[64:67], v[172:175], v[124:127]
    v_cvt_pk_bf16_f32 v219, v206, v207
    v_mfma_f32_16x16x32_bf16 v[128:131], a[64:67], v[176:179], v[128:131]
    ds_write_b128 v246, v[216:219] offset:24576
    v_fma_f32 v200, v84, v84, v240
    v_mfma_f32_16x16x32_bf16 v[132:135], a[68:71], v[164:167], v[132:135]
    s_add_u32 s20, s20, 4096
    buffer_load_dwordx4 a[40:43], v241, s[12:15], s20 offen offset:0
    v_fma_f32 v201, v85, v85, v240
    v_fma_f32 v202, v86, v86, v240
    v_mfma_f32_16x16x32_bf16 v[136:139], a[68:71], v[168:171], v[136:139]
    v_fma_f32 v203, v87, v87, v240
    v_mul_f32 v200, v200, v84
    v_mfma_f32_16x16x32_bf16 v[140:143], a[68:71], v[172:175], v[140:143]
    v_mul_f32 v201, v201, v85
    v_mul_f32 v202, v202, v86
    v_mfma_f32_16x16x32_bf16 v[144:147], a[68:71], v[176:179], v[144:147]
    s_waitcnt vmcnt(44) lgkmcnt(1)
    v_mul_f32 v203, v203, v87
    v_mfma_f32_16x16x32_bf16 v[100:103], a[72:75], v[148:151], v[100:103]
    buffer_load_dwordx4 a[44:47], v241, s[12:15], s20 offen offset:1024
    v_exp_f32 v200, -v200
    v_mfma_f32_16x16x32_bf16 v[104:107], a[72:75], v[152:155], v[104:107]
    ds_read_b128 v[164:167], v241 offset:28672
    v_exp_f32 v201, -v201
    v_mfma_f32_16x16x32_bf16 v[108:111], a[72:75], v[156:159], v[108:111]
    ds_read_b128 v[168:171], v241 offset:29696
    v_exp_f32 v202, -v202
    v_mfma_f32_16x16x32_bf16 v[112:115], a[72:75], v[160:163], v[112:115]
    ds_read_b128 v[172:175], v241 offset:30720
    v_exp_f32 v203, -v203
    v_mfma_f32_16x16x32_bf16 v[116:119], a[76:79], v[148:151], v[116:119]
    buffer_load_dwordx4 a[48:51], v241, s[12:15], s20 offen offset:2048
    v_add_f32 v200, 1.0, v200
    v_add_f32 v201, 1.0, v201
    v_mfma_f32_16x16x32_bf16 v[120:123], a[76:79], v[152:155], v[120:123]
    ds_read_b128 v[176:179], v241 offset:31744
    v_add_f32 v202, 1.0, v202
    v_mfma_f32_16x16x32_bf16 v[124:127], a[76:79], v[156:159], v[124:127]
    v_add_f32 v203, 1.0, v203
    v_rcp_f32 v200, v200
    v_mfma_f32_16x16x32_bf16 v[128:131], a[76:79], v[160:163], v[128:131]
    v_rcp_f32 v201, v201
    v_mfma_f32_16x16x32_bf16 v[132:135], a[80:83], v[148:151], v[132:135]
    buffer_load_dwordx4 a[52:55], v241, s[12:15], s20 offen offset:3072
    v_rcp_f32 v202, v202
    v_mfma_f32_16x16x32_bf16 v[136:139], a[80:83], v[152:155], v[136:139]
    v_rcp_f32 v203, v203
    v_mfma_f32_16x16x32_bf16 v[140:143], a[80:83], v[156:159], v[140:143]
    v_mul_f32 v200, v200, v84
    v_mfma_f32_16x16x32_bf16 v[144:147], a[80:83], v[160:163], v[144:147]
    s_waitcnt vmcnt(44) lgkmcnt(0)
    v_mul_f32 v201, v201, v85
    v_mfma_f32_16x16x32_bf16 v[100:103], a[84:87], v[164:167], v[100:103]
    s_add_u32 s20, s20, 4096
    buffer_load_dwordx4 a[56:59], v241, s[12:15], s20 offen offset:0
    v_mul_f32 v202, v202, v86
    v_mul_f32 v203, v203, v87
    v_mfma_f32_16x16x32_bf16 v[104:107], a[84:87], v[168:171], v[104:107]
    ds_read_b128 v[148:151], v241 offset:32768
    v_cvt_pk_bf16_f32 v220, v200, v201
    v_cvt_pk_bf16_f32 v221, v202, v203
    v_mfma_f32_16x16x32_bf16 v[108:111], a[84:87], v[172:175], v[108:111]
    ds_read_b128 v[152:155], v241 offset:33792
    v_mfma_f32_16x16x32_bf16 v[112:115], a[84:87], v[176:179], v[112:115]
    ds_read_b128 v[156:159], v241 offset:34816
    v_mfma_f32_16x16x32_bf16 v[116:119], a[88:91], v[164:167], v[116:119]
    buffer_load_dwordx4 a[60:63], v241, s[12:15], s20 offen offset:1024
    v_mfma_f32_16x16x32_bf16 v[120:123], a[88:91], v[168:171], v[120:123]
    ds_read_b128 v[160:163], v241 offset:35840
    v_mfma_f32_16x16x32_bf16 v[124:127], a[88:91], v[172:175], v[124:127]
    ds_write_b64 v247, v[220:221] offset:24576
    v_fma_f32 v204, v56, v56, v240
    v_fma_f32 v205, v57, v57, v240
    v_fma_f32 v206, v58, v58, v240
    v_fma_f32 v207, v59, v59, v240
    v_mul_f32 v204, v204, v56
    v_mul_f32 v205, v205, v57
    v_mul_f32 v206, v206, v58
    v_mul_f32 v207, v207, v59
    v_mfma_f32_16x16x32_bf16 v[128:131], a[88:91], v[176:179], v[128:131]
    v_exp_f32 v204, -v204
    v_mfma_f32_16x16x32_bf16 v[132:135], a[92:95], v[164:167], v[132:135]
    buffer_load_dwordx4 a[64:67], v241, s[12:15], s20 offen offset:2048
    v_exp_f32 v205, -v205
    v_mfma_f32_16x16x32_bf16 v[136:139], a[92:95], v[168:171], v[136:139]
    v_exp_f32 v206, -v206
    v_mfma_f32_16x16x32_bf16 v[140:143], a[92:95], v[172:175], v[140:143]
    v_exp_f32 v207, -v207
    v_mfma_f32_16x16x32_bf16 v[144:147], a[92:95], v[176:179], v[144:147]
    s_waitcnt vmcnt(44) lgkmcnt(1)
    v_add_f32 v204, 1.0, v204
    v_mfma_f32_16x16x32_bf16 v[100:103], a[96:99], v[148:151], v[100:103]
    buffer_load_dwordx4 a[68:71], v241, s[12:15], s20 offen offset:3072
    v_add_f32 v205, 1.0, v205
    v_add_f32 v206, 1.0, v206
    v_mfma_f32_16x16x32_bf16 v[104:107], a[96:99], v[152:155], v[104:107]
    ds_read_b128 v[164:167], v241 offset:36864
    v_add_f32 v207, 1.0, v207
    v_rcp_f32 v204, v204
    v_mfma_f32_16x16x32_bf16 v[108:111], a[96:99], v[156:159], v[108:111]
    ds_read_b128 v[168:171], v241 offset:37888
    v_rcp_f32 v205, v205
    v_mfma_f32_16x16x32_bf16 v[112:115], a[96:99], v[160:163], v[112:115]
    ds_read_b128 v[172:175], v241 offset:38912
    v_rcp_f32 v206, v206
    v_mfma_f32_16x16x32_bf16 v[116:119], a[100:103], v[148:151], v[116:119]
    s_add_u32 s20, s20, 4096
    buffer_load_dwordx4 a[72:75], v241, s[12:15], s20 offen offset:0
    v_mfma_f32_16x16x32_bf16 v[120:123], a[100:103], v[152:155], v[120:123]
    ds_read_b128 v[176:179], v241 offset:39936
    v_rcp_f32 v207, v207
    v_mfma_f32_16x16x32_bf16 v[124:127], a[100:103], v[156:159], v[124:127]
    v_mul_f32 v204, v204, v56
    v_mul_f32 v205, v205, v57
    v_mfma_f32_16x16x32_bf16 v[128:131], a[100:103], v[160:163], v[128:131]
    v_mul_f32 v206, v206, v58
    v_mul_f32 v207, v207, v59
    v_mfma_f32_16x16x32_bf16 v[132:135], a[104:107], v[148:151], v[132:135]
    buffer_load_dwordx4 a[76:79], v241, s[12:15], s20 offen offset:1024
    v_cvt_pk_bf16_f32 v224, v204, v205
    v_cvt_pk_bf16_f32 v225, v206, v207
    v_mfma_f32_16x16x32_bf16 v[136:139], a[104:107], v[152:155], v[136:139]
    v_fma_f32 v200, v72, v72, v240
    v_mfma_f32_16x16x32_bf16 v[140:143], a[104:107], v[156:159], v[140:143]
    v_fma_f32 v201, v73, v73, v240
    v_fma_f32 v202, v74, v74, v240
    v_mfma_f32_16x16x32_bf16 v[144:147], a[104:107], v[160:163], v[144:147]
    s_waitcnt vmcnt(44) lgkmcnt(0)
    v_fma_f32 v203, v75, v75, v240
    v_mul_f32 v200, v200, v72
    v_mfma_f32_16x16x32_bf16 v[100:103], a[108:111], v[164:167], v[100:103]
    buffer_load_dwordx4 a[80:83], v241, s[12:15], s20 offen offset:2048
    v_mul_f32 v201, v201, v73
    v_mul_f32 v202, v202, v74
    v_mfma_f32_16x16x32_bf16 v[104:107], a[108:111], v[168:171], v[104:107]
    ds_read_b128 v[148:151], v241 offset:40960
    v_mul_f32 v203, v203, v75
    v_exp_f32 v200, -v200
    v_mfma_f32_16x16x32_bf16 v[108:111], a[108:111], v[172:175], v[108:111]
    ds_read_b128 v[152:155], v241 offset:41984
    v_exp_f32 v201, -v201
    v_mfma_f32_16x16x32_bf16 v[112:115], a[108:111], v[176:179], v[112:115]
    ds_read_b128 v[156:159], v241 offset:43008
    v_mfma_f32_16x16x32_bf16 v[116:119], a[112:115], v[164:167], v[116:119]
    buffer_load_dwordx4 a[84:87], v241, s[12:15], s20 offen offset:3072
    v_exp_f32 v202, -v202
    v_mfma_f32_16x16x32_bf16 v[120:123], a[112:115], v[168:171], v[120:123]
    ds_read_b128 v[160:163], v241 offset:44032
    v_exp_f32 v203, -v203
    v_mfma_f32_16x16x32_bf16 v[124:127], a[112:115], v[172:175], v[124:127]
    v_add_f32 v200, 1.0, v200
    v_add_f32 v201, 1.0, v201
    v_mfma_f32_16x16x32_bf16 v[128:131], a[112:115], v[176:179], v[128:131]
    v_add_f32 v202, 1.0, v202
    v_add_f32 v203, 1.0, v203
    v_mfma_f32_16x16x32_bf16 v[132:135], a[116:119], v[164:167], v[132:135]
    s_add_u32 s20, s20, 4096
    buffer_load_dwordx4 a[88:91], v241, s[12:15], s20 offen offset:0
    v_rcp_f32 v200, v200
    v_mfma_f32_16x16x32_bf16 v[136:139], a[116:119], v[168:171], v[136:139]
    v_rcp_f32 v201, v201
    v_mfma_f32_16x16x32_bf16 v[140:143], a[116:119], v[172:175], v[140:143]
    buffer_load_dwordx4 a[92:95], v241, s[12:15], s20 offen offset:1024
    v_rcp_f32 v202, v202
    v_mfma_f32_16x16x32_bf16 v[144:147], a[116:119], v[176:179], v[144:147]
    s_waitcnt vmcnt(45) lgkmcnt(0)
    v_rcp_f32 v203, v203
    v_mfma_f32_16x16x32_bf16 v[100:103], a[120:123], v[148:151], v[100:103]
    buffer_load_dwordx4 a[96:99], v241, s[12:15], s20 offen offset:2048
    v_mul_f32 v200, v200, v72
    v_mfma_f32_16x16x32_bf16 v[104:107], a[120:123], v[152:155], v[104:107]
    ds_read_b128 v[164:167], v241 offset:45056
    v_mul_f32 v201, v201, v73
    v_mul_f32 v202, v202, v74
    v_mfma_f32_16x16x32_bf16 v[108:111], a[120:123], v[156:159], v[108:111]
    ds_read_b128 v[168:171], v241 offset:46080
    v_mul_f32 v203, v203, v75
    v_cvt_pk_bf16_f32 v226, v200, v201
    v_mfma_f32_16x16x32_bf16 v[112:115], a[120:123], v[160:163], v[112:115]
    ds_read_b128 v[172:175], v241 offset:47104
    v_cvt_pk_bf16_f32 v227, v202, v203
    v_mfma_f32_16x16x32_bf16 v[116:119], a[124:127], v[148:151], v[116:119]
    buffer_load_dwordx4 a[100:103], v241, s[12:15], s20 offen offset:3072
    v_mfma_f32_16x16x32_bf16 v[120:123], a[124:127], v[152:155], v[120:123]
    ds_read_b128 v[176:179], v241 offset:48128
    v_mfma_f32_16x16x32_bf16 v[124:127], a[124:127], v[156:159], v[124:127]
    ds_write_b128 v246, v[224:227] offset:25600
    v_fma_f32 v204, v88, v88, v240
    v_fma_f32 v205, v89, v89, v240
    v_fma_f32 v206, v90, v90, v240
    v_fma_f32 v207, v91, v91, v240
    v_mul_f32 v204, v204, v88
    v_mfma_f32_16x16x32_bf16 v[128:131], a[124:127], v[160:163], v[128:131]
    v_mul_f32 v205, v205, v89
    v_mul_f32 v206, v206, v90
    v_mfma_f32_16x16x32_bf16 v[132:135], a[128:131], v[148:151], v[132:135]
    s_add_u32 s20, s20, 4096
    buffer_load_dwordx4 a[104:107], v241, s[12:15], s20 offen offset:0
    v_mul_f32 v207, v207, v91
    v_mfma_f32_16x16x32_bf16 v[136:139], a[128:131], v[152:155], v[136:139]
    v_exp_f32 v204, -v204
    v_mfma_f32_16x16x32_bf16 v[140:143], a[128:131], v[156:159], v[140:143]
    v_exp_f32 v205, -v205
    v_mfma_f32_16x16x32_bf16 v[144:147], a[128:131], v[160:163], v[144:147]
    s_waitcnt vmcnt(45) lgkmcnt(1)
    v_exp_f32 v206, -v206
    v_mfma_f32_16x16x32_bf16 v[100:103], a[132:135], v[164:167], v[100:103]
    buffer_load_dwordx4 a[108:111], v241, s[12:15], s20 offen offset:1024
    v_exp_f32 v207, -v207
    v_mfma_f32_16x16x32_bf16 v[104:107], a[132:135], v[168:171], v[104:107]
    ds_read_b128 v[148:151], v241 offset:49152
    v_add_f32 v204, 1.0, v204
    v_add_f32 v205, 1.0, v205
    v_mfma_f32_16x16x32_bf16 v[108:111], a[132:135], v[172:175], v[108:111]
    ds_read_b128 v[152:155], v241 offset:50176
    v_add_f32 v206, 1.0, v206
    v_mfma_f32_16x16x32_bf16 v[112:115], a[132:135], v[176:179], v[112:115]
    ds_read_b128 v[156:159], v241 offset:51200
    v_add_f32 v207, 1.0, v207
    v_rcp_f32 v204, v204
    v_mfma_f32_16x16x32_bf16 v[116:119], a[136:139], v[164:167], v[116:119]
    buffer_load_dwordx4 a[112:115], v241, s[12:15], s20 offen offset:2048
    v_rcp_f32 v205, v205
    v_mfma_f32_16x16x32_bf16 v[120:123], a[136:139], v[168:171], v[120:123]
    ds_read_b128 v[160:163], v241 offset:52224
    v_rcp_f32 v206, v206
    v_mfma_f32_16x16x32_bf16 v[124:127], a[136:139], v[172:175], v[124:127]
    v_rcp_f32 v207, v207
    v_mfma_f32_16x16x32_bf16 v[128:131], a[136:139], v[176:179], v[128:131]
    v_mul_f32 v204, v204, v88
    v_mfma_f32_16x16x32_bf16 v[132:135], a[140:143], v[164:167], v[132:135]
    buffer_load_dwordx4 a[116:119], v241, s[12:15], s20 offen offset:3072
    v_mul_f32 v205, v205, v89
    v_mfma_f32_16x16x32_bf16 v[136:139], a[140:143], v[168:171], v[136:139]
    v_mul_f32 v206, v206, v90
    v_mul_f32 v207, v207, v91
    v_mfma_f32_16x16x32_bf16 v[140:143], a[140:143], v[172:175], v[140:143]
    v_cvt_pk_bf16_f32 v228, v204, v205
    v_cvt_pk_bf16_f32 v229, v206, v207
    v_mfma_f32_16x16x32_bf16 v[144:147], a[140:143], v[176:179], v[144:147]
    s_waitcnt vmcnt(45) lgkmcnt(0)
    ds_write_b64 v247, v[228:229] offset:25600
    v_fma_f32 v200, v60, v60, v240
    v_mfma_f32_16x16x32_bf16 v[100:103], a[144:147], v[148:151], v[100:103]
    s_add_u32 s20, s20, 4096
    buffer_load_dwordx4 a[120:123], v241, s[12:15], s20 offen offset:0
    v_fma_f32 v201, v61, v61, v240
    v_fma_f32 v202, v62, v62, v240
    v_mfma_f32_16x16x32_bf16 v[104:107], a[144:147], v[152:155], v[104:107]
    ds_read_b128 v[164:167], v241 offset:53248
    v_fma_f32 v203, v63, v63, v240
    v_mfma_f32_16x16x32_bf16 v[108:111], a[144:147], v[156:159], v[108:111]
    ds_read_b128 v[168:171], v241 offset:54272
    v_mul_f32 v200, v200, v60
    v_mul_f32 v201, v201, v61
    v_mfma_f32_16x16x32_bf16 v[112:115], a[144:147], v[160:163], v[112:115]
    ds_read_b128 v[172:175], v241 offset:55296
    v_mul_f32 v202, v202, v62
    v_mul_f32 v203, v203, v63
    v_mfma_f32_16x16x32_bf16 v[116:119], a[148:151], v[148:151], v[116:119]
    buffer_load_dwordx4 a[124:127], v241, s[12:15], s20 offen offset:1024
    v_exp_f32 v200, -v200
    v_mfma_f32_16x16x32_bf16 v[120:123], a[148:151], v[152:155], v[120:123]
    ds_read_b128 v[176:179], v241 offset:56320
    v_exp_f32 v201, -v201
    v_mfma_f32_16x16x32_bf16 v[124:127], a[148:151], v[156:159], v[124:127]
    v_exp_f32 v202, -v202
    v_mfma_f32_16x16x32_bf16 v[128:131], a[148:151], v[160:163], v[128:131]
    v_exp_f32 v203, -v203
    v_mfma_f32_16x16x32_bf16 v[132:135], a[152:155], v[148:151], v[132:135]
    buffer_load_dwordx4 a[128:131], v241, s[12:15], s20 offen offset:2048
    v_add_f32 v200, 1.0, v200
    v_mfma_f32_16x16x32_bf16 v[136:139], a[152:155], v[152:155], v[136:139]
    v_add_f32 v201, 1.0, v201
    v_add_f32 v202, 1.0, v202
    v_mfma_f32_16x16x32_bf16 v[140:143], a[152:155], v[156:159], v[140:143]
    v_add_f32 v203, 1.0, v203
    v_rcp_f32 v200, v200
    v_mfma_f32_16x16x32_bf16 v[144:147], a[152:155], v[160:163], v[144:147]
    s_waitcnt vmcnt(45) lgkmcnt(0)
    v_rcp_f32 v201, v201
    v_mfma_f32_16x16x32_bf16 v[100:103], a[156:159], v[164:167], v[100:103]
    buffer_load_dwordx4 a[132:135], v241, s[12:15], s20 offen offset:3072
    v_rcp_f32 v202, v202
    v_mfma_f32_16x16x32_bf16 v[104:107], a[156:159], v[168:171], v[104:107]
    ds_read_b128 v[148:151], v241 offset:57344
    v_mfma_f32_16x16x32_bf16 v[108:111], a[156:159], v[172:175], v[108:111]
    ds_read_b128 v[152:155], v241 offset:58368
    v_rcp_f32 v203, v203
    v_mfma_f32_16x16x32_bf16 v[112:115], a[156:159], v[176:179], v[112:115]
    ds_read_b128 v[156:159], v241 offset:59392
    v_mul_f32 v200, v200, v60
    v_mul_f32 v201, v201, v61
    v_mfma_f32_16x16x32_bf16 v[116:119], a[160:163], v[164:167], v[116:119]
    s_add_u32 s20, s20, 4096
    buffer_load_dwordx4 a[136:139], v241, s[12:15], s20 offen offset:0
    v_mul_f32 v202, v202, v62
    v_mul_f32 v203, v203, v63
    v_mfma_f32_16x16x32_bf16 v[120:123], a[160:163], v[168:171], v[120:123]
    ds_read_b128 v[160:163], v241 offset:60416
    v_cvt_pk_bf16_f32 v216, v200, v201
    v_cvt_pk_bf16_f32 v217, v202, v203
    v_mfma_f32_16x16x32_bf16 v[124:127], a[160:163], v[172:175], v[124:127]
    v_fma_f32 v204, v76, v76, v240
    v_mfma_f32_16x16x32_bf16 v[128:131], a[160:163], v[176:179], v[128:131]
    v_fma_f32 v205, v77, v77, v240
    v_fma_f32 v206, v78, v78, v240
    v_mfma_f32_16x16x32_bf16 v[132:135], a[164:167], v[164:167], v[132:135]
    buffer_load_dwordx4 a[140:143], v241, s[12:15], s20 offen offset:1024
    v_fma_f32 v207, v79, v79, v240
    v_mul_f32 v204, v204, v76
    v_mfma_f32_16x16x32_bf16 v[136:139], a[164:167], v[168:171], v[136:139]
    v_mul_f32 v205, v205, v77
    v_mul_f32 v206, v206, v78
    v_mfma_f32_16x16x32_bf16 v[140:143], a[164:167], v[172:175], v[140:143]
    v_mul_f32 v207, v207, v79
    v_exp_f32 v204, -v204
    v_mfma_f32_16x16x32_bf16 v[144:147], a[164:167], v[176:179], v[144:147]
    s_waitcnt vmcnt(45) lgkmcnt(0)
    v_exp_f32 v205, -v205
    v_mfma_f32_16x16x32_bf16 v[100:103], a[168:171], v[148:151], v[100:103]
    s_add_u32 s20, s20, 20480
    buffer_load_dwordx4 a[144:147], v241, s[12:15], s20 offen offset:0
    v_mfma_f32_16x16x32_bf16 v[104:107], a[168:171], v[152:155], v[104:107]
    ds_read_b128 v[164:167], v241 offset:61440
    v_exp_f32 v206, -v206
    v_mfma_f32_16x16x32_bf16 v[108:111], a[168:171], v[156:159], v[108:111]
    ds_read_b128 v[168:171], v241 offset:62464
    v_exp_f32 v207, -v207
    v_mfma_f32_16x16x32_bf16 v[112:115], a[168:171], v[160:163], v[112:115]
    ds_read_b128 v[172:175], v241 offset:63488
    v_add_f32 v204, 1.0, v204
    v_add_f32 v205, 1.0, v205
    v_mfma_f32_16x16x32_bf16 v[116:119], a[172:175], v[148:151], v[116:119]
    buffer_load_dwordx4 a[148:151], v241, s[12:15], s20 offen offset:1024
    v_add_f32 v206, 1.0, v206
    v_add_f32 v207, 1.0, v207
    v_mfma_f32_16x16x32_bf16 v[120:123], a[172:175], v[152:155], v[120:123]
    ds_read_b128 v[176:179], v241 offset:64512
    v_rcp_f32 v204, v204
    v_mfma_f32_16x16x32_bf16 v[124:127], a[172:175], v[156:159], v[124:127]
    v_rcp_f32 v205, v205
    v_mfma_f32_16x16x32_bf16 v[128:131], a[172:175], v[160:163], v[128:131]
    v_rcp_f32 v206, v206
    v_mfma_f32_16x16x32_bf16 v[132:135], a[176:179], v[148:151], v[132:135]
    buffer_load_dwordx4 a[152:155], v241, s[12:15], s20 offen offset:2048
    v_rcp_f32 v207, v207
    v_mfma_f32_16x16x32_bf16 v[136:139], a[176:179], v[152:155], v[136:139]
    v_mul_f32 v204, v204, v76
    v_mfma_f32_16x16x32_bf16 v[140:143], a[176:179], v[156:159], v[140:143]
    v_mul_f32 v205, v205, v77
    v_mul_f32 v206, v206, v78
    v_mfma_f32_16x16x32_bf16 v[144:147], a[176:179], v[160:163], v[144:147]
    s_waitcnt vmcnt(45) lgkmcnt(0)
    v_mul_f32 v207, v207, v79
    v_mfma_f32_16x16x32_bf16 v[100:103], a[180:183], v[164:167], v[100:103]
    buffer_load_dwordx4 a[156:159], v241, s[12:15], s20 offen offset:3072
    v_cvt_pk_bf16_f32 v218, v204, v205
    v_cvt_pk_bf16_f32 v219, v206, v207
    v_mfma_f32_16x16x32_bf16 v[104:107], a[180:183], v[168:171], v[104:107]
    ds_read_b128 v[148:151], v244 offset:0
    v_mfma_f32_16x16x32_bf16 v[108:111], a[180:183], v[172:175], v[108:111]
    ds_read_b128 v[152:155], v244 offset:1024
    v_mfma_f32_16x16x32_bf16 v[112:115], a[180:183], v[176:179], v[112:115]
    ds_read_b128 v[156:159], v244 offset:2048
    v_mfma_f32_16x16x32_bf16 v[116:119], a[184:187], v[164:167], v[116:119]
    s_add_u32 s20, s20, 4096
    buffer_load_dwordx4 a[160:163], v241, s[12:15], s20 offen offset:0
    v_mfma_f32_16x16x32_bf16 v[120:123], a[184:187], v[168:171], v[120:123]
    ds_read_b128 v[160:163], v244 offset:3072
    v_mfma_f32_16x16x32_bf16 v[124:127], a[184:187], v[172:175], v[124:127]
    ds_write_b128 v246, v[216:219] offset:26624
    v_fma_f32 v200, v92, v92, v240
    v_fma_f32 v201, v93, v93, v240
    v_fma_f32 v202, v94, v94, v240
    v_fma_f32 v203, v95, v95, v240
    v_mul_f32 v200, v200, v92
    v_mul_f32 v201, v201, v93
    v_mul_f32 v202, v202, v94
    v_mul_f32 v203, v203, v95
    v_exp_f32 v200, -v200
    v_mfma_f32_16x16x32_bf16 v[128:131], a[184:187], v[176:179], v[128:131]
    v_exp_f32 v201, -v201
    v_mfma_f32_16x16x32_bf16 v[132:135], a[188:191], v[164:167], v[132:135]
    buffer_load_dwordx4 a[164:167], v241, s[12:15], s20 offen offset:1024
    v_exp_f32 v202, -v202
    v_mfma_f32_16x16x32_bf16 v[136:139], a[188:191], v[168:171], v[136:139]
    v_exp_f32 v203, -v203
    v_mfma_f32_16x16x32_bf16 v[140:143], a[188:191], v[172:175], v[140:143]
    buffer_load_dwordx4 a[168:171], v241, s[12:15], s20 offen offset:2048
    v_add_f32 v200, 1.0, v200
    v_add_f32 v201, 1.0, v201
    v_mfma_f32_16x16x32_bf16 v[144:147], a[188:191], v[176:179], v[144:147]
    s_waitcnt vmcnt(46) lgkmcnt(1)
    v_add_f32 v202, 1.0, v202
    v_mfma_f32_16x16x32_bf16 v[100:103], a[192:195], v[148:151], v[100:103]
    buffer_load_dwordx4 a[172:175], v241, s[12:15], s20 offen offset:3072
    v_add_f32 v203, 1.0, v203
    v_rcp_f32 v200, v200
    v_mfma_f32_16x16x32_bf16 v[104:107], a[192:195], v[152:155], v[104:107]
    ds_read_b128 v[164:167], v244 offset:4096
    v_rcp_f32 v201, v201
    v_mfma_f32_16x16x32_bf16 v[108:111], a[192:195], v[156:159], v[108:111]
    ds_read_b128 v[168:171], v244 offset:5120
    v_rcp_f32 v202, v202
    v_mfma_f32_16x16x32_bf16 v[112:115], a[192:195], v[160:163], v[112:115]
    ds_read_b128 v[172:175], v244 offset:6144
    v_rcp_f32 v203, v203
    v_mfma_f32_16x16x32_bf16 v[116:119], a[196:199], v[148:151], v[116:119]
    s_add_u32 s20, s20, 4096
    buffer_load_dwordx4 a[176:179], v241, s[12:15], s20 offen offset:0
    v_mfma_f32_16x16x32_bf16 v[120:123], a[196:199], v[152:155], v[120:123]
    ds_read_b128 v[176:179], v244 offset:7168
    v_mul_f32 v200, v200, v92
    v_mul_f32 v201, v201, v93
    v_mfma_f32_16x16x32_bf16 v[124:127], a[196:199], v[156:159], v[124:127]
    v_mul_f32 v202, v202, v94
    v_mul_f32 v203, v203, v95
    v_mfma_f32_16x16x32_bf16 v[128:131], a[196:199], v[160:163], v[128:131]
    v_cvt_pk_bf16_f32 v220, v200, v201
    v_cvt_pk_bf16_f32 v221, v202, v203
    v_mfma_f32_16x16x32_bf16 v[132:135], a[200:203], v[148:151], v[132:135]
    buffer_load_dwordx4 a[180:183], v241, s[12:15], s20 offen offset:1024
    v_mfma_f32_16x16x32_bf16 v[136:139], a[200:203], v[152:155], v[136:139]
    ds_write_b64 v247, v[220:221] offset:26624
    v_fma_f32 v204, v64, v64, v240
    v_fma_f32 v205, v65, v65, v240
    v_fma_f32 v206, v66, v66, v240
    v_mfma_f32_16x16x32_bf16 v[140:143], a[200:203], v[156:159], v[140:143]
    v_fma_f32 v207, v67, v67, v240
    v_mfma_f32_16x16x32_bf16 v[144:147], a[200:203], v[160:163], v[144:147]
    s_waitcnt vmcnt(46) lgkmcnt(1)
    v_mul_f32 v204, v204, v64
    v_mul_f32 v205, v205, v65
    v_mfma_f32_16x16x32_bf16 v[100:103], a[204:207], v[164:167], v[100:103]
    s_waitcnt lgkmcnt(0)
    s_barrier
    buffer_load_dwordx4 a[184:187], v241, s[12:15], s20 offen offset:2048
    v_mul_f32 v206, v206, v66
    v_mul_f32 v207, v207, v67
    v_mfma_f32_16x16x32_bf16 v[104:107], a[204:207], v[168:171], v[104:107]
    ds_read_b128 v[148:151], v244 offset:8192
    v_exp_f32 v204, -v204
    v_mfma_f32_16x16x32_bf16 v[108:111], a[204:207], v[172:175], v[108:111]
    ds_read_b128 v[152:155], v244 offset:9216
    v_exp_f32 v205, -v205
    v_mfma_f32_16x16x32_bf16 v[112:115], a[204:207], v[176:179], v[112:115]
    ds_read_b128 v[156:159], v244 offset:10240
    v_exp_f32 v206, -v206
    v_mfma_f32_16x16x32_bf16 v[116:119], a[208:211], v[164:167], v[116:119]
    buffer_load_dwordx4 a[188:191], v241, s[12:15], s20 offen offset:3072
    v_exp_f32 v207, -v207
    v_mfma_f32_16x16x32_bf16 v[120:123], a[208:211], v[168:171], v[120:123]
    ds_read_b128 v[160:163], v244 offset:11264
    v_add_f32 v204, 1.0, v204
    v_mfma_f32_16x16x32_bf16 v[124:127], a[208:211], v[172:175], v[124:127]
    v_add_f32 v205, 1.0, v205
    v_add_f32 v206, 1.0, v206
    v_mfma_f32_16x16x32_bf16 v[128:131], a[208:211], v[176:179], v[128:131]
    v_add_f32 v207, 1.0, v207
    v_rcp_f32 v204, v204
    v_mfma_f32_16x16x32_bf16 v[132:135], a[212:215], v[164:167], v[132:135]
    s_add_u32 s20, s20, 4096
    buffer_load_dwordx4 a[192:195], v241, s[12:15], s20 offen offset:0
    v_rcp_f32 v205, v205
    v_mfma_f32_16x16x32_bf16 v[136:139], a[212:215], v[168:171], v[136:139]
    v_rcp_f32 v206, v206
    v_mfma_f32_16x16x32_bf16 v[140:143], a[212:215], v[172:175], v[140:143]
    v_mfma_f32_16x16x32_bf16 v[144:147], a[212:215], v[176:179], v[144:147]
    s_waitcnt vmcnt(46) lgkmcnt(0)
    v_rcp_f32 v207, v207
    v_mfma_f32_16x16x32_bf16 v[4:7], a[0:3], v[148:151], 0
    buffer_load_dwordx4 a[196:199], v241, s[12:15], s20 offen offset:1024
    v_mul_f32 v204, v204, v64
    v_mul_f32 v205, v205, v65
    v_mfma_f32_16x16x32_bf16 v[8:11], a[0:3], v[152:155], 0
    ds_read_b128 v[164:167], v244 offset:12288
    v_mul_f32 v206, v206, v66
    v_mul_f32 v207, v207, v67
    v_mfma_f32_16x16x32_bf16 v[12:15], a[0:3], v[156:159], 0
    ds_read_b128 v[168:171], v244 offset:13312
    v_cvt_pk_bf16_f32 v224, v204, v205
    v_cvt_pk_bf16_f32 v225, v206, v207
    v_mfma_f32_16x16x32_bf16 v[16:19], a[0:3], v[160:163], 0
    ds_read_b128 v[172:175], v244 offset:14336
    v_fma_f32 v200, v80, v80, v240
    v_mfma_f32_16x16x32_bf16 v[20:23], a[4:7], v[148:151], 0
    buffer_load_dwordx4 a[200:203], v241, s[12:15], s20 offen offset:2048
    v_fma_f32 v201, v81, v81, v240
    v_fma_f32 v202, v82, v82, v240
    v_mfma_f32_16x16x32_bf16 v[24:27], a[4:7], v[152:155], 0
    ds_read_b128 v[176:179], v244 offset:15360
    v_fma_f32 v203, v83, v83, v240
    v_mul_f32 v200, v200, v80
    v_mfma_f32_16x16x32_bf16 v[28:31], a[4:7], v[156:159], 0
    v_mul_f32 v201, v201, v81
    v_mul_f32 v202, v202, v82
    v_mfma_f32_16x16x32_bf16 v[32:35], a[4:7], v[160:163], 0
    v_mul_f32 v203, v203, v83
    v_exp_f32 v200, -v200
    v_mfma_f32_16x16x32_bf16 v[36:39], a[8:11], v[148:151], 0
    buffer_load_dwordx4 a[204:207], v241, s[12:15], s20 offen offset:3072
    v_exp_f32 v201, -v201
    v_mfma_f32_16x16x32_bf16 v[40:43], a[8:11], v[152:155], 0
    v_mfma_f32_16x16x32_bf16 v[44:47], a[8:11], v[156:159], 0
    v_exp_f32 v202, -v202
    v_mfma_f32_16x16x32_bf16 v[48:51], a[8:11], v[160:163], 0
    s_waitcnt vmcnt(46) lgkmcnt(0)
    v_exp_f32 v203, -v203
    v_mfma_f32_16x16x32_bf16 v[4:7], a[12:15], v[164:167], v[4:7]
    s_add_u32 s20, s20, 4096
    buffer_load_dwordx4 a[208:211], v241, s[12:15], s20 offen offset:0
    v_add_f32 v200, 1.0, v200
    v_add_f32 v201, 1.0, v201
    v_mfma_f32_16x16x32_bf16 v[8:11], a[12:15], v[168:171], v[8:11]
    ds_read_b128 v[148:151], v244 offset:16384
    v_add_f32 v202, 1.0, v202
    v_add_f32 v203, 1.0, v203
    v_mfma_f32_16x16x32_bf16 v[12:15], a[12:15], v[172:175], v[12:15]
    ds_read_b128 v[152:155], v244 offset:17408
    v_rcp_f32 v200, v200
    v_mfma_f32_16x16x32_bf16 v[16:19], a[12:15], v[176:179], v[16:19]
    ds_read_b128 v[156:159], v244 offset:18432
    v_rcp_f32 v201, v201
    v_mfma_f32_16x16x32_bf16 v[20:23], a[16:19], v[164:167], v[20:23]
    buffer_load_dwordx4 a[212:215], v241, s[12:15], s20 offen offset:1024
    v_rcp_f32 v202, v202
    v_mfma_f32_16x16x32_bf16 v[24:27], a[16:19], v[168:171], v[24:27]
    ds_read_b128 v[160:163], v244 offset:19456
    v_rcp_f32 v203, v203
    v_mfma_f32_16x16x32_bf16 v[28:31], a[16:19], v[172:175], v[28:31]
    v_mul_f32 v200, v200, v80
    v_mfma_f32_16x16x32_bf16 v[32:35], a[16:19], v[176:179], v[32:35]
    v_mul_f32 v201, v201, v81
    v_mul_f32 v202, v202, v82
    v_mfma_f32_16x16x32_bf16 v[36:39], a[20:23], v[164:167], v[36:39]
    buffer_load_dwordx4 a[0:3], v241, s[12:15], s20 offen offset:2048
    v_mul_f32 v203, v203, v83
    v_mfma_f32_16x16x32_bf16 v[40:43], a[20:23], v[168:171], v[40:43]
    v_cvt_pk_bf16_f32 v226, v200, v201
    v_cvt_pk_bf16_f32 v227, v202, v203
    v_mfma_f32_16x16x32_bf16 v[44:47], a[20:23], v[172:175], v[44:47]
    ds_write_b128 v246, v[224:227] offset:27648
    v_fma_f32 v204, v96, v96, v240
    v_mfma_f32_16x16x32_bf16 v[48:51], a[20:23], v[176:179], v[48:51]
    s_waitcnt vmcnt(46) lgkmcnt(1)
    v_fma_f32 v205, v97, v97, v240
    v_fma_f32 v206, v98, v98, v240
    v_mfma_f32_16x16x32_bf16 v[4:7], a[24:27], v[148:151], v[4:7]
    buffer_load_dwordx4 a[4:7], v241, s[12:15], s20 offen offset:3072
    v_fma_f32 v207, v99, v99, v240
    v_mul_f32 v204, v204, v96
    v_mfma_f32_16x16x32_bf16 v[8:11], a[24:27], v[152:155], v[8:11]
    ds_read_b128 v[164:167], v244 offset:20480
    v_mul_f32 v205, v205, v97
    v_mul_f32 v206, v206, v98
    v_mfma_f32_16x16x32_bf16 v[12:15], a[24:27], v[156:159], v[12:15]
    ds_read_b128 v[168:171], v244 offset:21504
    v_mul_f32 v207, v207, v99
    v_mfma_f32_16x16x32_bf16 v[16:19], a[24:27], v[160:163], v[16:19]
    ds_read_b128 v[172:175], v244 offset:22528
    v_exp_f32 v204, -v204
    v_mfma_f32_16x16x32_bf16 v[20:23], a[28:31], v[148:151], v[20:23]
    s_add_u32 s20, s20, 4096
    buffer_load_dwordx4 a[8:11], v241, s[12:15], s20 offen offset:0
    v_exp_f32 v205, -v205
    v_mfma_f32_16x16x32_bf16 v[24:27], a[28:31], v[152:155], v[24:27]
    ds_read_b128 v[176:179], v244 offset:23552
    v_exp_f32 v206, -v206
    v_mfma_f32_16x16x32_bf16 v[28:31], a[28:31], v[156:159], v[28:31]
    v_exp_f32 v207, -v207
    v_mfma_f32_16x16x32_bf16 v[32:35], a[28:31], v[160:163], v[32:35]
    v_add_f32 v204, 1.0, v204
    v_add_f32 v205, 1.0, v205
    v_mfma_f32_16x16x32_bf16 v[36:39], a[32:35], v[148:151], v[36:39]
    buffer_load_dwordx4 a[12:15], v241, s[12:15], s20 offen offset:1024
    v_add_f32 v206, 1.0, v206
    v_mfma_f32_16x16x32_bf16 v[40:43], a[32:35], v[152:155], v[40:43]
    v_add_f32 v207, 1.0, v207
    v_rcp_f32 v204, v204
    v_mfma_f32_16x16x32_bf16 v[44:47], a[32:35], v[156:159], v[44:47]
    v_rcp_f32 v205, v205
    v_mfma_f32_16x16x32_bf16 v[48:51], a[32:35], v[160:163], v[48:51]
    s_waitcnt vmcnt(46) lgkmcnt(0)
    v_rcp_f32 v206, v206
    v_mfma_f32_16x16x32_bf16 v[4:7], a[36:39], v[164:167], v[4:7]
    buffer_load_dwordx4 a[16:19], v241, s[12:15], s20 offen offset:2048
    v_rcp_f32 v207, v207
    v_mfma_f32_16x16x32_bf16 v[8:11], a[36:39], v[168:171], v[8:11]
    ds_read_b128 v[148:151], v244 offset:24576
    v_mfma_f32_16x16x32_bf16 v[12:15], a[36:39], v[172:175], v[12:15]
    ds_read_b128 v[152:155], v244 offset:25600
    v_mul_f32 v204, v204, v96
    v_mul_f32 v205, v205, v97
    v_mfma_f32_16x16x32_bf16 v[16:19], a[36:39], v[176:179], v[16:19]
    ds_read_b128 v[156:159], v244 offset:26624
    v_mul_f32 v206, v206, v98
    v_mul_f32 v207, v207, v99
    v_mfma_f32_16x16x32_bf16 v[20:23], a[40:43], v[164:167], v[20:23]
    buffer_load_dwordx4 a[20:23], v241, s[12:15], s20 offen offset:3072
    v_cvt_pk_bf16_f32 v228, v204, v205
    v_cvt_pk_bf16_f32 v229, v206, v207
    v_mfma_f32_16x16x32_bf16 v[24:27], a[40:43], v[168:171], v[24:27]
    ds_read_b128 v[160:163], v244 offset:27648
    v_mfma_f32_16x16x32_bf16 v[28:31], a[40:43], v[172:175], v[28:31]
    ds_write_b64 v247, v[228:229] offset:27648
    v_fma_f32 v200, v100, v100, v240
    v_fma_f32 v201, v101, v101, v240
    v_fma_f32 v202, v102, v102, v240
    v_mfma_f32_16x16x32_bf16 v[32:35], a[40:43], v[176:179], v[32:35]
    v_fma_f32 v203, v103, v103, v240
    v_mfma_f32_16x16x32_bf16 v[36:39], a[44:47], v[164:167], v[36:39]
    s_add_u32 s20, s20, 4096
    buffer_load_dwordx4 a[24:27], v241, s[12:15], s20 offen offset:0
    v_mul_f32 v200, v200, v100
    v_mul_f32 v201, v201, v101
    v_mfma_f32_16x16x32_bf16 v[40:43], a[44:47], v[168:171], v[40:43]
    v_mul_f32 v202, v202, v102
    v_mul_f32 v203, v203, v103
    v_mfma_f32_16x16x32_bf16 v[44:47], a[44:47], v[172:175], v[44:47]
    buffer_load_dwordx4 a[28:31], v241, s[12:15], s20 offen offset:1024
    v_exp_f32 v200, -v200
    v_mfma_f32_16x16x32_bf16 v[48:51], a[44:47], v[176:179], v[48:51]
    s_waitcnt vmcnt(47) lgkmcnt(1)
    v_exp_f32 v201, -v201
    v_mfma_f32_16x16x32_bf16 v[4:7], a[48:51], v[148:151], v[4:7]
    buffer_load_dwordx4 a[32:35], v241, s[12:15], s20 offen offset:2048
    v_exp_f32 v202, -v202
    v_mfma_f32_16x16x32_bf16 v[8:11], a[48:51], v[152:155], v[8:11]
    ds_read_b128 v[164:167], v244 offset:28672
    v_exp_f32 v203, -v203
    v_mfma_f32_16x16x32_bf16 v[12:15], a[48:51], v[156:159], v[12:15]
    ds_read_b128 v[168:171], v244 offset:29696
    v_add_f32 v200, 1.0, v200
    v_mfma_f32_16x16x32_bf16 v[16:19], a[48:51], v[160:163], v[16:19]
    ds_read_b128 v[172:175], v244 offset:30720
    v_add_f32 v201, 1.0, v201
    v_add_f32 v202, 1.0, v202
    v_mfma_f32_16x16x32_bf16 v[20:23], a[52:55], v[148:151], v[20:23]
    buffer_load_dwordx4 a[36:39], v241, s[12:15], s20 offen offset:3072
    v_add_f32 v203, 1.0, v203
    v_rcp_f32 v200, v200
    v_mfma_f32_16x16x32_bf16 v[24:27], a[52:55], v[152:155], v[24:27]
    ds_read_b128 v[176:179], v244 offset:31744
    v_rcp_f32 v201, v201
    v_mfma_f32_16x16x32_bf16 v[28:31], a[52:55], v[156:159], v[28:31]
    v_mfma_f32_16x16x32_bf16 v[32:35], a[52:55], v[160:163], v[32:35]
    v_rcp_f32 v202, v202
    v_mfma_f32_16x16x32_bf16 v[36:39], a[56:59], v[148:151], v[36:39]
    s_add_u32 s20, s20, 4096
    buffer_load_dwordx4 a[40:43], v241, s[12:15], s20 offen offset:0
    v_rcp_f32 v203, v203
    v_mfma_f32_16x16x32_bf16 v[40:43], a[56:59], v[152:155], v[40:43]
    v_mul_f32 v200, v200, v100
    v_mul_f32 v201, v201, v101
    v_mfma_f32_16x16x32_bf16 v[44:47], a[56:59], v[156:159], v[44:47]
    v_mul_f32 v202, v202, v102
    v_mul_f32 v203, v203, v103
    v_mfma_f32_16x16x32_bf16 v[48:51], a[56:59], v[160:163], v[48:51]
    s_waitcnt vmcnt(47) lgkmcnt(0)
    v_cvt_pk_bf16_f32 v216, v200, v201
    v_cvt_pk_bf16_f32 v217, v202, v203
    v_mfma_f32_16x16x32_bf16 v[4:7], a[60:63], v[164:167], v[4:7]
    s_waitcnt lgkmcnt(0)
    s_barrier
    buffer_load_dwordx4 a[44:47], v241, s[12:15], s20 offen offset:1024
    v_fma_f32 v204, v116, v116, v240
    v_mfma_f32_16x16x32_bf16 v[8:11], a[60:63], v[168:171], v[8:11]
    ds_read_b128 v[148:151], v244 offset:32768
    v_fma_f32 v205, v117, v117, v240
    v_fma_f32 v206, v118, v118, v240
    v_mfma_f32_16x16x32_bf16 v[12:15], a[60:63], v[172:175], v[12:15]
    ds_read_b128 v[152:155], v244 offset:33792
    v_fma_f32 v207, v119, v119, v240
    v_mul_f32 v204, v204, v116
    v_mfma_f32_16x16x32_bf16 v[16:19], a[60:63], v[176:179], v[16:19]
    ds_read_b128 v[156:159], v244 offset:34816
    v_mul_f32 v205, v205, v117
    v_mul_f32 v206, v206, v118
    v_mfma_f32_16x16x32_bf16 v[20:23], a[64:67], v[164:167], v[20:23]
    buffer_load_dwordx4 a[48:51], v241, s[12:15], s20 offen offset:2048
    v_mul_f32 v207, v207, v119
    v_exp_f32 v204, -v204
    v_mfma_f32_16x16x32_bf16 v[24:27], a[64:67], v[168:171], v[24:27]
    ds_read_b128 v[160:163], v244 offset:35840
    v_exp_f32 v205, -v205
    v_mfma_f32_16x16x32_bf16 v[28:31], a[64:67], v[172:175], v[28:31]
    v_mfma_f32_16x16x32_bf16 v[32:35], a[64:67], v[176:179], v[32:35]
    v_exp_f32 v206, -v206
    v_mfma_f32_16x16x32_bf16 v[36:39], a[68:71], v[164:167], v[36:39]
    buffer_load_dwordx4 a[52:55], v241, s[12:15], s20 offen offset:3072
    v_exp_f32 v207, -v207
    v_mfma_f32_16x16x32_bf16 v[40:43], a[68:71], v[168:171], v[40:43]
    v_add_f32 v204, 1.0, v204
    v_add_f32 v205, 1.0, v205
    v_mfma_f32_16x16x32_bf16 v[44:47], a[68:71], v[172:175], v[44:47]
    v_add_f32 v206, 1.0, v206
    v_add_f32 v207, 1.0, v207
    v_mfma_f32_16x16x32_bf16 v[48:51], a[68:71], v[176:179], v[48:51]
    s_waitcnt vmcnt(47) lgkmcnt(0)
    v_rcp_f32 v204, v204
    v_mfma_f32_16x16x32_bf16 v[4:7], a[72:75], v[148:151], v[4:7]
    s_add_u32 s20, s20, 4096
    buffer_load_dwordx4 a[56:59], v241, s[12:15], s20 offen offset:0
    v_rcp_f32 v205, v205
    v_mfma_f32_16x16x32_bf16 v[8:11], a[72:75], v[152:155], v[8:11]
    ds_read_b128 v[164:167], v244 offset:36864
    v_rcp_f32 v206, v206
    v_mfma_f32_16x16x32_bf16 v[12:15], a[72:75], v[156:159], v[12:15]
    ds_read_b128 v[168:171], v244 offset:37888
    v_rcp_f32 v207, v207
    v_mfma_f32_16x16x32_bf16 v[16:19], a[72:75], v[160:163], v[16:19]
    ds_read_b128 v[172:175], v244 offset:38912
    v_mul_f32 v204, v204, v116
    v_mfma_f32_16x16x32_bf16 v[20:23], a[76:79], v[148:151], v[20:23]
    buffer_load_dwordx4 a[60:63], v241, s[12:15], s20 offen offset:1024
    v_mul_f32 v205, v205, v117
    v_mul_f32 v206, v206, v118
    v_mfma_f32_16x16x32_bf16 v[24:27], a[76:79], v[152:155], v[24:27]
    ds_read_b128 v[176:179], v244 offset:39936
    v_mul_f32 v207, v207, v119
    v_mfma_f32_16x16x32_bf16 v[28:31], a[76:79], v[156:159], v[28:31]
    v_cvt_pk_bf16_f32 v218, v204, v205
    v_cvt_pk_bf16_f32 v219, v206, v207
    v_mfma_f32_16x16x32_bf16 v[32:35], a[76:79], v[160:163], v[32:35]
    ds_write_b128 v246, v[216:219] offset:49152
    v_fma_f32 v200, v132, v132, v240
    v_mfma_f32_16x16x32_bf16 v[36:39], a[80:83], v[148:151], v[36:39]
    buffer_load_dwordx4 a[64:67], v241, s[12:15], s20 offen offset:2048
    v_fma_f32 v201, v133, v133, v240
    v_fma_f32 v202, v134, v134, v240
    v_mfma_f32_16x16x32_bf16 v[40:43], a[80:83], v[152:155], v[40:43]
    v_fma_f32 v203, v135, v135, v240
    v_mul_f32 v200, v200, v132
    v_mfma_f32_16x16x32_bf16 v[44:47], a[80:83], v[156:159], v[44:47]
    v_mul_f32 v201, v201, v133
    v_mul_f32 v202, v202, v134
    v_mfma_f32_16x16x32_bf16 v[48:51], a[80:83], v[160:163], v[48:51]
    s_waitcnt vmcnt(47) lgkmcnt(1)
    v_mul_f32 v203, v203, v135
    v_mfma_f32_16x16x32_bf16 v[4:7], a[84:87], v[164:167], v[4:7]
    buffer_load_dwordx4 a[68:71], v241, s[12:15], s20 offen offset:3072
    v_exp_f32 v200, -v200
    v_mfma_f32_16x16x32_bf16 v[8:11], a[84:87], v[168:171], v[8:11]
    ds_read_b128 v[148:151], v244 offset:40960
    v_exp_f32 v201, -v201
    v_mfma_f32_16x16x32_bf16 v[12:15], a[84:87], v[172:175], v[12:15]
    ds_read_b128 v[152:155], v244 offset:41984
    v_exp_f32 v202, -v202
    v_mfma_f32_16x16x32_bf16 v[16:19], a[84:87], v[176:179], v[16:19]
    ds_read_b128 v[156:159], v244 offset:43008
    v_exp_f32 v203, -v203
    v_mfma_f32_16x16x32_bf16 v[20:23], a[88:91], v[164:167], v[20:23]
    s_add_u32 s20, s20, -51200
    buffer_load_dwordx4 a[72:75], v241, s[12:15], s20 offen offset:0
    v_add_f32 v200, 1.0, v200
    v_add_f32 v201, 1.0, v201
    v_mfma_f32_16x16x32_bf16 v[24:27], a[88:91], v[168:171], v[24:27]
    ds_read_b128 v[160:163], v244 offset:44032
    v_add_f32 v202, 1.0, v202
    v_mfma_f32_16x16x32_bf16 v[28:31], a[88:91], v[172:175], v[28:31]
    v_add_f32 v203, 1.0, v203
    v_rcp_f32 v200, v200
    v_mfma_f32_16x16x32_bf16 v[32:35], a[88:91], v[176:179], v[32:35]
    v_rcp_f32 v201, v201
    v_mfma_f32_16x16x32_bf16 v[36:39], a[92:95], v[164:167], v[36:39]
    buffer_load_dwordx4 a[76:79], v241, s[12:15], s20 offen offset:1024
    v_rcp_f32 v202, v202
    v_mfma_f32_16x16x32_bf16 v[40:43], a[92:95], v[168:171], v[40:43]
    v_rcp_f32 v203, v203
    v_mfma_f32_16x16x32_bf16 v[44:47], a[92:95], v[172:175], v[44:47]
    v_mfma_f32_16x16x32_bf16 v[48:51], a[92:95], v[176:179], v[48:51]
    s_waitcnt vmcnt(47) lgkmcnt(0)
    v_mul_f32 v200, v200, v132
    v_mul_f32 v201, v201, v133
    v_mfma_f32_16x16x32_bf16 v[4:7], a[96:99], v[148:151], v[4:7]
    buffer_load_dwordx4 a[80:83], v241, s[12:15], s20 offen offset:2048
    v_mul_f32 v202, v202, v134
    v_mul_f32 v203, v203, v135
    v_mfma_f32_16x16x32_bf16 v[8:11], a[96:99], v[152:155], v[8:11]
    ds_read_b128 v[164:167], v244 offset:45056
    v_cvt_pk_bf16_f32 v220, v200, v201
    v_cvt_pk_bf16_f32 v221, v202, v203
    v_mfma_f32_16x16x32_bf16 v[12:15], a[96:99], v[156:159], v[12:15]
    ds_read_b128 v[168:171], v244 offset:46080
    v_mfma_f32_16x16x32_bf16 v[16:19], a[96:99], v[160:163], v[16:19]
    ds_read_b128 v[172:175], v244 offset:47104
    v_mfma_f32_16x16x32_bf16 v[20:23], a[100:103], v[148:151], v[20:23]
    buffer_load_dwordx4 a[84:87], v241, s[12:15], s20 offen offset:3072
    v_mfma_f32_16x16x32_bf16 v[24:27], a[100:103], v[152:155], v[24:27]
    ds_read_b128 v[176:179], v244 offset:48128
    v_mfma_f32_16x16x32_bf16 v[28:31], a[100:103], v[156:159], v[28:31]
    ds_write_b64 v247, v[220:221] offset:49152
    v_fma_f32 v204, v104, v104, v240
    v_fma_f32 v205, v105, v105, v240
    v_fma_f32 v206, v106, v106, v240
    v_fma_f32 v207, v107, v107, v240
    v_mul_f32 v204, v204, v104
    v_mul_f32 v205, v205, v105
    v_mul_f32 v206, v206, v106
    v_mul_f32 v207, v207, v107
    v_mfma_f32_16x16x32_bf16 v[32:35], a[100:103], v[160:163], v[32:35]
    v_exp_f32 v204, -v204
    v_mfma_f32_16x16x32_bf16 v[36:39], a[104:107], v[148:151], v[36:39]
    s_add_u32 s20, s20, 4096
    buffer_load_dwordx4 a[88:91], v241, s[12:15], s20 offen offset:0
    v_exp_f32 v205, -v205
    v_mfma_f32_16x16x32_bf16 v[40:43], a[104:107], v[152:155], v[40:43]
    v_exp_f32 v206, -v206
    v_mfma_f32_16x16x32_bf16 v[44:47], a[104:107], v[156:159], v[44:47]
    v_exp_f32 v207, -v207
    v_mfma_f32_16x16x32_bf16 v[48:51], a[104:107], v[160:163], v[48:51]
    s_waitcnt vmcnt(47) lgkmcnt(1)
    v_add_f32 v204, 1.0, v204
    v_mfma_f32_16x16x32_bf16 v[4:7], a[108:111], v[164:167], v[4:7]
    buffer_load_dwordx4 a[92:95], v241, s[12:15], s20 offen offset:1024
    v_add_f32 v205, 1.0, v205
    v_add_f32 v206, 1.0, v206
    v_mfma_f32_16x16x32_bf16 v[8:11], a[108:111], v[168:171], v[8:11]
    ds_read_b128 v[148:151], v244 offset:49152
    v_add_f32 v207, 1.0, v207
    v_rcp_f32 v204, v204
    v_mfma_f32_16x16x32_bf16 v[12:15], a[108:111], v[172:175], v[12:15]
    ds_read_b128 v[152:155], v244 offset:50176
    v_rcp_f32 v205, v205
    v_mfma_f32_16x16x32_bf16 v[16:19], a[108:111], v[176:179], v[16:19]
    ds_read_b128 v[156:159], v244 offset:51200
    v_mfma_f32_16x16x32_bf16 v[20:23], a[112:115], v[164:167], v[20:23]
    buffer_load_dwordx4 a[96:99], v241, s[12:15], s20 offen offset:2048
    v_rcp_f32 v206, v206
    v_mfma_f32_16x16x32_bf16 v[24:27], a[112:115], v[168:171], v[24:27]
    ds_read_b128 v[160:163], v244 offset:52224
    v_rcp_f32 v207, v207
    v_mfma_f32_16x16x32_bf16 v[28:31], a[112:115], v[172:175], v[28:31]
    v_mul_f32 v204, v204, v104
    v_mul_f32 v205, v205, v105
    v_mfma_f32_16x16x32_bf16 v[32:35], a[112:115], v[176:179], v[32:35]
    v_mul_f32 v206, v206, v106
    v_mul_f32 v207, v207, v107
    v_mfma_f32_16x16x32_bf16 v[36:39], a[116:119], v[164:167], v[36:39]
    buffer_load_dwordx4 a[100:103], v241, s[12:15], s20 offen offset:3072
    v_cvt_pk_bf16_f32 v224, v204, v205
    v_cvt_pk_bf16_f32 v225, v206, v207
    v_mfma_f32_16x16x32_bf16 v[40:43], a[116:119], v[168:171], v[40:43]
    v_fma_f32 v200, v120, v120, v240
    v_mfma_f32_16x16x32_bf16 v[44:47], a[116:119], v[172:175], v[44:47]
    s_add_u32 s20, s20, 4096
    buffer_load_dwordx4 a[104:107], v241, s[12:15], s20 offen offset:0
    v_fma_f32 v201, v121, v121, v240
    v_fma_f32 v202, v122, v122, v240
    v_mfma_f32_16x16x32_bf16 v[48:51], a[116:119], v[176:179], v[48:51]
    s_waitcnt vmcnt(48) lgkmcnt(0)
    v_fma_f32 v203, v123, v123, v240
    v_mul_f32 v200, v200, v120
    v_mfma_f32_16x16x32_bf16 v[4:7], a[120:123], v[148:151], v[4:7]
    buffer_load_dwordx4 a[108:111], v241, s[12:15], s20 offen offset:1024
    v_mul_f32 v201, v201, v121
    v_mul_f32 v202, v202, v122
    v_mfma_f32_16x16x32_bf16 v[8:11], a[120:123], v[152:155], v[8:11]
    ds_read_b128 v[164:167], v244 offset:53248
    v_mul_f32 v203, v203, v123
    v_exp_f32 v200, -v200
    v_mfma_f32_16x16x32_bf16 v[12:15], a[120:123], v[156:159], v[12:15]
    ds_read_b128 v[168:171], v244 offset:54272
    v_exp_f32 v201, -v201
    v_mfma_f32_16x16x32_bf16 v[16:19], a[120:123], v[160:163], v[16:19]
    ds_read_b128 v[172:175], v244 offset:55296
    v_mfma_f32_16x16x32_bf16 v[20:23], a[124:127], v[148:151], v[20:23]
    buffer_load_dwordx4 a[112:115], v241, s[12:15], s20 offen offset:2048
    v_exp_f32 v202, -v202
    v_mfma_f32_16x16x32_bf16 v[24:27], a[124:127], v[152:155], v[24:27]
    ds_read_b128 v[176:179], v244 offset:56320
    v_exp_f32 v203, -v203
    v_mfma_f32_16x16x32_bf16 v[28:31], a[124:127], v[156:159], v[28:31]
    v_add_f32 v200, 1.0, v200
    v_add_f32 v201, 1.0, v201
    v_mfma_f32_16x16x32_bf16 v[32:35], a[124:127], v[160:163], v[32:35]
    v_add_f32 v202, 1.0, v202
    v_add_f32 v203, 1.0, v203
    v_mfma_f32_16x16x32_bf16 v[36:39], a[128:131], v[148:151], v[36:39]
    buffer_load_dwordx4 a[116:119], v241, s[12:15], s20 offen offset:3072
    v_rcp_f32 v200, v200
    v_mfma_f32_16x16x32_bf16 v[40:43], a[128:131], v[152:155], v[40:43]
    v_rcp_f32 v201, v201
    v_mfma_f32_16x16x32_bf16 v[44:47], a[128:131], v[156:159], v[44:47]
    v_rcp_f32 v202, v202
    v_mfma_f32_16x16x32_bf16 v[48:51], a[128:131], v[160:163], v[48:51]
    s_waitcnt vmcnt(48) lgkmcnt(0)
    v_rcp_f32 v203, v203
    v_mfma_f32_16x16x32_bf16 v[4:7], a[132:135], v[164:167], v[4:7]
    s_add_u32 s20, s20, 4096
    buffer_load_dwordx4 a[120:123], v241, s[12:15], s20 offen offset:0
    v_mul_f32 v200, v200, v120
    v_mfma_f32_16x16x32_bf16 v[8:11], a[132:135], v[168:171], v[8:11]
    ds_read_b128 v[148:151], v244 offset:8192
    v_mul_f32 v201, v201, v121
    v_mul_f32 v202, v202, v122
    v_mfma_f32_16x16x32_bf16 v[12:15], a[132:135], v[172:175], v[12:15]
    ds_read_b128 v[152:155], v244 offset:9216
    v_mul_f32 v203, v203, v123
    v_mfma_f32_16x16x32_bf16 v[16:19], a[132:135], v[176:179], v[16:19]
    ds_read_b128 v[156:159], v244 offset:10240
    v_cvt_pk_bf16_f32 v226, v200, v201
    v_cvt_pk_bf16_f32 v227, v202, v203
    v_mfma_f32_16x16x32_bf16 v[20:23], a[136:139], v[164:167], v[20:23]
    buffer_load_dwordx4 a[124:127], v241, s[12:15], s20 offen offset:1024
    v_mfma_f32_16x16x32_bf16 v[24:27], a[136:139], v[168:171], v[24:27]
    ds_read_b128 v[160:163], v244 offset:11264
    v_mfma_f32_16x16x32_bf16 v[28:31], a[136:139], v[172:175], v[28:31]
    ds_write_b128 v246, v[224:227] offset:50176
    v_fma_f32 v204, v136, v136, v240
    v_fma_f32 v205, v137, v137, v240
    v_fma_f32 v206, v138, v138, v240
    v_fma_f32 v207, v139, v139, v240
    v_mul_f32 v204, v204, v136
    v_mfma_f32_16x16x32_bf16 v[32:35], a[136:139], v[176:179], v[32:35]
    v_mul_f32 v205, v205, v137
    v_mul_f32 v206, v206, v138
    v_mfma_f32_16x16x32_bf16 v[36:39], a[140:143], v[164:167], v[36:39]
    buffer_load_dwordx4 a[128:131], v241, s[12:15], s20 offen offset:2048
    v_mul_f32 v207, v207, v139
    v_mfma_f32_16x16x32_bf16 v[40:43], a[140:143], v[168:171], v[40:43]
    v_exp_f32 v204, -v204
    v_mfma_f32_16x16x32_bf16 v[44:47], a[140:143], v[172:175], v[44:47]
    v_exp_f32 v205, -v205
    v_mfma_f32_16x16x32_bf16 v[48:51], a[140:143], v[176:179], v[48:51]
    s_waitcnt vmcnt(48) lgkmcnt(1)
    v_exp_f32 v206, -v206
    v_mfma_f32_16x16x32_bf16 v[52:55], a[144:147], v[148:151], 0
    buffer_load_dwordx4 a[132:135], v241, s[12:15], s20 offen offset:3072
    v_exp_f32 v207, -v207
    v_mfma_f32_16x16x32_bf16 v[56:59], a[144:147], v[152:155], 0
    ds_read_b128 v[164:167], v244 offset:12288
    v_add_f32 v204, 1.0, v204
    v_mfma_f32_16x16x32_bf16 v[60:63], a[144:147], v[156:159], 0
    ds_read_b128 v[168:171], v244 offset:13312
    v_add_f32 v205, 1.0, v205
    v_add_f32 v206, 1.0, v206
    v_mfma_f32_16x16x32_bf16 v[64:67], a[144:147], v[160:163], 0
    ds_read_b128 v[172:175], v244 offset:14336
    v_add_f32 v207, 1.0, v207
    v_rcp_f32 v204, v204
    v_mfma_f32_16x16x32_bf16 v[68:71], a[148:151], v[148:151], 0
    s_add_u32 s20, s20, 4096
    buffer_load_dwordx4 a[136:139], v241, s[12:15], s20 offen offset:0
    v_rcp_f32 v205, v205
    v_mfma_f32_16x16x32_bf16 v[72:75], a[148:151], v[152:155], 0
    ds_read_b128 v[176:179], v244 offset:15360
    v_rcp_f32 v206, v206
    v_mfma_f32_16x16x32_bf16 v[76:79], a[148:151], v[156:159], 0
    v_rcp_f32 v207, v207
    v_mfma_f32_16x16x32_bf16 v[80:83], a[148:151], v[160:163], 0
    v_mfma_f32_16x16x32_bf16 v[84:87], a[152:155], v[148:151], 0
    buffer_load_dwordx4 a[140:143], v241, s[12:15], s20 offen offset:1024
    v_mul_f32 v204, v204, v136
    v_mul_f32 v205, v205, v137
    v_mfma_f32_16x16x32_bf16 v[88:91], a[152:155], v[152:155], 0
    v_mul_f32 v206, v206, v138
    v_mul_f32 v207, v207, v139
    v_mfma_f32_16x16x32_bf16 v[92:95], a[152:155], v[156:159], 0
    v_cvt_pk_bf16_f32 v228, v204, v205
    v_cvt_pk_bf16_f32 v229, v206, v207
    v_mfma_f32_16x16x32_bf16 v[96:99], a[152:155], v[160:163], 0
    s_waitcnt vmcnt(48) lgkmcnt(0)
    ds_write_b64 v247, v[228:229] offset:50176
    v_fma_f32 v200, v108, v108, v240
    v_mfma_f32_16x16x32_bf16 v[52:55], a[156:159], v[164:167], v[52:55]
    s_add_u32 s20, s20, 38912
    buffer_load_dwordx4 a[144:147], v241, s[12:15], s20 offen offset:0
    v_fma_f32 v201, v109, v109, v240
    v_fma_f32 v202, v110, v110, v240
    v_mfma_f32_16x16x32_bf16 v[56:59], a[156:159], v[168:171], v[56:59]
    ds_read_b128 v[148:151], v244 offset:16384
    v_fma_f32 v203, v111, v111, v240
    v_mfma_f32_16x16x32_bf16 v[60:63], a[156:159], v[172:175], v[60:63]
    ds_read_b128 v[152:155], v244 offset:17408
    v_mul_f32 v200, v200, v108
    v_mul_f32 v201, v201, v109
    v_mfma_f32_16x16x32_bf16 v[64:67], a[156:159], v[176:179], v[64:67]
    ds_read_b128 v[156:159], v244 offset:18432
    v_mul_f32 v202, v202, v110
    v_mul_f32 v203, v203, v111
    v_mfma_f32_16x16x32_bf16 v[68:71], a[160:163], v[164:167], v[68:71]
    buffer_load_dwordx4 a[148:151], v241, s[12:15], s20 offen offset:1024
    v_exp_f32 v200, -v200
    v_mfma_f32_16x16x32_bf16 v[72:75], a[160:163], v[168:171], v[72:75]
    ds_read_b128 v[160:163], v244 offset:19456
    v_exp_f32 v201, -v201
    v_mfma_f32_16x16x32_bf16 v[76:79], a[160:163], v[172:175], v[76:79]
    v_exp_f32 v202, -v202
    v_mfma_f32_16x16x32_bf16 v[80:83], a[160:163], v[176:179], v[80:83]
    v_exp_f32 v203, -v203
    v_mfma_f32_16x16x32_bf16 v[84:87], a[164:167], v[164:167], v[84:87]
    buffer_load_dwordx4 a[152:155], v241, s[12:15], s20 offen offset:2048
    v_add_f32 v200, 1.0, v200
    v_mfma_f32_16x16x32_bf16 v[88:91], a[164:167], v[168:171], v[88:91]
    v_add_f32 v201, 1.0, v201
    v_add_f32 v202, 1.0, v202
    v_mfma_f32_16x16x32_bf16 v[92:95], a[164:167], v[172:175], v[92:95]
    v_add_f32 v203, 1.0, v203
    v_rcp_f32 v200, v200
    v_mfma_f32_16x16x32_bf16 v[96:99], a[164:167], v[176:179], v[96:99]
    s_waitcnt vmcnt(48) lgkmcnt(0)
    v_rcp_f32 v201, v201
    v_mfma_f32_16x16x32_bf16 v[52:55], a[168:171], v[148:151], v[52:55]
    buffer_load_dwordx4 a[156:159], v241, s[12:15], s20 offen offset:3072
    v_mfma_f32_16x16x32_bf16 v[56:59], a[168:171], v[152:155], v[56:59]
    ds_read_b128 v[164:167], v244 offset:20480
    v_rcp_f32 v202, v202
    v_mfma_f32_16x16x32_bf16 v[60:63], a[168:171], v[156:159], v[60:63]
    ds_read_b128 v[168:171], v244 offset:21504
    v_rcp_f32 v203, v203
    v_mfma_f32_16x16x32_bf16 v[64:67], a[168:171], v[160:163], v[64:67]
    ds_read_b128 v[172:175], v244 offset:22528
    v_mul_f32 v200, v200, v108
    v_mul_f32 v201, v201, v109
    v_mfma_f32_16x16x32_bf16 v[68:71], a[172:175], v[148:151], v[68:71]
    s_add_u32 s20, s20, 4096
    buffer_load_dwordx4 a[160:163], v241, s[12:15], s20 offen offset:0
    v_mul_f32 v202, v202, v110
    v_mul_f32 v203, v203, v111
    v_mfma_f32_16x16x32_bf16 v[72:75], a[172:175], v[152:155], v[72:75]
    ds_read_b128 v[176:179], v244 offset:23552
    v_cvt_pk_bf16_f32 v216, v200, v201
    v_cvt_pk_bf16_f32 v217, v202, v203
    v_mfma_f32_16x16x32_bf16 v[76:79], a[172:175], v[156:159], v[76:79]
    v_fma_f32 v204, v124, v124, v240
    v_mfma_f32_16x16x32_bf16 v[80:83], a[172:175], v[160:163], v[80:83]
    v_fma_f32 v205, v125, v125, v240
    v_fma_f32 v206, v126, v126, v240
    v_mfma_f32_16x16x32_bf16 v[84:87], a[176:179], v[148:151], v[84:87]
    buffer_load_dwordx4 a[164:167], v241, s[12:15], s20 offen offset:1024
    v_fma_f32 v207, v127, v127, v240
    v_mul_f32 v204, v204, v124
    v_mfma_f32_16x16x32_bf16 v[88:91], a[176:179], v[152:155], v[88:91]
    v_mul_f32 v205, v205, v125
    v_mul_f32 v206, v206, v126
    v_mfma_f32_16x16x32_bf16 v[92:95], a[176:179], v[156:159], v[92:95]
    v_mul_f32 v207, v207, v127
    v_exp_f32 v204, -v204
    v_mfma_f32_16x16x32_bf16 v[96:99], a[176:179], v[160:163], v[96:99]
    s_waitcnt vmcnt(48) lgkmcnt(0)
    v_exp_f32 v205, -v205
    v_mfma_f32_16x16x32_bf16 v[52:55], a[180:183], v[164:167], v[52:55]
    buffer_load_dwordx4 a[168:171], v241, s[12:15], s20 offen offset:2048
    v_mfma_f32_16x16x32_bf16 v[56:59], a[180:183], v[168:171], v[56:59]
    ds_read_b128 v[148:151], v244 offset:24576
    v_exp_f32 v206, -v206
    v_mfma_f32_16x16x32_bf16 v[60:63], a[180:183], v[172:175], v[60:63]
    ds_read_b128 v[152:155], v244 offset:25600
    v_exp_f32 v207, -v207
    v_mfma_f32_16x16x32_bf16 v[64:67], a[180:183], v[176:179], v[64:67]
    ds_read_b128 v[156:159], v244 offset:26624
    v_add_f32 v204, 1.0, v204
    v_add_f32 v205, 1.0, v205
    v_mfma_f32_16x16x32_bf16 v[68:71], a[184:187], v[164:167], v[68:71]
    buffer_load_dwordx4 a[172:175], v241, s[12:15], s20 offen offset:3072
    v_add_f32 v206, 1.0, v206
    v_add_f32 v207, 1.0, v207
    v_mfma_f32_16x16x32_bf16 v[72:75], a[184:187], v[168:171], v[72:75]
    ds_read_b128 v[160:163], v244 offset:27648
    v_rcp_f32 v204, v204
    v_mfma_f32_16x16x32_bf16 v[76:79], a[184:187], v[172:175], v[76:79]
    v_rcp_f32 v205, v205
    v_mfma_f32_16x16x32_bf16 v[80:83], a[184:187], v[176:179], v[80:83]
    v_rcp_f32 v206, v206
    v_mfma_f32_16x16x32_bf16 v[84:87], a[188:191], v[164:167], v[84:87]
    s_add_u32 s20, s20, 4096
    buffer_load_dwordx4 a[176:179], v241, s[12:15], s20 offen offset:0
    v_rcp_f32 v207, v207
    v_mfma_f32_16x16x32_bf16 v[88:91], a[188:191], v[168:171], v[88:91]
    v_mul_f32 v204, v204, v124
    v_mfma_f32_16x16x32_bf16 v[92:95], a[188:191], v[172:175], v[92:95]
    buffer_load_dwordx4 a[180:183], v241, s[12:15], s20 offen offset:1024
    v_mul_f32 v205, v205, v125
    v_mul_f32 v206, v206, v126
    v_mfma_f32_16x16x32_bf16 v[96:99], a[188:191], v[176:179], v[96:99]
    s_waitcnt vmcnt(49) lgkmcnt(0)
    v_mul_f32 v207, v207, v127
    v_mfma_f32_16x16x32_bf16 v[52:55], a[192:195], v[148:151], v[52:55]
    buffer_load_dwordx4 a[184:187], v241, s[12:15], s20 offen offset:2048
    v_cvt_pk_bf16_f32 v218, v204, v205
    v_cvt_pk_bf16_f32 v219, v206, v207
    v_mfma_f32_16x16x32_bf16 v[56:59], a[192:195], v[152:155], v[56:59]
    ds_read_b128 v[164:167], v244 offset:28672
    v_mfma_f32_16x16x32_bf16 v[60:63], a[192:195], v[156:159], v[60:63]
    ds_read_b128 v[168:171], v244 offset:29696
    v_mfma_f32_16x16x32_bf16 v[64:67], a[192:195], v[160:163], v[64:67]
    ds_read_b128 v[172:175], v244 offset:30720
    v_mfma_f32_16x16x32_bf16 v[68:71], a[196:199], v[148:151], v[68:71]
    buffer_load_dwordx4 a[188:191], v241, s[12:15], s20 offen offset:3072
    v_mfma_f32_16x16x32_bf16 v[72:75], a[196:199], v[152:155], v[72:75]
    ds_read_b128 v[176:179], v244 offset:31744
    v_mfma_f32_16x16x32_bf16 v[76:79], a[196:199], v[156:159], v[76:79]
    ds_write_b128 v246, v[216:219] offset:51200
    v_fma_f32 v200, v140, v140, v240
    v_fma_f32 v201, v141, v141, v240
    v_fma_f32 v202, v142, v142, v240
    v_fma_f32 v203, v143, v143, v240
    v_mul_f32 v200, v200, v140
    v_mul_f32 v201, v201, v141
    v_mul_f32 v202, v202, v142
    v_mul_f32 v203, v203, v143
    v_exp_f32 v200, -v200
    v_mfma_f32_16x16x32_bf16 v[80:83], a[196:199], v[160:163], v[80:83]
    v_exp_f32 v201, -v201
    v_mfma_f32_16x16x32_bf16 v[84:87], a[200:203], v[148:151], v[84:87]
    s_add_u32 s20, s20, 4096
    buffer_load_dwordx4 a[192:195], v241, s[12:15], s20 offen offset:0
    v_exp_f32 v202, -v202
    v_mfma_f32_16x16x32_bf16 v[88:91], a[200:203], v[152:155], v[88:91]
    v_exp_f32 v203, -v203
    v_mfma_f32_16x16x32_bf16 v[92:95], a[200:203], v[156:159], v[92:95]
    v_add_f32 v200, 1.0, v200
    v_mfma_f32_16x16x32_bf16 v[96:99], a[200:203], v[160:163], v[96:99]
    s_waitcnt vmcnt(49) lgkmcnt(1)
    v_add_f32 v201, 1.0, v201
    v_add_f32 v202, 1.0, v202
    v_mfma_f32_16x16x32_bf16 v[52:55], a[204:207], v[164:167], v[52:55]
    buffer_load_dwordx4 a[196:199], v241, s[12:15], s20 offen offset:1024
    v_add_f32 v203, 1.0, v203
    v_rcp_f32 v200, v200
    v_mfma_f32_16x16x32_bf16 v[56:59], a[204:207], v[168:171], v[56:59]
    ds_read_b128 v[148:151], v244 offset:32768
    v_rcp_f32 v201, v201
    v_mfma_f32_16x16x32_bf16 v[60:63], a[204:207], v[172:175], v[60:63]
    ds_read_b128 v[152:155], v244 offset:33792
    v_rcp_f32 v202, v202
    v_mfma_f32_16x16x32_bf16 v[64:67], a[204:207], v[176:179], v[64:67]
    ds_read_b128 v[156:159], v244 offset:34816
    v_rcp_f32 v203, v203
    v_mfma_f32_16x16x32_bf16 v[68:71], a[208:211], v[164:167], v[68:71]
    buffer_load_dwordx4 a[200:203], v241, s[12:15], s20 offen offset:2048
    v_mfma_f32_16x16x32_bf16 v[72:75], a[208:211], v[168:171], v[72:75]
    ds_read_b128 v[160:163], v244 offset:35840
    v_mul_f32 v200, v200, v140
    v_mul_f32 v201, v201, v141
    v_mfma_f32_16x16x32_bf16 v[76:79], a[208:211], v[172:175], v[76:79]
    v_mul_f32 v202, v202, v142
    v_mul_f32 v203, v203, v143
    v_mfma_f32_16x16x32_bf16 v[80:83], a[208:211], v[176:179], v[80:83]
    v_cvt_pk_bf16_f32 v220, v200, v201
    v_cvt_pk_bf16_f32 v221, v202, v203
    v_mfma_f32_16x16x32_bf16 v[84:87], a[212:215], v[164:167], v[84:87]
    buffer_load_dwordx4 a[204:207], v241, s[12:15], s20 offen offset:3072
    v_mfma_f32_16x16x32_bf16 v[88:91], a[212:215], v[168:171], v[88:91]
    ds_write_b64 v247, v[220:221] offset:51200
    v_fma_f32 v204, v112, v112, v240
    v_fma_f32 v205, v113, v113, v240
    v_fma_f32 v206, v114, v114, v240
    v_mfma_f32_16x16x32_bf16 v[92:95], a[212:215], v[172:175], v[92:95]
    v_fma_f32 v207, v115, v115, v240
    v_mfma_f32_16x16x32_bf16 v[96:99], a[212:215], v[176:179], v[96:99]
    s_waitcnt vmcnt(49) lgkmcnt(1)
    v_mul_f32 v204, v204, v112
    v_mul_f32 v205, v205, v113
    v_mfma_f32_16x16x32_bf16 v[52:55], a[0:3], v[148:151], v[52:55]
    s_add_u32 s20, s20, 4096
    buffer_load_dwordx4 a[208:211], v241, s[12:15], s20 offen offset:0
    v_mul_f32 v206, v206, v114
    v_mul_f32 v207, v207, v115
    v_mfma_f32_16x16x32_bf16 v[56:59], a[0:3], v[152:155], v[56:59]
    ds_read_b128 v[164:167], v244 offset:36864
    v_exp_f32 v204, -v204
    v_mfma_f32_16x16x32_bf16 v[60:63], a[0:3], v[156:159], v[60:63]
    ds_read_b128 v[168:171], v244 offset:37888
    v_exp_f32 v205, -v205
    v_mfma_f32_16x16x32_bf16 v[64:67], a[0:3], v[160:163], v[64:67]
    ds_read_b128 v[172:175], v244 offset:38912
    v_exp_f32 v206, -v206
    v_mfma_f32_16x16x32_bf16 v[68:71], a[4:7], v[148:151], v[68:71]
    buffer_load_dwordx4 a[212:215], v241, s[12:15], s20 offen offset:1024
    v_exp_f32 v207, -v207
    v_mfma_f32_16x16x32_bf16 v[72:75], a[4:7], v[152:155], v[72:75]
    ds_read_b128 v[176:179], v244 offset:39936
    v_add_f32 v204, 1.0, v204
    v_mfma_f32_16x16x32_bf16 v[76:79], a[4:7], v[156:159], v[76:79]
    v_add_f32 v205, 1.0, v205
    v_add_f32 v206, 1.0, v206
    v_mfma_f32_16x16x32_bf16 v[80:83], a[4:7], v[160:163], v[80:83]
    v_add_f32 v207, 1.0, v207
    v_rcp_f32 v204, v204
    v_mfma_f32_16x16x32_bf16 v[84:87], a[8:11], v[148:151], v[84:87]
    buffer_load_dwordx4 a[0:3], v241, s[12:15], s20 offen offset:2048
    v_rcp_f32 v205, v205
    v_mfma_f32_16x16x32_bf16 v[88:91], a[8:11], v[152:155], v[88:91]
    v_mfma_f32_16x16x32_bf16 v[92:95], a[8:11], v[156:159], v[92:95]
    v_rcp_f32 v206, v206
    v_mfma_f32_16x16x32_bf16 v[96:99], a[8:11], v[160:163], v[96:99]
    s_waitcnt vmcnt(49) lgkmcnt(0)
    v_rcp_f32 v207, v207
    v_mfma_f32_16x16x32_bf16 v[52:55], a[12:15], v[164:167], v[52:55]
    buffer_load_dwordx4 a[4:7], v241, s[12:15], s20 offen offset:3072
    v_mul_f32 v204, v204, v112
    v_mul_f32 v205, v205, v113
    v_mfma_f32_16x16x32_bf16 v[56:59], a[12:15], v[168:171], v[56:59]
    ds_read_b128 v[148:151], v244 offset:40960
    v_mul_f32 v206, v206, v114
    v_mul_f32 v207, v207, v115
    v_mfma_f32_16x16x32_bf16 v[60:63], a[12:15], v[172:175], v[60:63]
    ds_read_b128 v[152:155], v244 offset:41984
    v_cvt_pk_bf16_f32 v224, v204, v205
    v_cvt_pk_bf16_f32 v225, v206, v207
    v_mfma_f32_16x16x32_bf16 v[64:67], a[12:15], v[176:179], v[64:67]
    ds_read_b128 v[156:159], v244 offset:43008
    v_fma_f32 v200, v128, v128, v240
    v_mfma_f32_16x16x32_bf16 v[68:71], a[16:19], v[164:167], v[68:71]
    s_add_u32 s20, s20, 4096
    buffer_load_dwordx4 a[8:11], v241, s[12:15], s20 offen offset:0
    v_fma_f32 v201, v129, v129, v240
    v_fma_f32 v202, v130, v130, v240
    v_mfma_f32_16x16x32_bf16 v[72:75], a[16:19], v[168:171], v[72:75]
    ds_read_b128 v[160:163], v244 offset:44032
    v_fma_f32 v203, v131, v131, v240
    v_mul_f32 v200, v200, v128
    v_mfma_f32_16x16x32_bf16 v[76:79], a[16:19], v[172:175], v[76:79]
    v_mul_f32 v201, v201, v129
    v_mul_f32 v202, v202, v130
    v_mfma_f32_16x16x32_bf16 v[80:83], a[16:19], v[176:179], v[80:83]
    v_mul_f32 v203, v203, v131
    v_exp_f32 v200, -v200
    v_mfma_f32_16x16x32_bf16 v[84:87], a[20:23], v[164:167], v[84:87]
    buffer_load_dwordx4 a[12:15], v241, s[12:15], s20 offen offset:1024
    v_mfma_f32_16x16x32_bf16 v[88:91], a[20:23], v[168:171], v[88:91]
    v_exp_f32 v201, -v201
    v_mfma_f32_16x16x32_bf16 v[92:95], a[20:23], v[172:175], v[92:95]
    v_exp_f32 v202, -v202
    v_mfma_f32_16x16x32_bf16 v[96:99], a[20:23], v[176:179], v[96:99]
    s_waitcnt vmcnt(49) lgkmcnt(0)
    v_exp_f32 v203, -v203
    v_mfma_f32_16x16x32_bf16 v[52:55], a[24:27], v[148:151], v[52:55]
    buffer_load_dwordx4 a[16:19], v241, s[12:15], s20 offen offset:2048
    v_add_f32 v200, 1.0, v200
    v_add_f32 v201, 1.0, v201
    v_mfma_f32_16x16x32_bf16 v[56:59], a[24:27], v[152:155], v[56:59]
    ds_read_b128 v[164:167], v244 offset:45056
    v_add_f32 v202, 1.0, v202
    v_add_f32 v203, 1.0, v203
    v_mfma_f32_16x16x32_bf16 v[60:63], a[24:27], v[156:159], v[60:63]
    ds_read_b128 v[168:171], v244 offset:46080
    v_rcp_f32 v200, v200
    v_mfma_f32_16x16x32_bf16 v[64:67], a[24:27], v[160:163], v[64:67]
    ds_read_b128 v[172:175], v244 offset:47104
    v_rcp_f32 v201, v201
    v_mfma_f32_16x16x32_bf16 v[68:71], a[28:31], v[148:151], v[68:71]
    buffer_load_dwordx4 a[20:23], v241, s[12:15], s20 offen offset:3072
    v_rcp_f32 v202, v202
    v_mfma_f32_16x16x32_bf16 v[72:75], a[28:31], v[152:155], v[72:75]
    ds_read_b128 v[176:179], v244 offset:48128
    v_rcp_f32 v203, v203
    v_mfma_f32_16x16x32_bf16 v[76:79], a[28:31], v[156:159], v[76:79]
    v_mul_f32 v200, v200, v128
    v_mfma_f32_16x16x32_bf16 v[80:83], a[28:31], v[160:163], v[80:83]
    v_mul_f32 v201, v201, v129
    v_mul_f32 v202, v202, v130
    v_mfma_f32_16x16x32_bf16 v[84:87], a[32:35], v[148:151], v[84:87]
    s_add_u32 s20, s20, 4096
    buffer_load_dwordx4 a[24:27], v241, s[12:15], s20 offen offset:0
    v_mul_f32 v203, v203, v131
    v_mfma_f32_16x16x32_bf16 v[88:91], a[32:35], v[152:155], v[88:91]
    v_cvt_pk_bf16_f32 v226, v200, v201
    v_cvt_pk_bf16_f32 v227, v202, v203
    v_mfma_f32_16x16x32_bf16 v[92:95], a[32:35], v[156:159], v[92:95]
    ds_write_b128 v246, v[224:227] offset:52224
    v_fma_f32 v204, v144, v144, v240
    v_mfma_f32_16x16x32_bf16 v[96:99], a[32:35], v[160:163], v[96:99]
    s_waitcnt vmcnt(49) lgkmcnt(1)
    v_fma_f32 v205, v145, v145, v240
    v_fma_f32 v206, v146, v146, v240
    v_mfma_f32_16x16x32_bf16 v[52:55], a[36:39], v[164:167], v[52:55]
    buffer_load_dwordx4 a[28:31], v241, s[12:15], s20 offen offset:1024
    v_fma_f32 v207, v147, v147, v240
    v_mul_f32 v204, v204, v144
    v_mfma_f32_16x16x32_bf16 v[56:59], a[36:39], v[168:171], v[56:59]
    ds_read_b128 v[148:151], v244 offset:49152
    v_mul_f32 v205, v205, v145
    v_mfma_f32_16x16x32_bf16 v[60:63], a[36:39], v[172:175], v[60:63]
    ds_read_b128 v[152:155], v244 offset:50176
    v_mul_f32 v206, v206, v146
    v_mul_f32 v207, v207, v147
    v_mfma_f32_16x16x32_bf16 v[64:67], a[36:39], v[176:179], v[64:67]
    ds_read_b128 v[156:159], v244 offset:51200
    v_exp_f32 v204, -v204
    v_mfma_f32_16x16x32_bf16 v[68:71], a[40:43], v[164:167], v[68:71]
    buffer_load_dwordx4 a[32:35], v241, s[12:15], s20 offen offset:2048
    v_exp_f32 v205, -v205
    v_mfma_f32_16x16x32_bf16 v[72:75], a[40:43], v[168:171], v[72:75]
    ds_read_b128 v[160:163], v244 offset:52224
    v_exp_f32 v206, -v206
    v_mfma_f32_16x16x32_bf16 v[76:79], a[40:43], v[172:175], v[76:79]
    v_exp_f32 v207, -v207
    v_mfma_f32_16x16x32_bf16 v[80:83], a[40:43], v[176:179], v[80:83]
    v_add_f32 v204, 1.0, v204
    v_mfma_f32_16x16x32_bf16 v[84:87], a[44:47], v[164:167], v[84:87]
    buffer_load_dwordx4 a[36:39], v241, s[12:15], s20 offen offset:3072
    v_add_f32 v205, 1.0, v205
    v_add_f32 v206, 1.0, v206
    v_mfma_f32_16x16x32_bf16 v[88:91], a[44:47], v[168:171], v[88:91]
    v_add_f32 v207, 1.0, v207
    v_rcp_f32 v204, v204
    v_mfma_f32_16x16x32_bf16 v[92:95], a[44:47], v[172:175], v[92:95]
    s_add_u32 s20, s20, 4096
    buffer_load_dwordx4 a[40:43], v241, s[12:15], s20 offen offset:0
    v_rcp_f32 v205, v205
    v_mfma_f32_16x16x32_bf16 v[96:99], a[44:47], v[176:179], v[96:99]
    s_waitcnt vmcnt(50) lgkmcnt(0)
    v_rcp_f32 v206, v206
    v_mfma_f32_16x16x32_bf16 v[52:55], a[48:51], v[148:151], v[52:55]
    buffer_load_dwordx4 a[44:47], v241, s[12:15], s20 offen offset:1024
    v_rcp_f32 v207, v207
    v_mfma_f32_16x16x32_bf16 v[56:59], a[48:51], v[152:155], v[56:59]
    ds_read_b128 v[164:167], v244 offset:53248
    v_mfma_f32_16x16x32_bf16 v[60:63], a[48:51], v[156:159], v[60:63]
    ds_read_b128 v[168:171], v244 offset:54272
    v_mul_f32 v204, v204, v144
    v_mul_f32 v205, v205, v145
    v_mfma_f32_16x16x32_bf16 v[64:67], a[48:51], v[160:163], v[64:67]
    ds_read_b128 v[172:175], v244 offset:55296
    v_mul_f32 v206, v206, v146
    v_mul_f32 v207, v207, v147
    v_mfma_f32_16x16x32_bf16 v[68:71], a[52:55], v[148:151], v[68:71]
    buffer_load_dwordx4 a[48:51], v241, s[12:15], s20 offen offset:2048
    v_cvt_pk_bf16_f32 v228, v204, v205
    v_cvt_pk_bf16_f32 v229, v206, v207
    v_mfma_f32_16x16x32_bf16 v[72:75], a[52:55], v[152:155], v[72:75]
    ds_read_b128 v[176:179], v244 offset:56320
    v_mfma_f32_16x16x32_bf16 v[76:79], a[52:55], v[156:159], v[76:79]
    ds_write_b64 v247, v[228:229] offset:52224
    v_mfma_f32_16x16x32_bf16 v[80:83], a[52:55], v[160:163], v[80:83]
    v_mfma_f32_16x16x32_bf16 v[84:87], a[56:59], v[148:151], v[84:87]
    buffer_load_dwordx4 a[52:55], v241, s[12:15], s20 offen offset:3072
    v_mfma_f32_16x16x32_bf16 v[88:91], a[56:59], v[152:155], v[88:91]
    v_mfma_f32_16x16x32_bf16 v[92:95], a[56:59], v[156:159], v[92:95]
    v_mfma_f32_16x16x32_bf16 v[96:99], a[56:59], v[160:163], v[96:99]
    s_waitcnt vmcnt(50) lgkmcnt(1)
    v_mfma_f32_16x16x32_bf16 v[52:55], a[60:63], v[164:167], v[52:55]
    s_waitcnt lgkmcnt(0)
    s_barrier
    s_add_u32 s20, s20, 4096
    buffer_load_dwordx4 a[56:59], v241, s[12:15], s20 offen offset:0
    v_mfma_f32_16x16x32_bf16 v[56:59], a[60:63], v[168:171], v[56:59]
    ds_read_b128 v[148:151], v244 offset:57344
    v_mfma_f32_16x16x32_bf16 v[60:63], a[60:63], v[172:175], v[60:63]
    ds_read_b128 v[152:155], v244 offset:58368
    v_mfma_f32_16x16x32_bf16 v[64:67], a[60:63], v[176:179], v[64:67]
    ds_read_b128 v[156:159], v244 offset:59392
    v_mfma_f32_16x16x32_bf16 v[68:71], a[64:67], v[164:167], v[68:71]
    buffer_load_dwordx4 a[60:63], v241, s[12:15], s20 offen offset:1024
    v_mfma_f32_16x16x32_bf16 v[72:75], a[64:67], v[168:171], v[72:75]
    ds_read_b128 v[160:163], v244 offset:60416
    v_mfma_f32_16x16x32_bf16 v[76:79], a[64:67], v[172:175], v[76:79]
    v_mfma_f32_16x16x32_bf16 v[80:83], a[64:67], v[176:179], v[80:83]
    v_mfma_f32_16x16x32_bf16 v[84:87], a[68:71], v[164:167], v[84:87]
    buffer_load_dwordx4 a[64:67], v241, s[12:15], s20 offen offset:2048
    v_mfma_f32_16x16x32_bf16 v[88:91], a[68:71], v[168:171], v[88:91]
    v_mfma_f32_16x16x32_bf16 v[92:95], a[68:71], v[172:175], v[92:95]
    v_mfma_f32_16x16x32_bf16 v[96:99], a[68:71], v[176:179], v[96:99]
    s_waitcnt vmcnt(50) lgkmcnt(0)
    v_mfma_f32_16x16x32_bf16 v[4:7], a[72:75], v[148:151], v[4:7]
    buffer_load_dwordx4 a[68:71], v241, s[12:15], s20 offen offset:3072
    v_mfma_f32_16x16x32_bf16 v[8:11], a[72:75], v[152:155], v[8:11]
    ds_read_b128 v[164:167], v244 offset:61440
    v_mfma_f32_16x16x32_bf16 v[12:15], a[72:75], v[156:159], v[12:15]
    ds_read_b128 v[168:171], v244 offset:62464
    v_mfma_f32_16x16x32_bf16 v[16:19], a[72:75], v[160:163], v[16:19]
    ds_read_b128 v[172:175], v244 offset:63488
    v_mfma_f32_16x16x32_bf16 v[20:23], a[76:79], v[148:151], v[20:23]
    s_add_u32 s20, s20, 4096
    buffer_load_dwordx4 a[72:75], v241, s[12:15], s20 offen offset:0
    v_mfma_f32_16x16x32_bf16 v[24:27], a[76:79], v[152:155], v[24:27]
    ds_read_b128 v[176:179], v244 offset:64512
    v_mfma_f32_16x16x32_bf16 v[28:31], a[76:79], v[156:159], v[28:31]
    v_mfma_f32_16x16x32_bf16 v[32:35], a[76:79], v[160:163], v[32:35]
    v_mfma_f32_16x16x32_bf16 v[36:39], a[80:83], v[148:151], v[36:39]
    buffer_load_dwordx4 a[76:79], v241, s[12:15], s20 offen offset:1024
    v_mfma_f32_16x16x32_bf16 v[40:43], a[80:83], v[152:155], v[40:43]
    v_mfma_f32_16x16x32_bf16 v[44:47], a[80:83], v[156:159], v[44:47]
    v_mfma_f32_16x16x32_bf16 v[48:51], a[80:83], v[160:163], v[48:51]
    s_waitcnt vmcnt(50) lgkmcnt(0)
    v_mfma_f32_16x16x32_bf16 v[4:7], a[84:87], v[164:167], v[4:7]
    buffer_load_dwordx4 a[80:83], v241, s[12:15], s20 offen offset:2048
    v_mfma_f32_16x16x32_bf16 v[8:11], a[84:87], v[168:171], v[8:11]
    ds_read_b128 v[148:151], v245 offset:0
    v_mfma_f32_16x16x32_bf16 v[12:15], a[84:87], v[172:175], v[12:15]
    ds_read_b128 v[152:155], v245 offset:1024
    v_mfma_f32_16x16x32_bf16 v[16:19], a[84:87], v[176:179], v[16:19]
    ds_read_b128 v[156:159], v245 offset:2048
    v_mfma_f32_16x16x32_bf16 v[20:23], a[88:91], v[164:167], v[20:23]
    buffer_load_dwordx4 a[84:87], v241, s[12:15], s20 offen offset:3072
    v_mfma_f32_16x16x32_bf16 v[24:27], a[88:91], v[168:171], v[24:27]
    ds_read_b128 v[160:163], v245 offset:3072
    v_mfma_f32_16x16x32_bf16 v[28:31], a[88:91], v[172:175], v[28:31]
    v_mfma_f32_16x16x32_bf16 v[32:35], a[88:91], v[176:179], v[32:35]
    v_mfma_f32_16x16x32_bf16 v[36:39], a[92:95], v[164:167], v[36:39]
    s_add_u32 s20, s20, 4096
    buffer_load_dwordx4 a[88:91], v241, s[12:15], s20 offen offset:0
    v_mfma_f32_16x16x32_bf16 v[40:43], a[92:95], v[168:171], v[40:43]
    v_mfma_f32_16x16x32_bf16 v[44:47], a[92:95], v[172:175], v[44:47]
    v_mfma_f32_16x16x32_bf16 v[48:51], a[92:95], v[176:179], v[48:51]
    s_waitcnt vmcnt(50) lgkmcnt(0)
    v_mfma_f32_16x16x32_bf16 v[4:7], a[96:99], v[148:151], v[4:7]
    buffer_load_dwordx4 a[92:95], v241, s[12:15], s20 offen offset:1024
    v_mfma_f32_16x16x32_bf16 v[8:11], a[96:99], v[152:155], v[8:11]
    ds_read_b128 v[164:167], v245 offset:4096
    v_mfma_f32_16x16x32_bf16 v[12:15], a[96:99], v[156:159], v[12:15]
    ds_read_b128 v[168:171], v245 offset:5120
    v_mfma_f32_16x16x32_bf16 v[16:19], a[96:99], v[160:163], v[16:19]
    ds_read_b128 v[172:175], v245 offset:6144
    v_mfma_f32_16x16x32_bf16 v[20:23], a[100:103], v[148:151], v[20:23]
    buffer_load_dwordx4 a[96:99], v241, s[12:15], s20 offen offset:2048
    v_mfma_f32_16x16x32_bf16 v[24:27], a[100:103], v[152:155], v[24:27]
    ds_read_b128 v[176:179], v245 offset:7168
    v_mfma_f32_16x16x32_bf16 v[28:31], a[100:103], v[156:159], v[28:31]
    v_mfma_f32_16x16x32_bf16 v[32:35], a[100:103], v[160:163], v[32:35]
    v_mfma_f32_16x16x32_bf16 v[36:39], a[104:107], v[148:151], v[36:39]
    buffer_load_dwordx4 a[100:103], v241, s[12:15], s20 offen offset:3072
    v_mfma_f32_16x16x32_bf16 v[40:43], a[104:107], v[152:155], v[40:43]
    v_mfma_f32_16x16x32_bf16 v[44:47], a[104:107], v[156:159], v[44:47]
    v_mfma_f32_16x16x32_bf16 v[48:51], a[104:107], v[160:163], v[48:51]
    s_waitcnt vmcnt(50) lgkmcnt(0)
    v_mfma_f32_16x16x32_bf16 v[4:7], a[108:111], v[164:167], v[4:7]
    s_add_u32 s20, s20, 4096
    buffer_load_dwordx4 a[104:107], v241, s[12:15], s20 offen offset:0
    v_mfma_f32_16x16x32_bf16 v[8:11], a[108:111], v[168:171], v[8:11]
    ds_read_b128 v[148:151], v245 offset:8192
    v_mfma_f32_16x16x32_bf16 v[12:15], a[108:111], v[172:175], v[12:15]
    ds_read_b128 v[152:155], v245 offset:9216
    v_mfma_f32_16x16x32_bf16 v[16:19], a[108:111], v[176:179], v[16:19]
    ds_read_b128 v[156:159], v245 offset:10240
    v_mfma_f32_16x16x32_bf16 v[20:23], a[112:115], v[164:167], v[20:23]
    buffer_load_dwordx4 a[108:111], v241, s[12:15], s20 offen offset:1024
    v_mfma_f32_16x16x32_bf16 v[24:27], a[112:115], v[168:171], v[24:27]
    ds_read_b128 v[160:163], v245 offset:11264
    v_mfma_f32_16x16x32_bf16 v[28:31], a[112:115], v[172:175], v[28:31]
    v_mfma_f32_16x16x32_bf16 v[32:35], a[112:115], v[176:179], v[32:35]
    v_mfma_f32_16x16x32_bf16 v[36:39], a[116:119], v[164:167], v[36:39]
    buffer_load_dwordx4 a[112:115], v241, s[12:15], s20 offen offset:2048
    v_mfma_f32_16x16x32_bf16 v[40:43], a[116:119], v[168:171], v[40:43]
    v_mfma_f32_16x16x32_bf16 v[44:47], a[116:119], v[172:175], v[44:47]
    v_mfma_f32_16x16x32_bf16 v[48:51], a[116:119], v[176:179], v[48:51]
    s_waitcnt vmcnt(50) lgkmcnt(0)
    v_mfma_f32_16x16x32_bf16 v[4:7], a[120:123], v[148:151], v[4:7]
    buffer_load_dwordx4 a[116:119], v241, s[12:15], s20 offen offset:3072
    v_mfma_f32_16x16x32_bf16 v[8:11], a[120:123], v[152:155], v[8:11]
    ds_read_b128 v[164:167], v245 offset:12288
    v_mfma_f32_16x16x32_bf16 v[12:15], a[120:123], v[156:159], v[12:15]
    ds_read_b128 v[168:171], v245 offset:13312
    v_mfma_f32_16x16x32_bf16 v[16:19], a[120:123], v[160:163], v[16:19]
    ds_read_b128 v[172:175], v245 offset:14336
    v_mfma_f32_16x16x32_bf16 v[20:23], a[124:127], v[148:151], v[20:23]
    s_add_u32 s20, s20, 4096
    buffer_load_dwordx4 a[120:123], v241, s[12:15], s20 offen offset:0
    v_mfma_f32_16x16x32_bf16 v[24:27], a[124:127], v[152:155], v[24:27]
    ds_read_b128 v[176:179], v245 offset:15360
    v_mfma_f32_16x16x32_bf16 v[28:31], a[124:127], v[156:159], v[28:31]
    v_mfma_f32_16x16x32_bf16 v[32:35], a[124:127], v[160:163], v[32:35]
    v_mfma_f32_16x16x32_bf16 v[36:39], a[128:131], v[148:151], v[36:39]
    buffer_load_dwordx4 a[124:127], v241, s[12:15], s20 offen offset:1024
    v_mfma_f32_16x16x32_bf16 v[40:43], a[128:131], v[152:155], v[40:43]
    v_mfma_f32_16x16x32_bf16 v[44:47], a[128:131], v[156:159], v[44:47]
    v_mfma_f32_16x16x32_bf16 v[48:51], a[128:131], v[160:163], v[48:51]
    s_waitcnt vmcnt(50) lgkmcnt(0)
    v_mfma_f32_16x16x32_bf16 v[4:7], a[132:135], v[164:167], v[4:7]
    buffer_load_dwordx4 a[128:131], v241, s[12:15], s20 offen offset:2048
    v_mfma_f32_16x16x32_bf16 v[8:11], a[132:135], v[168:171], v[8:11]
    ds_read_b128 v[148:151], v244 offset:57344
    v_mfma_f32_16x16x32_bf16 v[12:15], a[132:135], v[172:175], v[12:15]
    ds_read_b128 v[152:155], v244 offset:58368
    v_mfma_f32_16x16x32_bf16 v[16:19], a[132:135], v[176:179], v[16:19]
    ds_read_b128 v[156:159], v244 offset:59392
    v_mfma_f32_16x16x32_bf16 v[20:23], a[136:139], v[164:167], v[20:23]
    buffer_load_dwordx4 a[132:135], v241, s[12:15], s20 offen offset:3072
    v_mfma_f32_16x16x32_bf16 v[24:27], a[136:139], v[168:171], v[24:27]
    ds_read_b128 v[160:163], v244 offset:60416
    v_mfma_f32_16x16x32_bf16 v[28:31], a[136:139], v[172:175], v[28:31]
    v_mfma_f32_16x16x32_bf16 v[32:35], a[136:139], v[176:179], v[32:35]
    v_mfma_f32_16x16x32_bf16 v[36:39], a[140:143], v[164:167], v[36:39]
    s_add_u32 s20, s20, 4096
    buffer_load_dwordx4 a[136:139], v241, s[12:15], s20 offen offset:0
    v_mfma_f32_16x16x32_bf16 v[40:43], a[140:143], v[168:171], v[40:43]
    v_mfma_f32_16x16x32_bf16 v[44:47], a[140:143], v[172:175], v[44:47]
    v_mfma_f32_16x16x32_bf16 v[48:51], a[140:143], v[176:179], v[48:51]
    s_waitcnt vmcnt(50) lgkmcnt(0)
    v_mfma_f32_16x16x32_bf16 v[52:55], a[144:147], v[148:151], v[52:55]
    buffer_load_dwordx4 a[140:143], v241, s[12:15], s20 offen offset:1024
    v_mfma_f32_16x16x32_bf16 v[56:59], a[144:147], v[152:155], v[56:59]
    ds_read_b128 v[164:167], v244 offset:61440
    v_mfma_f32_16x16x32_bf16 v[60:63], a[144:147], v[156:159], v[60:63]
    ds_read_b128 v[168:171], v244 offset:62464
    v_mfma_f32_16x16x32_bf16 v[64:67], a[144:147], v[160:163], v[64:67]
    ds_read_b128 v[172:175], v244 offset:63488
    v_mfma_f32_16x16x32_bf16 v[68:71], a[148:151], v[148:151], v[68:71]
    buffer_load_dwordx4 a[144:147], v241, s[12:15], s20 offen offset:2048
    v_mfma_f32_16x16x32_bf16 v[72:75], a[148:151], v[152:155], v[72:75]
    ds_read_b128 v[176:179], v244 offset:64512
    v_mfma_f32_16x16x32_bf16 v[76:79], a[148:151], v[156:159], v[76:79]
    v_mfma_f32_16x16x32_bf16 v[80:83], a[148:151], v[160:163], v[80:83]
    v_cvt_pk_bf16_f32 v216, v4, v5
    v_mfma_f32_16x16x32_bf16 v[84:87], a[152:155], v[148:151], v[84:87]
    buffer_load_dwordx4 a[148:151], v241, s[12:15], s20 offen offset:3072
    v_cvt_pk_bf16_f32 v217, v6, v7
    v_mfma_f32_16x16x32_bf16 v[88:91], a[152:155], v[152:155], v[88:91]
    v_mfma_f32_16x16x32_bf16 v[92:95], a[152:155], v[156:159], v[92:95]
    v_cvt_pk_bf16_f32 v218, v20, v21
    v_mfma_f32_16x16x32_bf16 v[96:99], a[152:155], v[160:163], v[96:99]
    s_waitcnt vmcnt(50) lgkmcnt(0)
    v_cvt_pk_bf16_f32 v219, v22, v23
    v_mfma_f32_16x16x32_bf16 v[52:55], a[156:159], v[164:167], v[52:55]
    s_add_u32 s20, s20, 4096
    buffer_load_dwordx4 a[152:155], v241, s[12:15], s20 offen offset:0
    v_mfma_f32_16x16x32_bf16 v[56:59], a[156:159], v[168:171], v[56:59]
    ds_read_b128 v[148:151], v245 offset:0
    v_mfma_f32_16x16x32_bf16 v[60:63], a[156:159], v[172:175], v[60:63]
    ds_read_b128 v[152:155], v245 offset:1024
    v_mfma_f32_16x16x32_bf16 v[64:67], a[156:159], v[176:179], v[64:67]
    ds_read_b128 v[156:159], v245 offset:2048
    v_mfma_f32_16x16x32_bf16 v[68:71], a[160:163], v[164:167], v[68:71]
    buffer_load_dwordx4 a[156:159], v241, s[12:15], s20 offen offset:1024
    v_mfma_f32_16x16x32_bf16 v[72:75], a[160:163], v[168:171], v[72:75]
    ds_read_b128 v[160:163], v245 offset:3072
    v_mfma_f32_16x16x32_bf16 v[76:79], a[160:163], v[172:175], v[76:79]
    buffer_store_dwordx4 v[216:219], v187, s[12:15], s22 offen sc1
    s_add_u32 s22, s22, 147456
    v_cvt_pk_bf16_f32 v220, v8, v9
    v_cvt_pk_bf16_f32 v221, v10, v11
    v_mfma_f32_16x16x32_bf16 v[80:83], a[160:163], v[176:179], v[80:83]
    v_mfma_f32_16x16x32_bf16 v[84:87], a[164:167], v[164:167], v[84:87]
    buffer_load_dwordx4 a[160:163], v241, s[12:15], s20 offen offset:2048
    v_cvt_pk_bf16_f32 v222, v24, v25
    v_mfma_f32_16x16x32_bf16 v[88:91], a[164:167], v[168:171], v[88:91]
    v_cvt_pk_bf16_f32 v223, v26, v27
    v_mfma_f32_16x16x32_bf16 v[92:95], a[164:167], v[172:175], v[92:95]
    v_mfma_f32_16x16x32_bf16 v[96:99], a[164:167], v[176:179], v[96:99]
    s_waitcnt vmcnt(51) lgkmcnt(0)
    buffer_store_dwordx4 v[220:223], v187, s[12:15], s22 offen sc1
    v_mfma_f32_16x16x32_bf16 v[52:55], a[168:171], v[148:151], v[52:55]
    buffer_load_dwordx4 a[164:167], v241, s[12:15], s20 offen offset:3072
    v_mfma_f32_16x16x32_bf16 v[56:59], a[168:171], v[152:155], v[56:59]
    ds_read_b128 v[164:167], v245 offset:4096
    s_add_u32 s22, s22, 147456
    v_mfma_f32_16x16x32_bf16 v[60:63], a[168:171], v[156:159], v[60:63]
    ds_read_b128 v[168:171], v245 offset:5120
    v_cvt_pk_bf16_f32 v224, v12, v13
    v_mfma_f32_16x16x32_bf16 v[64:67], a[168:171], v[160:163], v[64:67]
    ds_read_b128 v[172:175], v245 offset:6144
    v_mfma_f32_16x16x32_bf16 v[68:71], a[172:175], v[148:151], v[68:71]
    s_add_u32 s20, s20, 4096
    buffer_load_dwordx4 a[168:171], v241, s[12:15], s20 offen offset:0
    v_cvt_pk_bf16_f32 v225, v14, v15
    v_mfma_f32_16x16x32_bf16 v[72:75], a[172:175], v[152:155], v[72:75]
    ds_read_b128 v[176:179], v245 offset:7168
    v_mfma_f32_16x16x32_bf16 v[76:79], a[172:175], v[156:159], v[76:79]
    v_cvt_pk_bf16_f32 v226, v28, v29
    v_mfma_f32_16x16x32_bf16 v[80:83], a[172:175], v[160:163], v[80:83]
    v_cvt_pk_bf16_f32 v227, v30, v31
    v_mfma_f32_16x16x32_bf16 v[84:87], a[176:179], v[148:151], v[84:87]
    buffer_load_dwordx4 a[172:175], v241, s[12:15], s20 offen offset:1024
    v_mfma_f32_16x16x32_bf16 v[88:91], a[176:179], v[152:155], v[88:91]
    buffer_store_dwordx4 v[224:227], v187, s[12:15], s22 offen sc1
    v_mfma_f32_16x16x32_bf16 v[92:95], a[176:179], v[156:159], v[92:95]
    v_mfma_f32_16x16x32_bf16 v[96:99], a[176:179], v[160:163], v[96:99]
    s_waitcnt vmcnt(53) lgkmcnt(0)
    s_add_u32 s22, s22, 147456
    v_mfma_f32_16x16x32_bf16 v[52:55], a[180:183], v[164:167], v[52:55]
    buffer_load_dwordx4 a[176:179], v241, s[12:15], s20 offen offset:2048
    v_cvt_pk_bf16_f32 v228, v16, v17
    v_mfma_f32_16x16x32_bf16 v[56:59], a[180:183], v[168:171], v[56:59]
    ds_read_b128 v[148:151], v245 offset:8192
    v_mfma_f32_16x16x32_bf16 v[60:63], a[180:183], v[172:175], v[60:63]
    ds_read_b128 v[152:155], v245 offset:9216
    v_cvt_pk_bf16_f32 v229, v18, v19
    v_mfma_f32_16x16x32_bf16 v[64:67], a[180:183], v[176:179], v[64:67]
    ds_read_b128 v[156:159], v245 offset:10240
    v_mfma_f32_16x16x32_bf16 v[68:71], a[184:187], v[164:167], v[68:71]
    buffer_load_dwordx4 a[180:183], v241, s[12:15], s20 offen offset:3072
    v_cvt_pk_bf16_f32 v230, v32, v33
    v_mfma_f32_16x16x32_bf16 v[72:75], a[184:187], v[168:171], v[72:75]
    ds_read_b128 v[160:163], v245 offset:11264
    v_cvt_pk_bf16_f32 v231, v34, v35
    v_mfma_f32_16x16x32_bf16 v[76:79], a[184:187], v[172:175], v[76:79]
    v_mfma_f32_16x16x32_bf16 v[80:83], a[184:187], v[176:179], v[80:83]
    buffer_store_dwordx4 v[228:231], v187, s[12:15], s22 offen sc1
    v_mfma_f32_16x16x32_bf16 v[84:87], a[188:191], v[164:167], v[84:87]
    s_add_u32 s20, s20, 4096
    buffer_load_dwordx4 a[184:187], v241, s[12:15], s20 offen offset:0
    s_add_u32 s22, s22, 4294524928
    v_mfma_f32_16x16x32_bf16 v[88:91], a[188:191], v[168:171], v[88:91]
    v_mfma_f32_16x16x32_bf16 v[92:95], a[188:191], v[172:175], v[92:95]
    v_cvt_pk_bf16_f32 v232, v36, v37
    v_mfma_f32_16x16x32_bf16 v[96:99], a[188:191], v[176:179], v[96:99]
    s_waitcnt vmcnt(54) lgkmcnt(0)
    v_mfma_f32_16x16x32_bf16 v[52:55], a[192:195], v[148:151], v[52:55]
    buffer_load_dwordx4 a[188:191], v241, s[12:15], s20 offen offset:1024
    v_cvt_pk_bf16_f32 v233, v38, v39
    v_mfma_f32_16x16x32_bf16 v[56:59], a[192:195], v[152:155], v[56:59]
    ds_read_b128 v[164:167], v245 offset:12288
    v_cvt_pk_bf16_f32 v234, v40, v41
    v_mfma_f32_16x16x32_bf16 v[60:63], a[192:195], v[156:159], v[60:63]
    ds_read_b128 v[168:171], v245 offset:13312
    v_mfma_f32_16x16x32_bf16 v[64:67], a[192:195], v[160:163], v[64:67]
    ds_read_b128 v[172:175], v245 offset:14336
    v_cvt_pk_bf16_f32 v235, v42, v43
    v_mfma_f32_16x16x32_bf16 v[68:71], a[196:199], v[148:151], v[68:71]
    buffer_load_dwordx4 a[192:195], v241, s[12:15], s20 offen offset:2048
    v_mfma_f32_16x16x32_bf16 v[72:75], a[196:199], v[152:155], v[72:75]
    ds_read_b128 v[176:179], v245 offset:15360
    v_cvt_pk_bf16_f32 v236, v44, v45
    v_mfma_f32_16x16x32_bf16 v[76:79], a[196:199], v[156:159], v[76:79]
    v_cvt_pk_bf16_f32 v237, v46, v47
    v_mfma_f32_16x16x32_bf16 v[80:83], a[196:199], v[160:163], v[80:83]
    v_mfma_f32_16x16x32_bf16 v[84:87], a[200:203], v[148:151], v[84:87]
    buffer_load_dwordx4 a[196:199], v241, s[12:15], s20 offen offset:3072
    v_cvt_pk_bf16_f32 v238, v48, v49
    v_mfma_f32_16x16x32_bf16 v[88:91], a[200:203], v[152:155], v[88:91]
    v_mfma_f32_16x16x32_bf16 v[92:95], a[200:203], v[156:159], v[92:95]
    v_cvt_pk_bf16_f32 v239, v50, v51
    v_mfma_f32_16x16x32_bf16 v[96:99], a[200:203], v[160:163], v[96:99]
    s_waitcnt vmcnt(54) lgkmcnt(0)
    v_permlane16_swap_b32 v232, v234
    v_mfma_f32_16x16x32_bf16 v[52:55], a[204:207], v[164:167], v[52:55]
    s_add_u32 s20, s20, 4096
    buffer_load_dwordx4 a[200:203], v241, s[12:15], s20 offen offset:0
    v_mfma_f32_16x16x32_bf16 v[56:59], a[204:207], v[168:171], v[56:59]
    ds_read_b128 v[148:151], v244 offset:8192
    v_permlane16_swap_b32 v233, v235
    v_mfma_f32_16x16x32_bf16 v[60:63], a[204:207], v[172:175], v[60:63]
    ds_read_b128 v[152:155], v244 offset:9216
    v_mfma_f32_16x16x32_bf16 v[64:67], a[204:207], v[176:179], v[64:67]
    ds_read_b128 v[156:159], v244 offset:10240
    v_permlane16_swap_b32 v236, v238
    v_mfma_f32_16x16x32_bf16 v[68:71], a[208:211], v[164:167], v[68:71]
    buffer_load_dwordx4 a[204:207], v241, s[12:15], s20 offen offset:1024
    v_permlane16_swap_b32 v237, v239
    v_mfma_f32_16x16x32_bf16 v[72:75], a[208:211], v[168:171], v[72:75]
    ds_read_b128 v[160:163], v244 offset:11264
    v_mfma_f32_16x16x32_bf16 v[76:79], a[208:211], v[172:175], v[76:79]
    buffer_store_dwordx4 v[232:235], v249, s[12:15], s22 offen sc1
    v_mfma_f32_16x16x32_bf16 v[80:83], a[208:211], v[176:179], v[80:83]
    v_mfma_f32_16x16x32_bf16 v[84:87], a[212:215], v[164:167], v[84:87]
    buffer_load_dwordx4 a[208:211], v241, s[12:15], s20 offen offset:2048
    s_add_u32 s22, s22, 294912
    v_mfma_f32_16x16x32_bf16 v[88:91], a[212:215], v[168:171], v[88:91]
    buffer_store_dwordx4 v[236:239], v249, s[12:15], s22 offen sc1
    v_mfma_f32_16x16x32_bf16 v[92:95], a[212:215], v[172:175], v[92:95]
    v_mfma_f32_16x16x32_bf16 v[96:99], a[212:215], v[176:179], v[96:99]
    s_waitcnt vmcnt(56) lgkmcnt(0)
    s_add_u32 s22, s22, 4294678528
    v_mfma_f32_16x16x32_bf16 v[100:103], a[0:3], v[148:151], 0
    buffer_load_dwordx4 a[212:215], v241, s[12:15], s20 offen offset:3072
    v_mfma_f32_16x16x32_bf16 v[104:107], a[0:3], v[152:155], 0
    ds_read_b128 v[164:167], v244 offset:12288
    v_mfma_f32_16x16x32_bf16 v[108:111], a[0:3], v[156:159], 0
    ds_read_b128 v[168:171], v244 offset:13312
    v_mfma_f32_16x16x32_bf16 v[112:115], a[0:3], v[160:163], 0
    ds_read_b128 v[172:175], v244 offset:14336
    v_mfma_f32_16x16x32_bf16 v[116:119], a[4:7], v[148:151], 0
    v_mfma_f32_16x16x32_bf16 v[120:123], a[4:7], v[152:155], 0
    ds_read_b128 v[176:179], v244 offset:15360
    v_mfma_f32_16x16x32_bf16 v[124:127], a[4:7], v[156:159], 0
    v_mfma_f32_16x16x32_bf16 v[128:131], a[4:7], v[160:163], 0
    v_cvt_pk_bf16_f32 v216, v52, v53
    v_mfma_f32_16x16x32_bf16 v[132:135], a[8:11], v[148:151], 0
    v_cvt_pk_bf16_f32 v217, v54, v55
    v_mfma_f32_16x16x32_bf16 v[136:139], a[8:11], v[152:155], 0
    v_mfma_f32_16x16x32_bf16 v[140:143], a[8:11], v[156:159], 0
    v_cvt_pk_bf16_f32 v218, v68, v69
    v_mfma_f32_16x16x32_bf16 v[144:147], a[8:11], v[160:163], 0
    s_waitcnt vmcnt(54) lgkmcnt(0)
    v_cvt_pk_bf16_f32 v219, v70, v71
    v_mfma_f32_16x16x32_bf16 v[100:103], a[12:15], v[164:167], v[100:103]
    v_mfma_f32_16x16x32_bf16 v[104:107], a[12:15], v[168:171], v[104:107]
    ds_read_b128 v[148:151], v244 offset:16384
    v_mfma_f32_16x16x32_bf16 v[108:111], a[12:15], v[172:175], v[108:111]
    ds_read_b128 v[152:155], v244 offset:17408
    v_mfma_f32_16x16x32_bf16 v[112:115], a[12:15], v[176:179], v[112:115]
    ds_read_b128 v[156:159], v244 offset:18432
    v_mfma_f32_16x16x32_bf16 v[116:119], a[16:19], v[164:167], v[116:119]
    buffer_store_dwordx4 v[216:219], v187, s[12:15], s22 offen sc1
    s_add_u32 s22, s22, 147456
    v_cvt_pk_bf16_f32 v220, v56, v57
    v_mfma_f32_16x16x32_bf16 v[120:123], a[16:19], v[168:171], v[120:123]
    ds_read_b128 v[160:163], v244 offset:19456
    v_mfma_f32_16x16x32_bf16 v[124:127], a[16:19], v[172:175], v[124:127]
    v_cvt_pk_bf16_f32 v221, v58, v59
    v_mfma_f32_16x16x32_bf16 v[128:131], a[16:19], v[176:179], v[128:131]
    v_mfma_f32_16x16x32_bf16 v[132:135], a[20:23], v[164:167], v[132:135]
    v_cvt_pk_bf16_f32 v222, v72, v73
    v_mfma_f32_16x16x32_bf16 v[136:139], a[20:23], v[168:171], v[136:139]
    v_cvt_pk_bf16_f32 v223, v74, v75
    v_mfma_f32_16x16x32_bf16 v[140:143], a[20:23], v[172:175], v[140:143]
    v_mfma_f32_16x16x32_bf16 v[144:147], a[20:23], v[176:179], v[144:147]
    s_waitcnt vmcnt(52) lgkmcnt(0)
    buffer_store_dwordx4 v[220:223], v187, s[12:15], s22 offen sc1
    v_mfma_f32_16x16x32_bf16 v[100:103], a[24:27], v[148:151], v[100:103]
    v_mfma_f32_16x16x32_bf16 v[104:107], a[24:27], v[152:155], v[104:107]
    ds_read_b128 v[164:167], v244 offset:20480
    s_add_u32 s22, s22, 147456
    v_mfma_f32_16x16x32_bf16 v[108:111], a[24:27], v[156:159], v[108:111]
    ds_read_b128 v[168:171], v244 offset:21504
    v_cvt_pk_bf16_f32 v224, v60, v61
    v_mfma_f32_16x16x32_bf16 v[112:115], a[24:27], v[160:163], v[112:115]
    ds_read_b128 v[172:175], v244 offset:22528
    v_mfma_f32_16x16x32_bf16 v[116:119], a[28:31], v[148:151], v[116:119]
    v_cvt_pk_bf16_f32 v225, v62, v63
    v_mfma_f32_16x16x32_bf16 v[120:123], a[28:31], v[152:155], v[120:123]
    ds_read_b128 v[176:179], v244 offset:23552
    v_mfma_f32_16x16x32_bf16 v[124:127], a[28:31], v[156:159], v[124:127]
    v_cvt_pk_bf16_f32 v226, v76, v77
    v_mfma_f32_16x16x32_bf16 v[128:131], a[28:31], v[160:163], v[128:131]
    v_cvt_pk_bf16_f32 v227, v78, v79
    v_mfma_f32_16x16x32_bf16 v[132:135], a[32:35], v[148:151], v[132:135]
    v_mfma_f32_16x16x32_bf16 v[136:139], a[32:35], v[152:155], v[136:139]
    buffer_store_dwordx4 v[224:227], v187, s[12:15], s22 offen sc1
    v_mfma_f32_16x16x32_bf16 v[140:143], a[32:35], v[156:159], v[140:143]
    v_mfma_f32_16x16x32_bf16 v[144:147], a[32:35], v[160:163], v[144:147]
    s_waitcnt vmcnt(51) lgkmcnt(0)
    s_add_u32 s22, s22, 147456
    v_mfma_f32_16x16x32_bf16 v[100:103], a[36:39], v[164:167], v[100:103]
    v_cvt_pk_bf16_f32 v228, v64, v65
    v_mfma_f32_16x16x32_bf16 v[104:107], a[36:39], v[168:171], v[104:107]
    ds_read_b128 v[148:151], v244 offset:24576
    v_mfma_f32_16x16x32_bf16 v[108:111], a[36:39], v[172:175], v[108:111]
    ds_read_b128 v[152:155], v244 offset:25600
    v_cvt_pk_bf16_f32 v229, v66, v67
    v_mfma_f32_16x16x32_bf16 v[112:115], a[36:39], v[176:179], v[112:115]
    ds_read_b128 v[156:159], v244 offset:26624
    v_mfma_f32_16x16x32_bf16 v[116:119], a[40:43], v[164:167], v[116:119]
    v_cvt_pk_bf16_f32 v230, v80, v81
    v_mfma_f32_16x16x32_bf16 v[120:123], a[40:43], v[168:171], v[120:123]
    ds_read_b128 v[160:163], v244 offset:27648
    v_cvt_pk_bf16_f32 v231, v82, v83
    v_mfma_f32_16x16x32_bf16 v[124:127], a[40:43], v[172:175], v[124:127]
    v_mfma_f32_16x16x32_bf16 v[128:131], a[40:43], v[176:179], v[128:131]
    buffer_store_dwordx4 v[228:231], v187, s[12:15], s22 offen sc1
    v_mfma_f32_16x16x32_bf16 v[132:135], a[44:47], v[164:167], v[132:135]
    s_add_u32 s22, s22, 4294524928
    v_mfma_f32_16x16x32_bf16 v[136:139], a[44:47], v[168:171], v[136:139]
    v_mfma_f32_16x16x32_bf16 v[140:143], a[44:47], v[172:175], v[140:143]
    v_cvt_pk_bf16_f32 v232, v84, v85
    v_mfma_f32_16x16x32_bf16 v[144:147], a[44:47], v[176:179], v[144:147]
    s_waitcnt vmcnt(49) lgkmcnt(0)
    v_mfma_f32_16x16x32_bf16 v[100:103], a[48:51], v[148:151], v[100:103]
    v_cvt_pk_bf16_f32 v233, v86, v87
    v_mfma_f32_16x16x32_bf16 v[104:107], a[48:51], v[152:155], v[104:107]
    ds_read_b128 v[164:167], v244 offset:28672
    v_cvt_pk_bf16_f32 v234, v88, v89
    v_mfma_f32_16x16x32_bf16 v[108:111], a[48:51], v[156:159], v[108:111]
    ds_read_b128 v[168:171], v244 offset:29696
    v_mfma_f32_16x16x32_bf16 v[112:115], a[48:51], v[160:163], v[112:115]
    ds_read_b128 v[172:175], v244 offset:30720
    v_cvt_pk_bf16_f32 v235, v90, v91
    v_mfma_f32_16x16x32_bf16 v[116:119], a[52:55], v[148:151], v[116:119]
    v_mfma_f32_16x16x32_bf16 v[120:123], a[52:55], v[152:155], v[120:123]
    ds_read_b128 v[176:179], v244 offset:31744
    v_cvt_pk_bf16_f32 v236, v92, v93
    v_mfma_f32_16x16x32_bf16 v[124:127], a[52:55], v[156:159], v[124:127]
    v_cvt_pk_bf16_f32 v237, v94, v95
    v_mfma_f32_16x16x32_bf16 v[128:131], a[52:55], v[160:163], v[128:131]
    v_mfma_f32_16x16x32_bf16 v[132:135], a[56:59], v[148:151], v[132:135]
    v_cvt_pk_bf16_f32 v238, v96, v97
    v_mfma_f32_16x16x32_bf16 v[136:139], a[56:59], v[152:155], v[136:139]
    v_mfma_f32_16x16x32_bf16 v[140:143], a[56:59], v[156:159], v[140:143]
    v_cvt_pk_bf16_f32 v239, v98, v99
    v_mfma_f32_16x16x32_bf16 v[144:147], a[56:59], v[160:163], v[144:147]
    s_waitcnt vmcnt(46) lgkmcnt(0)
    v_permlane16_swap_b32 v232, v234
    v_mfma_f32_16x16x32_bf16 v[100:103], a[60:63], v[164:167], v[100:103]
    v_mfma_f32_16x16x32_bf16 v[104:107], a[60:63], v[168:171], v[104:107]
    ds_read_b128 v[148:151], v244 offset:32768
    v_permlane16_swap_b32 v233, v235
    v_mfma_f32_16x16x32_bf16 v[108:111], a[60:63], v[172:175], v[108:111]
    ds_read_b128 v[152:155], v244 offset:33792
    v_mfma_f32_16x16x32_bf16 v[112:115], a[60:63], v[176:179], v[112:115]
    ds_read_b128 v[156:159], v244 offset:34816
    v_permlane16_swap_b32 v236, v238
    v_mfma_f32_16x16x32_bf16 v[116:119], a[64:67], v[164:167], v[116:119]
    v_permlane16_swap_b32 v237, v239
    v_mfma_f32_16x16x32_bf16 v[120:123], a[64:67], v[168:171], v[120:123]
    ds_read_b128 v[160:163], v244 offset:35840
    v_mfma_f32_16x16x32_bf16 v[124:127], a[64:67], v[172:175], v[124:127]
    buffer_store_dwordx4 v[232:235], v249, s[12:15], s22 offen sc1
    v_mfma_f32_16x16x32_bf16 v[128:131], a[64:67], v[176:179], v[128:131]
    v_mfma_f32_16x16x32_bf16 v[132:135], a[68:71], v[164:167], v[132:135]
    s_add_u32 s22, s22, 294912
    v_mfma_f32_16x16x32_bf16 v[136:139], a[68:71], v[168:171], v[136:139]
    buffer_store_dwordx4 v[236:239], v249, s[12:15], s22 offen sc1
    v_mfma_f32_16x16x32_bf16 v[140:143], a[68:71], v[172:175], v[140:143]
    v_mfma_f32_16x16x32_bf16 v[144:147], a[68:71], v[176:179], v[144:147]
    s_waitcnt vmcnt(45) lgkmcnt(0)
    s_add_u32 s22, s22, 4294678528
    v_mfma_f32_16x16x32_bf16 v[100:103], a[72:75], v[148:151], v[100:103]
    v_mfma_f32_16x16x32_bf16 v[104:107], a[72:75], v[152:155], v[104:107]
    ds_read_b128 v[164:167], v244 offset:36864
    v_mfma_f32_16x16x32_bf16 v[108:111], a[72:75], v[156:159], v[108:111]
    ds_read_b128 v[168:171], v244 offset:37888
    v_mfma_f32_16x16x32_bf16 v[112:115], a[72:75], v[160:163], v[112:115]
    ds_read_b128 v[172:175], v244 offset:38912
    v_mfma_f32_16x16x32_bf16 v[116:119], a[76:79], v[148:151], v[116:119]
    v_mfma_f32_16x16x32_bf16 v[120:123], a[76:79], v[152:155], v[120:123]
    ds_read_b128 v[176:179], v244 offset:39936
    v_mfma_f32_16x16x32_bf16 v[124:127], a[76:79], v[156:159], v[124:127]
    v_mfma_f32_16x16x32_bf16 v[128:131], a[76:79], v[160:163], v[128:131]
    v_mfma_f32_16x16x32_bf16 v[132:135], a[80:83], v[148:151], v[132:135]
    v_mfma_f32_16x16x32_bf16 v[136:139], a[80:83], v[152:155], v[136:139]
    v_mfma_f32_16x16x32_bf16 v[140:143], a[80:83], v[156:159], v[140:143]
    v_mfma_f32_16x16x32_bf16 v[144:147], a[80:83], v[160:163], v[144:147]
    s_waitcnt vmcnt(42) lgkmcnt(0)
    v_mfma_f32_16x16x32_bf16 v[100:103], a[84:87], v[164:167], v[100:103]
    v_mfma_f32_16x16x32_bf16 v[104:107], a[84:87], v[168:171], v[104:107]
    ds_read_b128 v[148:151], v244 offset:40960
    v_mfma_f32_16x16x32_bf16 v[108:111], a[84:87], v[172:175], v[108:111]
    ds_read_b128 v[152:155], v244 offset:41984
    v_mfma_f32_16x16x32_bf16 v[112:115], a[84:87], v[176:179], v[112:115]
    ds_read_b128 v[156:159], v244 offset:43008
    v_mfma_f32_16x16x32_bf16 v[116:119], a[88:91], v[164:167], v[116:119]
    v_mfma_f32_16x16x32_bf16 v[120:123], a[88:91], v[168:171], v[120:123]
    ds_read_b128 v[160:163], v244 offset:44032
    v_mfma_f32_16x16x32_bf16 v[124:127], a[88:91], v[172:175], v[124:127]
    v_mfma_f32_16x16x32_bf16 v[128:131], a[88:91], v[176:179], v[128:131]
    v_mfma_f32_16x16x32_bf16 v[132:135], a[92:95], v[164:167], v[132:135]
    v_mfma_f32_16x16x32_bf16 v[136:139], a[92:95], v[168:171], v[136:139]
    v_mfma_f32_16x16x32_bf16 v[140:143], a[92:95], v[172:175], v[140:143]
    v_mfma_f32_16x16x32_bf16 v[144:147], a[92:95], v[176:179], v[144:147]
    s_waitcnt vmcnt(39) lgkmcnt(0)
    v_mfma_f32_16x16x32_bf16 v[100:103], a[96:99], v[148:151], v[100:103]
    v_mfma_f32_16x16x32_bf16 v[104:107], a[96:99], v[152:155], v[104:107]
    ds_read_b128 v[164:167], v244 offset:45056
    v_mfma_f32_16x16x32_bf16 v[108:111], a[96:99], v[156:159], v[108:111]
    ds_read_b128 v[168:171], v244 offset:46080
    v_mfma_f32_16x16x32_bf16 v[112:115], a[96:99], v[160:163], v[112:115]
    ds_read_b128 v[172:175], v244 offset:47104
    v_mfma_f32_16x16x32_bf16 v[116:119], a[100:103], v[148:151], v[116:119]
    v_mfma_f32_16x16x32_bf16 v[120:123], a[100:103], v[152:155], v[120:123]
    ds_read_b128 v[176:179], v244 offset:48128
    v_mfma_f32_16x16x32_bf16 v[124:127], a[100:103], v[156:159], v[124:127]
    v_mfma_f32_16x16x32_bf16 v[128:131], a[100:103], v[160:163], v[128:131]
    v_mfma_f32_16x16x32_bf16 v[132:135], a[104:107], v[148:151], v[132:135]
    v_mfma_f32_16x16x32_bf16 v[136:139], a[104:107], v[152:155], v[136:139]
    v_mfma_f32_16x16x32_bf16 v[140:143], a[104:107], v[156:159], v[140:143]
    v_mfma_f32_16x16x32_bf16 v[144:147], a[104:107], v[160:163], v[144:147]
    s_waitcnt vmcnt(36) lgkmcnt(0)
    v_mfma_f32_16x16x32_bf16 v[100:103], a[108:111], v[164:167], v[100:103]
    v_mfma_f32_16x16x32_bf16 v[104:107], a[108:111], v[168:171], v[104:107]
    ds_read_b128 v[148:151], v244 offset:49152
    v_mfma_f32_16x16x32_bf16 v[108:111], a[108:111], v[172:175], v[108:111]
    ds_read_b128 v[152:155], v244 offset:50176
    v_mfma_f32_16x16x32_bf16 v[112:115], a[108:111], v[176:179], v[112:115]
    ds_read_b128 v[156:159], v244 offset:51200
    v_mfma_f32_16x16x32_bf16 v[116:119], a[112:115], v[164:167], v[116:119]
    v_mfma_f32_16x16x32_bf16 v[120:123], a[112:115], v[168:171], v[120:123]
    ds_read_b128 v[160:163], v244 offset:52224
    v_mfma_f32_16x16x32_bf16 v[124:127], a[112:115], v[172:175], v[124:127]
    v_mfma_f32_16x16x32_bf16 v[128:131], a[112:115], v[176:179], v[128:131]
    v_mfma_f32_16x16x32_bf16 v[132:135], a[116:119], v[164:167], v[132:135]
    v_mfma_f32_16x16x32_bf16 v[136:139], a[116:119], v[168:171], v[136:139]
    v_mfma_f32_16x16x32_bf16 v[140:143], a[116:119], v[172:175], v[140:143]
    v_mfma_f32_16x16x32_bf16 v[144:147], a[116:119], v[176:179], v[144:147]
    s_waitcnt vmcnt(33) lgkmcnt(0)
    v_mfma_f32_16x16x32_bf16 v[100:103], a[120:123], v[148:151], v[100:103]
    v_mfma_f32_16x16x32_bf16 v[104:107], a[120:123], v[152:155], v[104:107]
    ds_read_b128 v[164:167], v244 offset:53248
    v_mfma_f32_16x16x32_bf16 v[108:111], a[120:123], v[156:159], v[108:111]
    ds_read_b128 v[168:171], v244 offset:54272
    v_mfma_f32_16x16x32_bf16 v[112:115], a[120:123], v[160:163], v[112:115]
    ds_read_b128 v[172:175], v244 offset:55296
    v_mfma_f32_16x16x32_bf16 v[116:119], a[124:127], v[148:151], v[116:119]
    v_mfma_f32_16x16x32_bf16 v[120:123], a[124:127], v[152:155], v[120:123]
    ds_read_b128 v[176:179], v244 offset:56320
    v_mfma_f32_16x16x32_bf16 v[124:127], a[124:127], v[156:159], v[124:127]
    v_mfma_f32_16x16x32_bf16 v[128:131], a[124:127], v[160:163], v[128:131]
    v_mfma_f32_16x16x32_bf16 v[132:135], a[128:131], v[148:151], v[132:135]
    v_mfma_f32_16x16x32_bf16 v[136:139], a[128:131], v[152:155], v[136:139]
    v_mfma_f32_16x16x32_bf16 v[140:143], a[128:131], v[156:159], v[140:143]
    v_mfma_f32_16x16x32_bf16 v[144:147], a[128:131], v[160:163], v[144:147]
    s_waitcnt vmcnt(30) lgkmcnt(0)
    v_mfma_f32_16x16x32_bf16 v[100:103], a[132:135], v[164:167], v[100:103]
    v_mfma_f32_16x16x32_bf16 v[104:107], a[132:135], v[168:171], v[104:107]
    ds_read_b128 v[148:151], v244 offset:57344
    v_mfma_f32_16x16x32_bf16 v[108:111], a[132:135], v[172:175], v[108:111]
    ds_read_b128 v[152:155], v244 offset:58368
    v_mfma_f32_16x16x32_bf16 v[112:115], a[132:135], v[176:179], v[112:115]
    ds_read_b128 v[156:159], v244 offset:59392
    v_mfma_f32_16x16x32_bf16 v[116:119], a[136:139], v[164:167], v[116:119]
    v_mfma_f32_16x16x32_bf16 v[120:123], a[136:139], v[168:171], v[120:123]
    ds_read_b128 v[160:163], v244 offset:60416
    v_mfma_f32_16x16x32_bf16 v[124:127], a[136:139], v[172:175], v[124:127]
    v_mfma_f32_16x16x32_bf16 v[128:131], a[136:139], v[176:179], v[128:131]
    v_mfma_f32_16x16x32_bf16 v[132:135], a[140:143], v[164:167], v[132:135]
    v_mfma_f32_16x16x32_bf16 v[136:139], a[140:143], v[168:171], v[136:139]
    v_mfma_f32_16x16x32_bf16 v[140:143], a[140:143], v[172:175], v[140:143]
    v_mfma_f32_16x16x32_bf16 v[144:147], a[140:143], v[176:179], v[144:147]
    s_waitcnt vmcnt(27) lgkmcnt(0)
    v_mfma_f32_16x16x32_bf16 v[100:103], a[144:147], v[148:151], v[100:103]
    v_mfma_f32_16x16x32_bf16 v[104:107], a[144:147], v[152:155], v[104:107]
    ds_read_b128 v[164:167], v244 offset:61440
    v_mfma_f32_16x16x32_bf16 v[108:111], a[144:147], v[156:159], v[108:111]
    ds_read_b128 v[168:171], v244 offset:62464
    v_mfma_f32_16x16x32_bf16 v[112:115], a[144:147], v[160:163], v[112:115]
    ds_read_b128 v[172:175], v244 offset:63488
    v_mfma_f32_16x16x32_bf16 v[116:119], a[148:151], v[148:151], v[116:119]
    v_mfma_f32_16x16x32_bf16 v[120:123], a[148:151], v[152:155], v[120:123]
    ds_read_b128 v[176:179], v244 offset:64512
    v_mfma_f32_16x16x32_bf16 v[124:127], a[148:151], v[156:159], v[124:127]
    v_mov_b32 v254, 1
    s_waitcnt vmcnt(0)
    s_mov_b32 exec_hi, 0
    buffer_store_dword v254, v0, s[12:15], s36 offen sc1
    s_mov_b32 exec_hi, -1
    v_mfma_f32_16x16x32_bf16 v[128:131], a[148:151], v[160:163], v[128:131]
    v_mfma_f32_16x16x32_bf16 v[132:135], a[152:155], v[148:151], v[132:135]
    v_mfma_f32_16x16x32_bf16 v[136:139], a[152:155], v[152:155], v[136:139]
    v_mfma_f32_16x16x32_bf16 v[140:143], a[152:155], v[156:159], v[140:143]
    v_mfma_f32_16x16x32_bf16 v[144:147], a[152:155], v[160:163], v[144:147]
    s_waitcnt lgkmcnt(0)
    v_mfma_f32_16x16x32_bf16 v[100:103], a[156:159], v[164:167], v[100:103]
    v_mfma_f32_16x16x32_bf16 v[104:107], a[156:159], v[168:171], v[104:107]
    ds_read_b128 v[148:151], v245 offset:0
    v_mfma_f32_16x16x32_bf16 v[108:111], a[156:159], v[172:175], v[108:111]
    ds_read_b128 v[152:155], v245 offset:1024
    v_mfma_f32_16x16x32_bf16 v[112:115], a[156:159], v[176:179], v[112:115]
    ds_read_b128 v[156:159], v245 offset:2048
    v_mfma_f32_16x16x32_bf16 v[116:119], a[160:163], v[164:167], v[116:119]
    v_mfma_f32_16x16x32_bf16 v[120:123], a[160:163], v[168:171], v[120:123]
    ds_read_b128 v[160:163], v245 offset:3072
    v_mfma_f32_16x16x32_bf16 v[124:127], a[160:163], v[172:175], v[124:127]
    v_mfma_f32_16x16x32_bf16 v[128:131], a[160:163], v[176:179], v[128:131]
    v_mfma_f32_16x16x32_bf16 v[132:135], a[164:167], v[164:167], v[132:135]
    v_mfma_f32_16x16x32_bf16 v[136:139], a[164:167], v[168:171], v[136:139]
    v_mfma_f32_16x16x32_bf16 v[140:143], a[164:167], v[172:175], v[140:143]
    v_mfma_f32_16x16x32_bf16 v[144:147], a[164:167], v[176:179], v[144:147]
    s_waitcnt lgkmcnt(0)
    v_mfma_f32_16x16x32_bf16 v[100:103], a[168:171], v[148:151], v[100:103]
    v_mfma_f32_16x16x32_bf16 v[104:107], a[168:171], v[152:155], v[104:107]
    ds_read_b128 v[164:167], v245 offset:4096
    v_mfma_f32_16x16x32_bf16 v[108:111], a[168:171], v[156:159], v[108:111]
    ds_read_b128 v[168:171], v245 offset:5120
    v_mfma_f32_16x16x32_bf16 v[112:115], a[168:171], v[160:163], v[112:115]
    ds_read_b128 v[172:175], v245 offset:6144
    v_mfma_f32_16x16x32_bf16 v[116:119], a[172:175], v[148:151], v[116:119]
    v_mfma_f32_16x16x32_bf16 v[120:123], a[172:175], v[152:155], v[120:123]
    ds_read_b128 v[176:179], v245 offset:7168
    v_mfma_f32_16x16x32_bf16 v[124:127], a[172:175], v[156:159], v[124:127]
    v_mfma_f32_16x16x32_bf16 v[128:131], a[172:175], v[160:163], v[128:131]
    v_mfma_f32_16x16x32_bf16 v[132:135], a[176:179], v[148:151], v[132:135]
    v_mfma_f32_16x16x32_bf16 v[136:139], a[176:179], v[152:155], v[136:139]
    v_mfma_f32_16x16x32_bf16 v[140:143], a[176:179], v[156:159], v[140:143]
    v_mfma_f32_16x16x32_bf16 v[144:147], a[176:179], v[160:163], v[144:147]
    s_waitcnt lgkmcnt(0)
    v_mfma_f32_16x16x32_bf16 v[100:103], a[180:183], v[164:167], v[100:103]
    v_mfma_f32_16x16x32_bf16 v[104:107], a[180:183], v[168:171], v[104:107]
    ds_read_b128 v[148:151], v245 offset:8192
    v_mfma_f32_16x16x32_bf16 v[108:111], a[180:183], v[172:175], v[108:111]
    ds_read_b128 v[152:155], v245 offset:9216
    v_mfma_f32_16x16x32_bf16 v[112:115], a[180:183], v[176:179], v[112:115]
    ds_read_b128 v[156:159], v245 offset:10240
    v_mfma_f32_16x16x32_bf16 v[116:119], a[184:187], v[164:167], v[116:119]
    v_mfma_f32_16x16x32_bf16 v[120:123], a[184:187], v[168:171], v[120:123]
    ds_read_b128 v[160:163], v245 offset:11264
    v_mfma_f32_16x16x32_bf16 v[124:127], a[184:187], v[172:175], v[124:127]
    v_mfma_f32_16x16x32_bf16 v[128:131], a[184:187], v[176:179], v[128:131]
    v_mfma_f32_16x16x32_bf16 v[132:135], a[188:191], v[164:167], v[132:135]
    v_mfma_f32_16x16x32_bf16 v[136:139], a[188:191], v[168:171], v[136:139]
    v_mfma_f32_16x16x32_bf16 v[140:143], a[188:191], v[172:175], v[140:143]
    v_mfma_f32_16x16x32_bf16 v[144:147], a[188:191], v[176:179], v[144:147]
    s_waitcnt lgkmcnt(0)
    v_mfma_f32_16x16x32_bf16 v[100:103], a[192:195], v[148:151], v[100:103]
    v_mfma_f32_16x16x32_bf16 v[104:107], a[192:195], v[152:155], v[104:107]
    ds_read_b128 v[164:167], v245 offset:12288
    v_mfma_f32_16x16x32_bf16 v[108:111], a[192:195], v[156:159], v[108:111]
    ds_read_b128 v[168:171], v245 offset:13312
    v_mfma_f32_16x16x32_bf16 v[112:115], a[192:195], v[160:163], v[112:115]
    ds_read_b128 v[172:175], v245 offset:14336
    v_mfma_f32_16x16x32_bf16 v[116:119], a[196:199], v[148:151], v[116:119]
    v_mfma_f32_16x16x32_bf16 v[120:123], a[196:199], v[152:155], v[120:123]
    ds_read_b128 v[176:179], v245 offset:15360
    v_mfma_f32_16x16x32_bf16 v[124:127], a[196:199], v[156:159], v[124:127]
    v_mfma_f32_16x16x32_bf16 v[128:131], a[196:199], v[160:163], v[128:131]
    v_mfma_f32_16x16x32_bf16 v[132:135], a[200:203], v[148:151], v[132:135]
    v_mfma_f32_16x16x32_bf16 v[136:139], a[200:203], v[152:155], v[136:139]
    v_mfma_f32_16x16x32_bf16 v[140:143], a[200:203], v[156:159], v[140:143]
    v_mfma_f32_16x16x32_bf16 v[144:147], a[200:203], v[160:163], v[144:147]
    s_waitcnt lgkmcnt(0)
    v_mfma_f32_16x16x32_bf16 v[100:103], a[204:207], v[164:167], v[100:103]
    v_mfma_f32_16x16x32_bf16 v[104:107], a[204:207], v[168:171], v[104:107]
    v_mfma_f32_16x16x32_bf16 v[108:111], a[204:207], v[172:175], v[108:111]
    v_mfma_f32_16x16x32_bf16 v[112:115], a[204:207], v[176:179], v[112:115]
    v_mfma_f32_16x16x32_bf16 v[116:119], a[208:211], v[164:167], v[116:119]
    v_mfma_f32_16x16x32_bf16 v[120:123], a[208:211], v[168:171], v[120:123]
    v_mfma_f32_16x16x32_bf16 v[124:127], a[208:211], v[172:175], v[124:127]
    v_mfma_f32_16x16x32_bf16 v[128:131], a[208:211], v[176:179], v[128:131]
    v_mfma_f32_16x16x32_bf16 v[132:135], a[212:215], v[164:167], v[132:135]
    v_mfma_f32_16x16x32_bf16 v[136:139], a[212:215], v[168:171], v[136:139]
    v_mfma_f32_16x16x32_bf16 v[140:143], a[212:215], v[172:175], v[140:143]
    v_mfma_f32_16x16x32_bf16 v[144:147], a[212:215], v[176:179], v[144:147]
    buffer_load_dword v255, v251, s[12:15], s35 offen sc1
    v_cvt_pk_bf16_f32 v216, v100, v101
    v_cvt_pk_bf16_f32 v217, v102, v103
    v_cvt_pk_bf16_f32 v218, v116, v117
    v_cvt_pk_bf16_f32 v219, v118, v119
    buffer_store_dwordx4 v[216:219], v187, s[12:15], s22 offen sc1
    s_add_u32 s22, s22, 147456
    v_cvt_pk_bf16_f32 v220, v104, v105
    v_cvt_pk_bf16_f32 v221, v106, v107
    v_cvt_pk_bf16_f32 v222, v120, v121
    v_cvt_pk_bf16_f32 v223, v122, v123
    buffer_store_dwordx4 v[220:223], v187, s[12:15], s22 offen sc1
    s_add_u32 s22, s22, 147456
    v_cvt_pk_bf16_f32 v224, v108, v109
    v_cvt_pk_bf16_f32 v225, v110, v111
    v_cvt_pk_bf16_f32 v226, v124, v125
    v_cvt_pk_bf16_f32 v227, v126, v127
    buffer_store_dwordx4 v[224:227], v187, s[12:15], s22 offen sc1
    s_add_u32 s22, s22, 147456
    v_cvt_pk_bf16_f32 v228, v112, v113
    v_cvt_pk_bf16_f32 v229, v114, v115
    v_cvt_pk_bf16_f32 v230, v128, v129
    v_cvt_pk_bf16_f32 v231, v130, v131
    buffer_store_dwordx4 v[228:231], v187, s[12:15], s22 offen sc1
    s_add_u32 s22, s22, 4294524928
    v_cvt_pk_bf16_f32 v232, v132, v133
    v_cvt_pk_bf16_f32 v233, v134, v135
    v_cvt_pk_bf16_f32 v234, v136, v137
    v_cvt_pk_bf16_f32 v235, v138, v139
    v_cvt_pk_bf16_f32 v236, v140, v141
    v_cvt_pk_bf16_f32 v237, v142, v143
    v_cvt_pk_bf16_f32 v238, v144, v145
    v_cvt_pk_bf16_f32 v239, v146, v147
    v_permlane16_swap_b32 v232, v234
    v_permlane16_swap_b32 v233, v235
    v_permlane16_swap_b32 v236, v238
    v_permlane16_swap_b32 v237, v239
    buffer_store_dwordx4 v[232:235], v249, s[12:15], s22 offen sc1
    s_add_u32 s22, s22, 294912
    buffer_store_dwordx4 v[236:239], v249, s[12:15], s22 offen sc1
    s_add_u32 s22, s22, 4294678528
    s_mov_b32 s24, 0x00003f80
    s_mov_b32 s25, 0x3f800000
    s_mov_b32 s26, 0x40088e99
    v_accvgpr_read_b32 v124, a216
    v_accvgpr_read_b32 v125, a217
    v_accvgpr_read_b32 v126, a218
    v_accvgpr_read_b32 v127, a219
    v_accvgpr_read_b32 v128, a220
    v_accvgpr_read_b32 v129, a221
    v_accvgpr_read_b32 v130, a222
    v_accvgpr_read_b32 v131, a223
    v_accvgpr_read_b32 v132, a224
    v_accvgpr_read_b32 v133, a225
    v_accvgpr_read_b32 v134, a226
    v_accvgpr_read_b32 v135, a227
    v_accvgpr_read_b32 v136, a228
    v_accvgpr_read_b32 v137, a229
    v_accvgpr_read_b32 v138, a230
    v_accvgpr_read_b32 v139, a231
    v_accvgpr_read_b32 v140, a232
    v_accvgpr_read_b32 v141, a233
    v_accvgpr_read_b32 v142, a234
    v_accvgpr_read_b32 v143, a235
    v_accvgpr_read_b32 v144, a236
    v_accvgpr_read_b32 v145, a237
    v_accvgpr_read_b32 v146, a238
    v_accvgpr_read_b32 v147, a239
    v_lshlrev_b32 v148, 16, v124
    v_and_b32 v149, 0xffff0000, v124
    v_lshlrev_b32 v150, 16, v125
    v_and_b32 v151, 0xffff0000, v125
    v_lshlrev_b32 v152, 16, v126
    v_and_b32 v153, 0xffff0000, v126
    v_lshlrev_b32 v154, 16, v127
    v_and_b32 v155, 0xffff0000, v127
    v_lshlrev_b32 v156, 16, v128
    v_and_b32 v157, 0xffff0000, v128
    v_lshlrev_b32 v158, 16, v129
    v_and_b32 v159, 0xffff0000, v129
    v_lshlrev_b32 v160, 16, v130
    v_and_b32 v161, 0xffff0000, v130
    v_lshlrev_b32 v162, 16, v131
    v_and_b32 v163, 0xffff0000, v131
    v_lshlrev_b32 v164, 16, v132
    v_and_b32 v165, 0xffff0000, v132
    v_lshlrev_b32 v166, 16, v133
    v_and_b32 v167, 0xffff0000, v133
    v_lshlrev_b32 v168, 16, v134
    v_and_b32 v169, 0xffff0000, v134
    v_lshlrev_b32 v170, 16, v135
    v_and_b32 v171, 0xffff0000, v135
    v_dot2c_f32_bf16 v148, s24, v136
    v_dot2c_f32_bf16 v149, s25, v136
    v_dot2c_f32_bf16 v150, s24, v137
    v_dot2c_f32_bf16 v151, s25, v137
    v_dot2c_f32_bf16 v152, s24, v138
    v_dot2c_f32_bf16 v153, s25, v138
    v_dot2c_f32_bf16 v154, s24, v139
    v_dot2c_f32_bf16 v155, s25, v139
    v_dot2c_f32_bf16 v156, s24, v140
    v_dot2c_f32_bf16 v157, s25, v140
    v_dot2c_f32_bf16 v158, s24, v141
    v_dot2c_f32_bf16 v159, s25, v141
    v_dot2c_f32_bf16 v160, s24, v142
    v_dot2c_f32_bf16 v161, s25, v142
    v_dot2c_f32_bf16 v162, s24, v143
    v_dot2c_f32_bf16 v163, s25, v143
    v_dot2c_f32_bf16 v164, s24, v144
    v_dot2c_f32_bf16 v165, s25, v144
    v_dot2c_f32_bf16 v166, s24, v145
    v_dot2c_f32_bf16 v167, s25, v145
    v_dot2c_f32_bf16 v168, s24, v146
    v_dot2c_f32_bf16 v169, s25, v146
    v_dot2c_f32_bf16 v170, s24, v147
    v_dot2c_f32_bf16 v171, s25, v147
    s_waitcnt vmcnt(6)
    s_mov_b32 s37, 4194304
ffn_kernel_s1a:
    v_cmp_gt_i32 vcc, 1, v255
    s_sub_u32 s37, s37, 1
    s_cbranch_scc1 ffn_kernel_s1b
    s_nop 2
    s_cbranch_vccz ffn_kernel_s1b
    buffer_load_dword v255, v251, s[12:15], s35 offen sc1
    s_waitcnt vmcnt(0)
    s_branch ffn_kernel_s1a
ffn_kernel_s1b:
    buffer_load_dwordx4 v[4:7], v186, s[12:15], s44 offen sc1
    s_add_u32 s44, s44, 768
    buffer_load_dwordx4 v[8:11], v186, s[12:15], s44 offen sc1
    s_add_u32 s44, s44, 768
    buffer_load_dwordx4 v[12:15], v186, s[12:15], s44 offen sc1
    s_add_u32 s44, s44, 768
    buffer_load_dwordx4 v[16:19], v186, s[12:15], s44 offen sc1
    s_add_u32 s44, s44, 768
    buffer_load_dwordx4 v[20:23], v186, s[12:15], s44 offen sc1
    s_add_u32 s44, s44, 768
    buffer_load_dwordx4 v[24:27], v186, s[12:15], s44 offen sc1
    s_add_u32 s44, s44, 768
    buffer_load_dwordx4 v[28:31], v186, s[12:15], s44 offen sc1
    s_add_u32 s44, s44, 768
    buffer_load_dwordx4 v[32:35], v186, s[12:15], s44 offen sc1
    s_add_u32 s44, s44, 768
    v_mov_b32 v254, 2
    s_waitcnt vmcnt(8)
    s_mov_b32 exec_hi, 0
    buffer_store_dword v254, v0, s[12:15], s36 offen sc1
    s_mov_b32 exec_hi, -1
    buffer_load_dwordx4 v[36:39], v186, s[12:15], s45 offen sc1
    s_add_u32 s45, s45, 768
    buffer_load_dwordx4 v[40:43], v186, s[12:15], s45 offen sc1
    s_add_u32 s45, s45, 768
    buffer_load_dwordx4 v[44:47], v186, s[12:15], s45 offen sc1
    s_add_u32 s45, s45, 768
    buffer_load_dwordx4 v[48:51], v186, s[12:15], s45 offen sc1
    s_add_u32 s45, s45, 768
    buffer_load_dwordx4 v[52:55], v186, s[12:15], s45 offen sc1
    s_add_u32 s45, s45, 768
    buffer_load_dwordx4 v[56:59], v186, s[12:15], s45 offen sc1
    s_add_u32 s45, s45, 768
    buffer_load_dwordx4 v[60:63], v186, s[12:15], s45 offen sc1
    s_add_u32 s45, s45, 768
    buffer_load_dwordx4 v[64:67], v186, s[12:15], s45 offen sc1
    s_add_u32 s45, s45, 768
    s_waitcnt vmcnt(16)
    v_lshlrev_b32 v100, 16, v4
    v_and_b32 v101, 0xffff0000, v4
    v_lshlrev_b32 v102, 16, v5
    v_and_b32 v103, 0xffff0000, v5
    v_lshlrev_b32 v104, 16, v6
    v_and_b32 v105, 0xffff0000, v6
    v_lshlrev_b32 v106, 16, v7
    v_and_b32 v107, 0xffff0000, v7
    s_waitcnt vmcnt(15)
    v_dot2c_f32_bf16 v100, s24, v8
    v_dot2c_f32_bf16 v101, s25, v8
    v_dot2c_f32_bf16 v102, s24, v9
    v_dot2c_f32_bf16 v103, s25, v9
    v_dot2c_f32_bf16 v104, s24, v10
    v_dot2c_f32_bf16 v105, s25, v10
    v_dot2c_f32_bf16 v106, s24, v11
    v_dot2c_f32_bf16 v107, s25, v11
    s_waitcnt vmcnt(14)
    v_dot2c_f32_bf16 v100, s24, v12
    v_dot2c_f32_bf16 v101, s25, v12
    v_dot2c_f32_bf16 v102, s24, v13
    v_dot2c_f32_bf16 v103, s25, v13
    v_dot2c_f32_bf16 v104, s24, v14
    v_dot2c_f32_bf16 v105, s25, v14
    v_dot2c_f32_bf16 v106, s24, v15
    v_dot2c_f32_bf16 v107, s25, v15
    s_waitcnt vmcnt(13)
    v_dot2c_f32_bf16 v100, s24, v16
    v_dot2c_f32_bf16 v101, s25, v16
    v_dot2c_f32_bf16 v102, s24, v17
    v_dot2c_f32_bf16 v103, s25, v17
    v_dot2c_f32_bf16 v104, s24, v18
    v_dot2c_f32_bf16 v105, s25, v18
    v_dot2c_f32_bf16 v106, s24, v19
    v_dot2c_f32_bf16 v107, s25, v19
    s_waitcnt vmcnt(12)
    v_dot2c_f32_bf16 v100, s24, v20
    v_dot2c_f32_bf16 v101, s25, v20
    v_dot2c_f32_bf16 v102, s24, v21
    v_dot2c_f32_bf16 v103, s25, v21
    v_dot2c_f32_bf16 v104, s24, v22
    v_dot2c_f32_bf16 v105, s25, v22
    v_dot2c_f32_bf16 v106, s24, v23
    v_dot2c_f32_bf16 v107, s25, v23
    s_waitcnt vmcnt(11)
    v_dot2c_f32_bf16 v100, s24, v24
    v_dot2c_f32_bf16 v101, s25, v24
    v_dot2c_f32_bf16 v102, s24, v25
    v_dot2c_f32_bf16 v103, s25, v25
    v_dot2c_f32_bf16 v104, s24, v26
    v_dot2c_f32_bf16 v105, s25, v26
    v_dot2c_f32_bf16 v106, s24, v27
    v_dot2c_f32_bf16 v107, s25, v27
    s_waitcnt vmcnt(10)
    v_dot2c_f32_bf16 v100, s24, v28
    v_dot2c_f32_bf16 v101, s25, v28
    v_dot2c_f32_bf16 v102, s24, v29
    v_dot2c_f32_bf16 v103, s25, v29
    v_dot2c_f32_bf16 v104, s24, v30
    v_dot2c_f32_bf16 v105, s25, v30
    v_dot2c_f32_bf16 v106, s24, v31
    v_dot2c_f32_bf16 v107, s25, v31
    s_waitcnt vmcnt(9)
    v_dot2c_f32_bf16 v100, s24, v32
    v_dot2c_f32_bf16 v101, s25, v32
    v_dot2c_f32_bf16 v102, s24, v33
    v_dot2c_f32_bf16 v103, s25, v33
    v_dot2c_f32_bf16 v104, s24, v34
    v_dot2c_f32_bf16 v105, s25, v34
    v_dot2c_f32_bf16 v106, s24, v35
    v_dot2c_f32_bf16 v107, s25, v35
    s_waitcnt vmcnt(7)
    v_lshlrev_b32 v108, 16, v36
    v_and_b32 v109, 0xffff0000, v36
    v_lshlrev_b32 v110, 16, v37
    v_and_b32 v111, 0xffff0000, v37
    v_lshlrev_b32 v112, 16, v38
    v_and_b32 v113, 0xffff0000, v38
    v_lshlrev_b32 v114, 16, v39
    v_and_b32 v115, 0xffff0000, v39
    s_waitcnt vmcnt(6)
    v_dot2c_f32_bf16 v108, s24, v40
    v_dot2c_f32_bf16 v109, s25, v40
    v_dot2c_f32_bf16 v110, s24, v41
    v_dot2c_f32_bf16 v111, s25, v41
    v_dot2c_f32_bf16 v112, s24, v42
    v_dot2c_f32_bf16 v113, s25, v42
    v_dot2c_f32_bf16 v114, s24, v43
    v_dot2c_f32_bf16 v115, s25, v43
    buffer_load_dword v255, v251, s[12:15], s35 offen sc1
    s_waitcnt vmcnt(6)
    v_dot2c_f32_bf16 v108, s24, v44
    v_dot2c_f32_bf16 v109, s25, v44
    v_dot2c_f32_bf16 v110, s24, v45
    v_dot2c_f32_bf16 v111, s25, v45
    v_dot2c_f32_bf16 v112, s24, v46
    v_dot2c_f32_bf16 v113, s25, v46
    v_dot2c_f32_bf16 v114, s24, v47
    v_dot2c_f32_bf16 v115, s25, v47
    s_waitcnt vmcnt(5)
    v_dot2c_f32_bf16 v108, s24, v48
    v_dot2c_f32_bf16 v109, s25, v48
    v_dot2c_f32_bf16 v110, s24, v49
    v_dot2c_f32_bf16 v111, s25, v49
    v_dot2c_f32_bf16 v112, s24, v50
    v_dot2c_f32_bf16 v113, s25, v50
    v_dot2c_f32_bf16 v114, s24, v51
    v_dot2c_f32_bf16 v115, s25, v51
    s_waitcnt vmcnt(4)
    v_dot2c_f32_bf16 v108, s24, v52
    v_dot2c_f32_bf16 v109, s25, v52
    v_dot2c_f32_bf16 v110, s24, v53
    v_dot2c_f32_bf16 v111, s25, v53
    v_dot2c_f32_bf16 v112, s24, v54
    v_dot2c_f32_bf16 v113, s25, v54
    v_dot2c_f32_bf16 v114, s24, v55
    v_dot2c_f32_bf16 v115, s25, v55
    s_waitcnt vmcnt(3)
    v_dot2c_f32_bf16 v108, s24, v56
    v_dot2c_f32_bf16 v109, s25, v56
    v_dot2c_f32_bf16 v110, s24, v57
    v_dot2c_f32_bf16 v111, s25, v57
    v_dot2c_f32_bf16 v112, s24, v58
    v_dot2c_f32_bf16 v113, s25, v58
    v_dot2c_f32_bf16 v114, s24, v59
    v_dot2c_f32_bf16 v115, s25, v59
    s_waitcnt vmcnt(2)
    v_dot2c_f32_bf16 v108, s24, v60
    v_dot2c_f32_bf16 v109, s25, v60
    v_dot2c_f32_bf16 v110, s24, v61
    v_dot2c_f32_bf16 v111, s25, v61
    v_dot2c_f32_bf16 v112, s24, v62
    v_dot2c_f32_bf16 v113, s25, v62
    v_dot2c_f32_bf16 v114, s24, v63
    v_dot2c_f32_bf16 v115, s25, v63
    s_waitcnt vmcnt(1)
    v_dot2c_f32_bf16 v108, s24, v64
    v_dot2c_f32_bf16 v109, s25, v64
    v_dot2c_f32_bf16 v110, s24, v65
    v_dot2c_f32_bf16 v111, s25, v65
    v_dot2c_f32_bf16 v112, s24, v66
    v_dot2c_f32_bf16 v113, s25, v66
    v_dot2c_f32_bf16 v114, s24, v67
    v_dot2c_f32_bf16 v115, s25, v67
    s_waitcnt vmcnt(0)
    s_mov_b32 s37, 4194304
ffn_kernel_s2a:
    v_cmp_gt_i32 vcc, 2, v255
    s_sub_u32 s37, s37, 1
    s_cbranch_scc1 ffn_kernel_s2b
    s_nop 2
    s_cbranch_vccz ffn_kernel_s2b
    buffer_load_dword v255, v251, s[12:15], s35 offen sc1
    s_waitcnt vmcnt(0)
    s_branch ffn_kernel_s2a
ffn_kernel_s2b:
    buffer_load_dwordx4 v[68:71], v186, s[12:15], s46 offen sc1
    s_add_u32 s46, s46, 768
    buffer_load_dwordx4 v[72:75], v186, s[12:15], s46 offen sc1
    s_add_u32 s46, s46, 768
    buffer_load_dwordx4 v[76:79], v186, s[12:15], s46 offen sc1
    s_add_u32 s46, s46, 768
    buffer_load_dwordx4 v[80:83], v186, s[12:15], s46 offen sc1
    s_add_u32 s46, s46, 768
    buffer_load_dwordx4 v[84:87], v186, s[12:15], s46 offen sc1
    s_add_u32 s46, s46, 768
    buffer_load_dwordx4 v[88:91], v186, s[12:15], s46 offen sc1
    s_add_u32 s46, s46, 768
    buffer_load_dwordx4 v[92:95], v186, s[12:15], s46 offen sc1
    s_add_u32 s46, s46, 768
    buffer_load_dwordx4 v[96:99], v186, s[12:15], s46 offen sc1
    s_add_u32 s46, s46, 768
    v_fma_f32 v100, v100, s26, v148
    v_fma_f32 v101, v101, s26, v149
    v_fma_f32 v102, v102, s26, v150
    v_fma_f32 v103, v103, s26, v151
    v_fma_f32 v104, v104, s26, v152
    v_fma_f32 v105, v105, s26, v153
    v_fma_f32 v106, v106, s26, v154
    v_fma_f32 v107, v107, s26, v155
    v_cvt_pk_bf16_f32 v124, v100, v101
    v_cvt_pk_bf16_f32 v125, v102, v103
    v_cvt_pk_bf16_f32 v126, v104, v105
    v_cvt_pk_bf16_f32 v127, v106, v107
    buffer_store_dwordx4 v[124:127], v2, s[60:63], s41 offen offset:0
    v_fma_f32 v108, v108, s26, v156
    v_fma_f32 v109, v109, s26, v157
    v_fma_f32 v110, v110, s26, v158
    v_fma_f32 v111, v111, s26, v159
    v_fma_f32 v112, v112, s26, v160
    v_fma_f32 v113, v113, s26, v161
    v_fma_f32 v114, v114, s26, v162
    v_fma_f32 v115, v115, s26, v163
    v_cvt_pk_bf16_f32 v128, v108, v109
    v_cvt_pk_bf16_f32 v129, v110, v111
    v_cvt_pk_bf16_f32 v130, v112, v113
    v_cvt_pk_bf16_f32 v131, v114, v115
    buffer_store_dwordx4 v[128:131], v2, s[60:63], s41 offen offset:96
    s_waitcnt vmcnt(9)
    v_lshlrev_b32 v116, 16, v68
    v_and_b32 v117, 0xffff0000, v68
    v_lshlrev_b32 v118, 16, v69
    v_and_b32 v119, 0xffff0000, v69
    v_lshlrev_b32 v120, 16, v70
    v_and_b32 v121, 0xffff0000, v70
    v_lshlrev_b32 v122, 16, v71
    v_and_b32 v123, 0xffff0000, v71
    s_waitcnt vmcnt(8)
    v_dot2c_f32_bf16 v116, s24, v72
    v_dot2c_f32_bf16 v117, s25, v72
    v_dot2c_f32_bf16 v118, s24, v73
    v_dot2c_f32_bf16 v119, s25, v73
    v_dot2c_f32_bf16 v120, s24, v74
    v_dot2c_f32_bf16 v121, s25, v74
    v_dot2c_f32_bf16 v122, s24, v75
    v_dot2c_f32_bf16 v123, s25, v75
    s_waitcnt vmcnt(7)
    v_dot2c_f32_bf16 v116, s24, v76
    v_dot2c_f32_bf16 v117, s25, v76
    v_dot2c_f32_bf16 v118, s24, v77
    v_dot2c_f32_bf16 v119, s25, v77
    v_dot2c_f32_bf16 v120, s24, v78
    v_dot2c_f32_bf16 v121, s25, v78
    v_dot2c_f32_bf16 v122, s24, v79
    v_dot2c_f32_bf16 v123, s25, v79
    s_waitcnt vmcnt(6)
    v_dot2c_f32_bf16 v116, s24, v80
    v_dot2c_f32_bf16 v117, s25, v80
    v_dot2c_f32_bf16 v118, s24, v81
    v_dot2c_f32_bf16 v119, s25, v81
    v_dot2c_f32_bf16 v120, s24, v82
    v_dot2c_f32_bf16 v121, s25, v82
    v_dot2c_f32_bf16 v122, s24, v83
    v_dot2c_f32_bf16 v123, s25, v83
    s_waitcnt vmcnt(5)
    v_dot2c_f32_bf16 v116, s24, v84
    v_dot2c_f32_bf16 v117, s25, v84
    v_dot2c_f32_bf16 v118, s24, v85
    v_dot2c_f32_bf16 v119, s25, v85
    v_dot2c_f32_bf16 v120, s24, v86
    v_dot2c_f32_bf16 v121, s25, v86
    v_dot2c_f32_bf16 v122, s24, v87
    v_dot2c_f32_bf16 v123, s25, v87
    s_waitcnt vmcnt(4)
    v_dot2c_f32_bf16 v116, s24, v88
    v_dot2c_f32_bf16 v117, s25, v88
    v_dot2c_f32_bf16 v118, s24, v89
    v_dot2c_f32_bf16 v119, s25, v89
    v_dot2c_f32_bf16 v120, s24, v90
    v_dot2c_f32_bf16 v121, s25, v90
    v_dot2c_f32_bf16 v122, s24, v91
    v_dot2c_f32_bf16 v123, s25, v91
    s_waitcnt vmcnt(3)
    v_dot2c_f32_bf16 v116, s24, v92
    v_dot2c_f32_bf16 v117, s25, v92
    v_dot2c_f32_bf16 v118, s24, v93
    v_dot2c_f32_bf16 v119, s25, v93
    v_dot2c_f32_bf16 v120, s24, v94
    v_dot2c_f32_bf16 v121, s25, v94
    v_dot2c_f32_bf16 v122, s24, v95
    v_dot2c_f32_bf16 v123, s25, v95
    s_waitcnt vmcnt(2)
    v_dot2c_f32_bf16 v116, s24, v96
    v_dot2c_f32_bf16 v117, s25, v96
    v_dot2c_f32_bf16 v118, s24, v97
    v_dot2c_f32_bf16 v119, s25, v97
    v_dot2c_f32_bf16 v120, s24, v98
    v_dot2c_f32_bf16 v121, s25, v98
    v_dot2c_f32_bf16 v122, s24, v99
    v_dot2c_f32_bf16 v123, s25, v99
    v_fma_f32 v116, v116, s26, v164
    v_fma_f32 v117, v117, s26, v165
    v_fma_f32 v118, v118, s26, v166
    v_fma_f32 v119, v119, s26, v167
    v_fma_f32 v120, v120, s26, v168
    v_fma_f32 v121, v121, s26, v169
    v_fma_f32 v122, v122, s26, v170
    v_fma_f32 v123, v123, s26, v171
    v_cvt_pk_bf16_f32 v132, v116, v117
    v_cvt_pk_bf16_f32 v133, v118, v119
    v_cvt_pk_bf16_f32 v134, v120, v121
    v_cvt_pk_bf16_f32 v135, v122, v123
    buffer_store_dwordx4 v[132:135], v2, s[60:63], s41 offen offset:192
ffn_kernel_end:
    s_endpgm
.section .rodata,"a"
.p2align 6
.amdhsa_kernel qkv_kernel
  .amdhsa_next_free_vgpr 284
  .amdhsa_next_free_sgpr 102
  .amdhsa_accum_offset 256
  .amdhsa_group_segment_fixed_size 0
  .amdhsa_kernarg_size 88
  .amdhsa_user_sgpr_count 2
  .amdhsa_user_sgpr_kernarg_segment_ptr 1
  .amdhsa_system_sgpr_workgroup_id_x 1
.end_amdhsa_kernel
.p2align 6
.amdhsa_kernel attn_kernel
  .amdhsa_next_free_vgpr 176
  .amdhsa_next_free_sgpr 102
  .amdhsa_accum_offset 176
  .amdhsa_group_segment_fixed_size 0
  .amdhsa_kernarg_size 88
  .amdhsa_user_sgpr_count 2
  .amdhsa_user_sgpr_kernarg_segment_ptr 1
  .amdhsa_system_sgpr_workgroup_id_x 1
.end_amdhsa_kernel
.p2align 6
.amdhsa_kernel ffn_kernel
  .amdhsa_next_free_vgpr 496
  .amdhsa_next_free_sgpr 102
  .amdhsa_accum_offset 256
  .amdhsa_group_segment_fixed_size 0
  .amdhsa_kernarg_size 88
  .amdhsa_user_sgpr_count 2
  .amdhsa_user_sgpr_kernarg_segment_ptr 1
  .amdhsa_system_sgpr_workgroup_id_x 1
.end_amdhsa_kernel
```
